```python
import torch

def _softmax(x, axis=-1):
    return torch.softmax(x, dim=axis)
def _gelu(x):
    return torch.nn.functional.gelu(x, approximate="tanh")
def _silu(x):
    return torch.nn.functional.silu(x)
def _sigmoid(x):
    return torch.sigmoid(x)
def _layernorm(x, axis=-1, eps=1e-5):
    m = x.mean(dim=axis, keepdim=True)
    v = x.var(dim=axis, keepdim=True, unbiased=False)
    return (x - m) / torch.sqrt(v + eps)
def _scatter_add(tgt, idx, src, axis=0):
    return tgt.clone().index_add_(axis, idx, src)
def _segment_sum(src, seg, n):
    out = torch.zeros((n,) + src.shape[1:], dtype=src.dtype)
    return out.index_add_(0, seg, src)
def _pad(x, pw):
    flat = tuple(v for pair in reversed(pw) for v in pair)
    return torch.nn.functional.pad(x, flat)

kernel_name = 'recurrent_scan__sliding_block__mixer_channel_mlp__prompt'

def setup_inputs():

    _w = (lambda a: (lambda t: t.to(torch.bfloat16) if t.is_floating_point() else t)(torch.as_tensor(a)))
    def _A_setup():
        B, S, D = 1, 2048, 512
        return {
            "x": _w((lambda *s: torch.randn(*s, dtype=torch.bfloat16) * 0.05)(B, S, D)),
            "wqkv": _w((lambda *s: torch.randn(*s, dtype=torch.bfloat16) * 0.05)(D, 3 * D)),
            "wo": _w((lambda *s: torch.randn(*s, dtype=torch.bfloat16) * 0.05)(D, D)),
        }
    _A_in = _A_setup()

    def _B_setup():
        B, S, D, F = 1, 2048, 512, 1792
        return {
            "x": _w((lambda *s: torch.randn(*s, dtype=torch.bfloat16) * 0.05)(B, S, D)),
            "w1": _w((lambda *s: torch.randn(*s, dtype=torch.bfloat16) * 1.6)(D, F) * (D ** -0.5)),
            "b1": _w((lambda *s: torch.randn(*s, dtype=torch.bfloat16) * 0.8)(F)),
            "w2": _w((lambda *s: torch.randn(*s, dtype=torch.bfloat16) * 0.05)(F, D) * (F ** -0.5)),
            "b2": _w((lambda *s: torch.randn(*s, dtype=torch.bfloat16) * 0.05)(D)),
        }
    _B_in = _B_setup()

    return {
        "A_x": _A_in["x"],
        "A_wqkv": _A_in["wqkv"],
        "A_wo": _A_in["wo"],
        "B_x": _B_in["x"],
        "B_w1": _B_in["w1"],
        "B_b1": _B_in["b1"],
        "B_w2": _B_in["w2"],
        "B_b2": _B_in["b2"],
    }

def reference(A_x, A_wqkv, A_wo, B_x, B_w1, B_b1, B_w2, B_b2):
    def _A_ref(x, wqkv, wo):
        B, S, D = x.shape
        H = 32; Dh = D // H; W = 256
        qkv = (lambda x, *d: x.permute(*d))((x @ wqkv).reshape(B, S, 3, H, Dh), 2, 0, 3, 1, 4)
        q, k, v = qkv[0], qkv[1], qkv[2]
        scores = torch.einsum("bhqd,bhkd->bhqk", q, k) * (Dh ** -0.5)
        idx = torch.arange(S)
        mask = (idx[:, None] - idx[None, :] >= 0) & (idx[:, None] - idx[None, :] < W)
        scores = torch.where(mask[None, None], scores, -1e9)
        p = _softmax(scores, axis=-1)
        o = torch.einsum("bhqk,bhkd->bhqd", p, v)
        return (lambda x, *d: x.permute(*d))(o, 0, 2, 1, 3).reshape(B, S, D) @ wo

    def _B_ref(x, w1, b1, w2, b2):
        y = _layernorm(x, axis=-1)
        h = _gelu(torch.einsum("bsd,df->bsf", y, w1) + b1)
        return torch.einsum("bsf,fd->bsd", h, w2) + b2

    x = A_x
    xn = _layernorm(x, axis=-1)
    s = _A_ref(xn, A_wqkv, A_wo)
    g = _silu(_B_ref(xn, B_w1, B_b1, B_w2, B_b2))
    return x + s * g
```

```asm
; @launch grid=(256,1,1) block=(256,1,1) lds=163840
.amdgcn_target "amdgcn-amd-amdhsa--gfx950"
.text
.globl recurrent_scan__sliding_block__mixer_channel_mlp__prompt_kernel
.p2align 8
.type recurrent_scan__sliding_block__mixer_channel_mlp__prompt_kernel,@function
recurrent_scan__sliding_block__mixer_channel_mlp__prompt_kernel:
  s_cmp_ge_u32 s2, 256
  s_cbranch_scc1 L_end
  s_load_dwordx2 s[4:5], s[0:1], 0
  s_load_dwordx2 s[8:9], s[0:1], 8
  s_load_dwordx2 s[28:29], s[0:1], 80
  s_load_dwordx2 s[32:33], s[0:1], 40
  s_load_dwordx2 s[16:17], s[0:1], 32
  s_load_dwordx2 s[12:13], s[0:1], 16
  s_load_dwordx2 s[20:21], s[0:1], 48
  s_load_dwordx2 s[36:37], s[0:1], 56
  s_load_dwordx2 s[24:25], s[0:1], 64
  s_getpc_b64 s[60:61]
L_pc:
  v_lshrrev_b32 v2, 6, v0
  v_and_b32 v1, 3, v0
  v_lshl_add_u32 v1, v2, 2, v1
  s_lshr_b32 s46, s2, 3
  s_lshl_b32 s49, s46, 11
  v_lshlrev_b32 v1, 7, v1
  v_add_u32 v1, s49, v1
  s_mov_b32 s50, L_hot_end-L_pc-4
  v_min_u32 v1, s50, v1
  v_readfirstlane_b32 s42, v2
  global_load_dword a255, v1, s[60:61]
  s_and_b32 s49, s2, 7
  s_lshr_b32 s50, s49, 1
  s_lshl_b32 s50, s50, 2
  s_and_b32 s51, s46, 3
  s_add_u32 s40, s50, s51
  s_and_b32 s50, s49, 1
  s_lshl_b32 s50, s50, 3
  s_lshr_b32 s51, s46, 2
  s_add_u32 s41, s50, s51
  v_and_b32 v0, 63, v0
  s_mov_b32 s6, 2097152
  s_mov_b32 s7, 0x20000
  s_mov_b32 s10, 1572864
  s_mov_b32 s11, 0x20000
  s_mov_b32 s30, 33554432
  s_mov_b32 s31, 0x20000
  s_mov_b32 s34, 3584
  s_mov_b32 s35, 0x20000
  s_lshr_b32 s50, s41, 1
  s_mul_i32 s50, s50, 7
  s_and_b32 s47, s41, 1
  s_lshl_b32 s51, s47, 2
  s_add_u32 s45, s50, s51
  s_lshr_b32 s50, s40, 2
  s_lshl_b32 s50, s50, 9
  s_lshl_b32 s51, s46, 4
  s_add_u32 s50, s50, s51
  s_lshl_b32 s51, s42, 2
  s_add_u32 s50, s50, s51
  s_lshl_b32 s50, s50, 10
  v_bfe_u32 v1, v0, 3, 2
  v_and_b32 v2, 7, v0
  v_lshlrev_b32 v2, 7, v2
  v_lshl_add_u32 v1, v1, 10, v2
  s_waitcnt lgkmcnt(0)
  buffer_load_dword a254, v1, s[4:7], s50 offen
  s_waitcnt lgkmcnt(0)
  buffer_load_dword v13, off, s[28:31], 0 offset:0 sc1
  v_and_b32 v14, 31, v0
  v_lshlrev_b32 v14, 1, v14
  s_lshl_b32 s49, s45, 6
  buffer_load_ushort v104, v14, s[32:35], s49 offen offset:0
  buffer_load_ushort v105, v14, s[32:35], s49 offen offset:64
  buffer_load_ushort v106, v14, s[32:35], s49 offen offset:128
  buffer_load_ushort v107, v14, s[32:35], s49 offen offset:192
  s_lshl_b32 s44, s40, 2
  s_add_u32 s44, s44, s42
  s_lshl_b32 s52, s44, 15
  s_lshl_b32 s53, s42, 15
  v_lshrrev_b32 v14, 4, v0
  v_and_b32 v12, 15, v0
  v_xor_b32 v12, v12, v14
  v_lshlrev_b32 v12, 4, v12
  v_lshl_add_u32 v124, v14, 10, v12
  v_xor_b32 v125, 64, v124
  v_xor_b32 v126, 128, v124
  v_xor_b32 v127, 192, v124
  s_lshl_b32 s56, s42, 13
  s_mul_i32 s54, s42, 393216
  s_lshl_b32 s50, s41, 6
  s_add_u32 s54, s54, s50
  v_lshlrev_b32 v1, 4, v0
  v_lshrrev_b32 v14, 2, v0
  v_and_b32 v12, 3, v0
  v_lshlrev_b32 v12, 4, v12
  s_movk_i32 s50, 3072
  s_movk_i32 s51, 3584
  v_mad_u32_u24 v2, v14, s50, v12
  v_mad_u32_u24 v3, v14, s51, v12
  s_mul_i32 s55, s42, 458752
  s_lshl_b32 s50, s45, 6
  s_add_u32 s55, s55, s50
  s_lshl_b32 s50, s41, 6
  s_add_u32 s50, s50, s44
  s_lshl_b32 s57, s50, 12
  s_add_u32 s57, s57, 65536
  s_mul_i32 s50, s44, 112
  s_lshl_b32 s51, s45, 1
  s_add_u32 s50, s50, s51
  s_lshl_b32 s50, s50, 10
  s_add_u32 s58, s50, 7340032
  s_mov_b32 s18, 1835008
  s_mov_b32 s19, 0x20000
  s_mov_b32 s14, 524288
  s_mov_b32 s15, 0x20000
  s_mov_b32 s22, 1835008
  s_mov_b32 s23, 0x20000
  s_mov_b32 s38, 1024
  s_mov_b32 s39, 0x20000
  s_mov_b32 s26, 2097152
  s_mov_b32 s27, 0x20000
  v_lshrrev_b32 v14, 5, v0
  v_lshlrev_b32 v14, 2, v14
  v_bfe_u32 v15, v0, 2, 2
  v_add_u32 v14, v14, v15
  v_lshlrev_b32 v14, 6, v14
  v_bfe_u32 v15, v0, 4, 1
  v_lshl_add_u32 v14, v15, 5, v14
  v_and_b32 v15, 3, v0
  v_lshl_add_u32 v4, v15, 3, v14
  v_and_b32 v14, 31, v0
  v_lshrrev_b32 v15, 5, v0
  v_and_b32 v96, 15, v0
  v_xor_b32 v15, v15, v96
  v_lshlrev_b32 v15, 4, v15
  v_lshl_add_u32 v14, v14, 8, v15
  v_add_u32 v96, s53, v14
  v_xor_b32 v97, 32, v96
  v_xor_b32 v98, 64, v96
  v_xor_b32 v99, 96, v96
  v_xor_b32 v100, 128, v96
  v_xor_b32 v101, 160, v96
  v_xor_b32 v102, 192, v96
  v_xor_b32 v103, 224, v96
  v_mov_b32 v112, 0xbb00bb00
  v_mov_b32 v113, 0xbb00bb00
  v_mov_b32 v114, 0xbb00bb00
  v_mov_b32 v115, 0xbb00bb00
  v_and_b32 v14, 31, v0
  v_lshrrev_b32 v15, 5, v0
  v_lshlrev_b32 v15, 3, v15
  v_sub_u32 v14, v14, v15
  v_and_b32 v15, 1, v14
  v_lshlrev_b32 v15, 4, v15
  v_mov_b32 v16, 0x3f80
  v_lshlrev_b32 v15, v15, v16
  v_lshrrev_b32 v16, 1, v14
  v_subrev_u32 v17, 8, v16
  v_cmp_eq_u32 s[60:61], 0, v16
  s_nop 1
  v_cndmask_b32 v116, 0, v15, s[60:61]
  v_cmp_eq_u32 s[62:63], 1, v16
  s_nop 1
  v_cndmask_b32 v117, 0, v15, s[62:63]
  v_cmp_eq_u32 s[60:61], 2, v16
  s_nop 1
  v_cndmask_b32 v118, 0, v15, s[60:61]
  v_cmp_eq_u32 s[62:63], 3, v16
  s_nop 1
  v_cndmask_b32 v119, 0, v15, s[62:63]
  v_cmp_eq_u32 s[60:61], 0, v17
  s_nop 1
  v_cndmask_b32 v120, 0, v15, s[60:61]
  v_cmp_eq_u32 s[62:63], 1, v17
  s_nop 1
  v_cndmask_b32 v121, 0, v15, s[62:63]
  v_cmp_eq_u32 s[60:61], 2, v17
  s_nop 1
  v_cndmask_b32 v122, 0, v15, s[60:61]
  v_cmp_eq_u32 s[62:63], 3, v17
  s_nop 1
  v_cndmask_b32 v123, 0, v15, s[62:63]
  s_mov_b32 s60, 0xaaaaaaaa
  s_mov_b32 s61, 0xaaaaaaaa
  s_mov_b32 s62, 0xcccccccc
  s_mov_b32 s63, 0xcccccccc
  s_mov_b32 s64, 0xf0f0f0f0
  s_mov_b32 s65, 0xf0f0f0f0
  s_mov_b32 s66, 0xff00ff00
  s_mov_b32 s67, 0xff00ff00
  s_mov_b32 s68, 0xffff0000
  s_mov_b32 s69, 0xffff0000
  v_and_b32 v14, 31, v0
  v_lshrrev_b32 v15, 5, v0
  v_lshlrev_b32 v15, 2, v15
  v_sub_u32 v14, v14, v15
  v_cmp_le_i32 s[70:71], 0, v14
  v_cmp_le_i32 s[72:73], 1, v14
  v_cmp_le_i32 s[74:75], 2, v14
  v_cmp_le_i32 s[76:77], 3, v14
  v_cmp_le_i32 s[78:79], 8, v14
  v_cmp_le_i32 s[80:81], 9, v14
  v_cmp_le_i32 s[82:83], 10, v14
  v_cmp_le_i32 s[84:85], 11, v14
  v_cmp_le_i32 s[86:87], 16, v14
  v_cmp_le_i32 s[88:89], 17, v14
  v_cmp_le_i32 s[90:91], 18, v14
  v_cmp_le_i32 s[92:93], 19, v14
  v_cmp_le_i32 s[94:95], 24, v14
  v_cmp_le_i32 s[96:97], 25, v14
  v_cmp_le_i32 s[98:99], 26, v14
  v_cmp_le_i32 s[100:101], 27, v14
  s_add_u32 m0, s53, 0
  s_add_u32 s48, s52, 0
  buffer_load_dwordx4 v124, s[4:7], s48 offen lds
  s_add_u32 m0, s53, 1024
  s_add_u32 s48, s52, 4096
  buffer_load_dwordx4 v125, s[4:7], s48 offen lds
  s_add_u32 m0, s53, 2048
  s_add_u32 s48, s52, 8192
  buffer_load_dwordx4 v126, s[4:7], s48 offen lds
  s_add_u32 m0, s53, 3072
  s_add_u32 s48, s52, 12288
  buffer_load_dwordx4 v127, s[4:7], s48 offen lds
  s_add_u32 m0, s53, 4096
  s_add_u32 s48, s52, 16384
  buffer_load_dwordx4 v124, s[4:7], s48 offen lds
  s_add_u32 m0, s53, 5120
  s_add_u32 s48, s52, 20480
  buffer_load_dwordx4 v125, s[4:7], s48 offen lds
  s_add_u32 m0, s53, 6144
  s_add_u32 s48, s52, 24576
  buffer_load_dwordx4 v126, s[4:7], s48 offen lds
  s_add_u32 m0, s53, 7168
  s_add_u32 s48, s52, 28672
  buffer_load_dwordx4 v127, s[4:7], s48 offen lds
  s_add_u32 m0, s53, 8192
  s_add_u32 s48, s52, 256
  buffer_load_dwordx4 v124, s[4:7], s48 offen lds
  s_add_u32 m0, s53, 9216
  s_add_u32 s48, s52, 4352
  buffer_load_dwordx4 v125, s[4:7], s48 offen lds
  s_add_u32 m0, s53, 10240
  s_add_u32 s48, s52, 8448
  buffer_load_dwordx4 v126, s[4:7], s48 offen lds
  s_add_u32 m0, s53, 11264
  s_add_u32 s48, s52, 12544
  buffer_load_dwordx4 v127, s[4:7], s48 offen lds
  s_add_u32 m0, s53, 12288
  s_add_u32 s48, s52, 16640
  buffer_load_dwordx4 v124, s[4:7], s48 offen lds
  s_add_u32 m0, s53, 13312
  s_add_u32 s48, s52, 20736
  buffer_load_dwordx4 v125, s[4:7], s48 offen lds
  s_add_u32 m0, s53, 14336
  s_add_u32 s48, s52, 24832
  buffer_load_dwordx4 v126, s[4:7], s48 offen lds
  s_add_u32 m0, s53, 15360
  s_add_u32 s48, s52, 28928
  buffer_load_dwordx4 v127, s[4:7], s48 offen lds
  s_waitcnt vmcnt(8)
  ds_read_b128 v[128:131], v96 offset:0
  ds_read_b128 v[132:135], v97 offset:0
  ds_read_b128 v[136:139], v98 offset:0
  ds_read_b128 v[140:143], v99 offset:0
  ds_read_b128 v[144:147], v100 offset:0
  ds_read_b128 v[148:151], v101 offset:0
  ds_read_b128 v[152:155], v102 offset:0
  ds_read_b128 v[156:159], v103 offset:0
  s_waitcnt lgkmcnt(7)
  v_mfma_f32_32x32x16_bf16 v[64:79], v[112:115], v[128:131], 0
  v_mfma_f32_32x32x16_bf16 v[80:95], v[128:131], v[128:131], 0
  s_add_u32 m0, s53, 16384
  s_add_u32 s48, s52, 512
  buffer_load_dwordx4 v124, s[4:7], s48 offen lds
  s_waitcnt lgkmcnt(6)
  v_mfma_f32_32x32x16_bf16 v[64:79], v[112:115], v[132:135], v[64:79]
  v_mfma_f32_32x32x16_bf16 v[80:95], v[132:135], v[132:135], v[80:95]
  s_add_u32 m0, s53, 17408
  s_add_u32 s48, s52, 4608
  buffer_load_dwordx4 v125, s[4:7], s48 offen lds
  s_waitcnt lgkmcnt(5)
  v_mfma_f32_32x32x16_bf16 v[64:79], v[112:115], v[136:139], v[64:79]
  v_mfma_f32_32x32x16_bf16 v[80:95], v[136:139], v[136:139], v[80:95]
  s_add_u32 m0, s53, 18432
  s_add_u32 s48, s52, 8704
  buffer_load_dwordx4 v126, s[4:7], s48 offen lds
  s_waitcnt lgkmcnt(4)
  v_mfma_f32_32x32x16_bf16 v[64:79], v[112:115], v[140:143], v[64:79]
  v_mfma_f32_32x32x16_bf16 v[80:95], v[140:143], v[140:143], v[80:95]
  s_add_u32 m0, s53, 19456
  s_add_u32 s48, s52, 12800
  buffer_load_dwordx4 v127, s[4:7], s48 offen lds
  s_waitcnt lgkmcnt(3)
  v_mfma_f32_32x32x16_bf16 v[64:79], v[112:115], v[144:147], v[64:79]
  v_mfma_f32_32x32x16_bf16 v[80:95], v[144:147], v[144:147], v[80:95]
  s_add_u32 m0, s53, 20480
  s_add_u32 s48, s52, 16896
  buffer_load_dwordx4 v124, s[4:7], s48 offen lds
  s_waitcnt lgkmcnt(2)
  v_mfma_f32_32x32x16_bf16 v[64:79], v[112:115], v[148:151], v[64:79]
  v_mfma_f32_32x32x16_bf16 v[80:95], v[148:151], v[148:151], v[80:95]
  s_add_u32 m0, s53, 21504
  s_add_u32 s48, s52, 20992
  buffer_load_dwordx4 v125, s[4:7], s48 offen lds
  s_waitcnt lgkmcnt(1)
  v_mfma_f32_32x32x16_bf16 v[64:79], v[112:115], v[152:155], v[64:79]
  v_mfma_f32_32x32x16_bf16 v[80:95], v[152:155], v[152:155], v[80:95]
  s_add_u32 m0, s53, 22528
  s_add_u32 s48, s52, 25088
  buffer_load_dwordx4 v126, s[4:7], s48 offen lds
  s_waitcnt lgkmcnt(0)
  v_mfma_f32_32x32x16_bf16 v[64:79], v[112:115], v[156:159], v[64:79]
  v_mfma_f32_32x32x16_bf16 v[80:95], v[156:159], v[156:159], v[80:95]
  s_add_u32 m0, s53, 23552
  s_add_u32 s48, s52, 29184
  buffer_load_dwordx4 v127, s[4:7], s48 offen lds
  s_waitcnt vmcnt(8)
  ds_read_b128 v[160:163], v96 offset:8192
  ds_read_b128 v[164:167], v97 offset:8192
  ds_read_b128 v[168:171], v98 offset:8192
  ds_read_b128 v[172:175], v99 offset:8192
  ds_read_b128 v[176:179], v100 offset:8192
  ds_read_b128 v[180:183], v101 offset:8192
  ds_read_b128 v[184:187], v102 offset:8192
  ds_read_b128 v[188:191], v103 offset:8192
  s_waitcnt lgkmcnt(7)
  v_mfma_f32_32x32x16_bf16 v[64:79], v[112:115], v[160:163], v[64:79]
  v_mfma_f32_32x32x16_bf16 v[80:95], v[160:163], v[160:163], v[80:95]
  s_add_u32 m0, s53, 24576
  s_add_u32 s48, s52, 768
  buffer_load_dwordx4 v124, s[4:7], s48 offen lds
  s_waitcnt lgkmcnt(6)
  v_mfma_f32_32x32x16_bf16 v[64:79], v[112:115], v[164:167], v[64:79]
  v_mfma_f32_32x32x16_bf16 v[80:95], v[164:167], v[164:167], v[80:95]
  s_add_u32 m0, s53, 25600
  s_add_u32 s48, s52, 4864
  buffer_load_dwordx4 v125, s[4:7], s48 offen lds
  s_waitcnt lgkmcnt(5)
  v_mfma_f32_32x32x16_bf16 v[64:79], v[112:115], v[168:171], v[64:79]
  v_mfma_f32_32x32x16_bf16 v[80:95], v[168:171], v[168:171], v[80:95]
  s_add_u32 m0, s53, 26624
  s_add_u32 s48, s52, 8960
  buffer_load_dwordx4 v126, s[4:7], s48 offen lds
  s_waitcnt lgkmcnt(4)
  v_mfma_f32_32x32x16_bf16 v[64:79], v[112:115], v[172:175], v[64:79]
  s_movk_i32 s50, 3072
  v_mfma_f32_32x32x16_bf16 v[80:95], v[172:175], v[172:175], v[80:95]
  s_add_u32 m0, s53, 27648
  s_add_u32 s48, s52, 13056
  buffer_load_dwordx4 v127, s[4:7], s48 offen lds
  s_waitcnt lgkmcnt(3)
  v_mfma_f32_32x32x16_bf16 v[64:79], v[112:115], v[176:179], v[64:79]
  v_mfma_f32_32x32x16_bf16 v[80:95], v[176:179], v[176:179], v[80:95]
  s_add_u32 m0, s53, 28672
  s_add_u32 s48, s52, 17152
  buffer_load_dwordx4 v124, s[4:7], s48 offen lds
  s_waitcnt lgkmcnt(2)
  v_mfma_f32_32x32x16_bf16 v[64:79], v[112:115], v[180:183], v[64:79]
  v_mfma_f32_32x32x16_bf16 v[80:95], v[180:183], v[180:183], v[80:95]
  s_add_u32 m0, s53, 29696
  s_add_u32 s48, s52, 21248
  buffer_load_dwordx4 v125, s[4:7], s48 offen lds
  s_waitcnt lgkmcnt(1)
  v_mfma_f32_32x32x16_bf16 v[64:79], v[112:115], v[184:187], v[64:79]
  v_mfma_f32_32x32x16_bf16 v[80:95], v[184:187], v[184:187], v[80:95]
  s_add_u32 m0, s53, 30720
  s_add_u32 s48, s52, 25344
  buffer_load_dwordx4 v126, s[4:7], s48 offen lds
  s_waitcnt lgkmcnt(0)
  v_mfma_f32_32x32x16_bf16 v[64:79], v[112:115], v[188:191], v[64:79]
  v_mfma_f32_32x32x16_bf16 v[80:95], v[188:191], v[188:191], v[80:95]
  s_add_u32 m0, s53, 31744
  s_add_u32 s48, s52, 29440
  buffer_load_dwordx4 v127, s[4:7], s48 offen lds
  s_waitcnt vmcnt(8)
  ds_read_b128 v[192:195], v96 offset:16384
  ds_read_b128 v[196:199], v97 offset:16384
  ds_read_b128 v[200:203], v98 offset:16384
  ds_read_b128 v[204:207], v99 offset:16384
  ds_read_b128 v[208:211], v100 offset:16384
  ds_read_b128 v[212:215], v101 offset:16384
  ds_read_b128 v[216:219], v102 offset:16384
  ds_read_b128 v[220:223], v103 offset:16384
  v_mov_b32 v124, v104
  v_mov_b32 v125, v105
  v_mov_b32 v126, v106
  v_mov_b32 v127, v107
  s_waitcnt lgkmcnt(7)
  v_mfma_f32_32x32x16_bf16 v[64:79], v[112:115], v[192:195], v[64:79]
  v_mfma_f32_32x32x16_bf16 v[80:95], v[192:195], v[192:195], v[80:95]
  v_bfe_u32 v12, v0, 2, 3
  v_and_b32 v15, 3, v0
  v_lshlrev_b32 v15, 7, v15
  v_mad_u32_u24 v15, v12, s50, v15
  s_lshl_b32 s50, s46, 1
  s_and_b32 s51, s42, 1
  s_add_u32 s50, s50, s51
  s_mul_i32 s50, s50, 24576
  s_lshr_b32 s51, s41, 3
  s_lshl_b32 s51, s51, 9
  s_add_u32 s50, s50, s51
  s_lshr_b32 s51, s42, 1
  s_add_u32 s51, s51, 1
  s_lshl_b32 s51, s51, 10
  s_add_u32 s50, s50, s51
  buffer_load_dword a253, v15, s[8:11], s50 offen
  s_add_u32 m0, s56, 131072
  s_add_u32 s48, s54, 1024
  buffer_load_dwordx4 v2, s[8:11], s48 offen lds
  s_waitcnt lgkmcnt(6)
  v_mfma_f32_32x32x16_bf16 v[64:79], v[112:115], v[196:199], v[64:79]
  v_mfma_f32_32x32x16_bf16 v[80:95], v[196:199], v[196:199], v[80:95]
  s_add_u32 m0, s56, 132096
  s_add_u32 s48, s54, 50176
  buffer_load_dwordx4 v2, s[8:11], s48 offen lds
  s_waitcnt lgkmcnt(5)
  v_mfma_f32_32x32x16_bf16 v[64:79], v[112:115], v[200:203], v[64:79]
  v_mfma_f32_32x32x16_bf16 v[80:95], v[200:203], v[200:203], v[80:95]
  s_add_u32 m0, s56, 133120
  s_add_u32 s48, s54, 99328
  buffer_load_dwordx4 v2, s[8:11], s48 offen lds
  s_waitcnt lgkmcnt(4)
  v_mfma_f32_32x32x16_bf16 v[64:79], v[112:115], v[204:207], v[64:79]
  v_mfma_f32_32x32x16_bf16 v[80:95], v[204:207], v[204:207], v[80:95]
  s_add_u32 m0, s56, 134144
  s_add_u32 s48, s54, 148480
  buffer_load_dwordx4 v2, s[8:11], s48 offen lds
  s_waitcnt lgkmcnt(3)
  v_mfma_f32_32x32x16_bf16 v[64:79], v[112:115], v[208:211], v[64:79]
  v_mfma_f32_32x32x16_bf16 v[80:95], v[208:211], v[208:211], v[80:95]
  s_add_u32 m0, s56, 135168
  s_add_u32 s48, s54, 197632
  buffer_load_dwordx4 v2, s[8:11], s48 offen lds
  s_waitcnt lgkmcnt(2)
  v_mfma_f32_32x32x16_bf16 v[64:79], v[112:115], v[212:215], v[64:79]
  v_mfma_f32_32x32x16_bf16 v[80:95], v[212:215], v[212:215], v[80:95]
  s_add_u32 m0, s56, 136192
  s_add_u32 s48, s54, 246784
  buffer_load_dwordx4 v2, s[8:11], s48 offen lds
  s_waitcnt lgkmcnt(1)
  v_mfma_f32_32x32x16_bf16 v[64:79], v[112:115], v[216:219], v[64:79]
  v_mfma_f32_32x32x16_bf16 v[80:95], v[216:219], v[216:219], v[80:95]
  s_add_u32 m0, s56, 137216
  s_add_u32 s48, s54, 295936
  buffer_load_dwordx4 v2, s[8:11], s48 offen lds
  s_waitcnt lgkmcnt(0)
  v_mfma_f32_32x32x16_bf16 v[64:79], v[112:115], v[220:223], v[64:79]
  v_mfma_f32_32x32x16_bf16 v[80:95], v[220:223], v[220:223], v[80:95]
  s_add_u32 m0, s56, 138240
  s_add_u32 s48, s54, 345088
  buffer_load_dwordx4 v2, s[8:11], s48 offen lds
  s_waitcnt vmcnt(9)
  ds_read_b128 v[224:227], v96 offset:24576
  ds_read_b128 v[228:231], v97 offset:24576
  ds_read_b128 v[232:235], v98 offset:24576
  ds_read_b128 v[236:239], v99 offset:24576
  ds_read_b128 v[240:243], v100 offset:24576
  ds_read_b128 v[244:247], v101 offset:24576
  ds_read_b128 v[248:251], v102 offset:24576
  ds_read_b128 v[252:255], v103 offset:24576
  s_waitcnt lgkmcnt(7)
  v_mfma_f32_32x32x16_bf16 v[64:79], v[112:115], v[224:227], v[64:79]
  s_lshl_b32 s50, s42, 2
  v_mfma_f32_32x32x16_bf16 v[80:95], v[224:227], v[224:227], v[80:95]
  s_lshr_b32 s51, s41, 3
  v_and_b32 v15, 3, v0
  v_add_u32 v15, s50, v15
  v_min_u32 v15, 13, v15
  v_lshlrev_b32 v15, 7, v15
  v_lshrrev_b32 v12, 2, v0
  s_movk_i32 s50, 3584
  v_mad_u32_u24 v15, v12, s50, v15
  s_mul_i32 s50, s46, 57344
  s_mul_i32 s51, s51, 1792
  s_add_u32 s50, s50, s51
  buffer_load_dword a248, v15, s[16:19], s50 offen
  s_waitcnt lgkmcnt(6)
  v_mfma_f32_32x32x16_bf16 v[64:79], v[112:115], v[228:231], v[64:79]
  v_mfma_f32_32x32x16_bf16 v[80:95], v[228:231], v[228:231], v[80:95]
  s_waitcnt lgkmcnt(5)
  v_mfma_f32_32x32x16_bf16 v[64:79], v[112:115], v[232:235], v[64:79]
  v_mfma_f32_32x32x16_bf16 v[80:95], v[232:235], v[232:235], v[80:95]
  s_waitcnt lgkmcnt(4)
  v_mfma_f32_32x32x16_bf16 v[64:79], v[112:115], v[236:239], v[64:79]
  v_mfma_f32_32x32x16_bf16 v[80:95], v[236:239], v[236:239], v[80:95]
  s_waitcnt lgkmcnt(3)
  v_mfma_f32_32x32x16_bf16 v[64:79], v[112:115], v[240:243], v[64:79]
  v_mfma_f32_32x32x16_bf16 v[80:95], v[240:243], v[240:243], v[80:95]
  s_waitcnt lgkmcnt(2)
  v_mfma_f32_32x32x16_bf16 v[64:79], v[112:115], v[244:247], v[64:79]
  v_mfma_f32_32x32x16_bf16 v[80:95], v[244:247], v[244:247], v[80:95]
  s_waitcnt lgkmcnt(1)
  v_mfma_f32_32x32x16_bf16 v[64:79], v[112:115], v[248:251], v[64:79]
  v_mfma_f32_32x32x16_bf16 v[80:95], v[248:251], v[248:251], v[80:95]
  s_waitcnt lgkmcnt(0)
  v_mfma_f32_32x32x16_bf16 v[64:79], v[112:115], v[252:255], v[64:79]
  v_mfma_f32_32x32x16_bf16 v[80:95], v[252:255], v[252:255], v[80:95]
  s_barrier
  v_mfma_f32_32x32x16_bf16 v[32:47], v[116:119], v[128:131], v[64:79]
  v_mfma_f32_32x32x16_bf16 v[32:47], v[120:123], v[132:135], v[32:47]
  v_mfma_f32_32x32x16_bf16 v[16:31], v[116:119], v[136:139], v[64:79]
  v_mfma_f32_32x32x16_bf16 v[16:31], v[120:123], v[140:143], v[16:31]
  s_nop 2
  v_mfma_f32_32x32x16_bf16 v[48:63], v[116:119], v[144:147], v[64:79]
  s_nop 5
  v_cvt_pk_bf16_f32 v128, v32, v33
  v_cvt_pk_bf16_f32 v129, v34, v35
  v_cvt_pk_bf16_f32 v130, v36, v37
  v_cvt_pk_bf16_f32 v131, v38, v39
  v_mfma_f32_32x32x16_bf16 v[48:63], v[120:123], v[148:151], v[48:63]
  v_cvt_pk_bf16_f32 v132, v40, v41
  v_cvt_pk_bf16_f32 v133, v42, v43
  v_cvt_pk_bf16_f32 v134, v44, v45
  v_cvt_pk_bf16_f32 v135, v46, v47
  v_mfma_f32_32x32x16_bf16 v[32:47], v[116:119], v[152:155], v[64:79]
  v_cvt_pk_bf16_f32 v136, v16, v17
  v_cvt_pk_bf16_f32 v137, v18, v19
  v_cvt_pk_bf16_f32 v138, v20, v21
  v_cvt_pk_bf16_f32 v139, v22, v23
  v_mfma_f32_32x32x16_bf16 v[32:47], v[120:123], v[156:159], v[32:47]
  v_cvt_pk_bf16_f32 v140, v24, v25
  v_cvt_pk_bf16_f32 v141, v26, v27
  v_cvt_pk_bf16_f32 v142, v28, v29
  v_cvt_pk_bf16_f32 v143, v30, v31
  v_cndmask_b32 v80, v80, v81, s[60:61]
  v_cndmask_b32 v82, v82, v83, s[60:61]
  v_cndmask_b32 v84, v84, v85, s[60:61]
  v_cndmask_b32 v86, v86, v87, s[60:61]
  v_cndmask_b32 v88, v88, v89, s[60:61]
  v_cndmask_b32 v90, v90, v91, s[60:61]
  v_cndmask_b32 v92, v92, v93, s[60:61]
  v_mfma_f32_32x32x16_bf16 v[16:31], v[116:119], v[160:163], v[64:79]
  v_cvt_pk_bf16_f32 v144, v48, v49
  v_cvt_pk_bf16_f32 v145, v50, v51
  v_cvt_pk_bf16_f32 v146, v52, v53
  v_cvt_pk_bf16_f32 v147, v54, v55
  v_mfma_f32_32x32x16_bf16 v[16:31], v[120:123], v[164:167], v[16:31]
  v_cvt_pk_bf16_f32 v148, v56, v57
  v_cvt_pk_bf16_f32 v149, v58, v59
  v_cvt_pk_bf16_f32 v150, v60, v61
  v_cvt_pk_bf16_f32 v151, v62, v63
  v_cndmask_b32 v94, v94, v95, s[60:61]
  v_cndmask_b32 v80, v80, v82, s[62:63]
  v_cndmask_b32 v84, v84, v86, s[62:63]
  v_cndmask_b32 v88, v88, v90, s[62:63]
  v_cndmask_b32 v92, v92, v94, s[62:63]
  v_cndmask_b32 v80, v80, v84, s[66:67]
  v_mfma_f32_32x32x16_bf16 v[48:63], v[116:119], v[168:171], v[64:79]
  v_cvt_pk_bf16_f32 v152, v32, v33
  v_cvt_pk_bf16_f32 v153, v34, v35
  v_cvt_pk_bf16_f32 v154, v36, v37
  v_cvt_pk_bf16_f32 v155, v38, v39
  v_mfma_f32_32x32x16_bf16 v[48:63], v[120:123], v[172:175], v[48:63]
  v_cvt_pk_bf16_f32 v156, v40, v41
  v_cvt_pk_bf16_f32 v157, v42, v43
  v_cvt_pk_bf16_f32 v158, v44, v45
  v_cvt_pk_bf16_f32 v159, v46, v47
  v_cndmask_b32 v88, v88, v92, s[66:67]
  v_cndmask_b32 v80, v80, v88, s[68:69]
  v_mul_f32 v82, v64, v64
  v_mov_b32 v81, v80
  v_mov_b32 v83, 0x3b000000
  s_nop 0
  v_permlane32_swap_b32 v80, v81
  v_mov_b32 v84, 0x3727c5ac
  v_mfma_f32_32x32x16_bf16 v[32:47], v[116:119], v[176:179], v[64:79]
  s_add_u32 m0, s56, 0
  v_cvt_pk_bf16_f32 v160, v16, v17
  v_cvt_pk_bf16_f32 v161, v18, v19
  v_cvt_pk_bf16_f32 v162, v20, v21
  v_cvt_pk_bf16_f32 v163, v22, v23
  v_mfma_f32_32x32x16_bf16 v[32:47], v[120:123], v[180:183], v[32:47]
  s_add_u32 s48, s54, 2048
  v_cvt_pk_bf16_f32 v164, v24, v25
  v_cvt_pk_bf16_f32 v165, v26, v27
  v_cvt_pk_bf16_f32 v166, v28, v29
  v_cvt_pk_bf16_f32 v167, v30, v31
  v_cndmask_b32 v80, v80, v81, s[64:65]
  v_fma_f32 v80, v80, v83, -v82
  v_max_f32 v80, 0, v80
  v_add_f32 v81, v80, v84
  v_rsq_f32 v9, v81
  v_mfma_f32_32x32x16_bf16 v[16:31], v[116:119], v[184:187], v[64:79]
  v_cvt_pk_bf16_f32 v168, v48, v49
  v_cvt_pk_bf16_f32 v169, v50, v51
  v_cvt_pk_bf16_f32 v170, v52, v53
  v_cvt_pk_bf16_f32 v171, v54, v55
  v_mfma_f32_32x32x16_bf16 v[16:31], v[120:123], v[188:191], v[16:31]
  v_cvt_pk_bf16_f32 v172, v56, v57
  v_cvt_pk_bf16_f32 v173, v58, v59
  v_cvt_pk_bf16_f32 v174, v60, v61
  v_cvt_pk_bf16_f32 v175, v62, v63
  v_mul_f32 v81, v9, v9
  v_fma_f32 v81, v80, v81, v84
  v_rsq_f32 v81, v81
  s_nop 0
  v_mul_f32 v81, v81, v9
  v_mul_f32 v10, 0x3eb8aa3b, v9
  v_mfma_f32_32x32x16_bf16 v[48:63], v[116:119], v[192:195], v[64:79]
  v_cvt_pk_bf16_f32 v176, v32, v33
  v_cvt_pk_bf16_f32 v177, v34, v35
  v_cvt_pk_bf16_f32 v178, v36, v37
  v_cvt_pk_bf16_f32 v179, v38, v39
  v_mfma_f32_32x32x16_bf16 v[48:63], v[120:123], v[196:199], v[48:63]
  v_cvt_pk_bf16_f32 v180, v40, v41
  v_cvt_pk_bf16_f32 v181, v42, v43
  v_cvt_pk_bf16_f32 v182, v44, v45
  v_cvt_pk_bf16_f32 v183, v46, v47
  buffer_load_dwordx4 v2, s[8:11], s48 offen lds
  v_rcp_f32 v8, v81
  s_add_u32 m0, s56, 1024
  v_mul_f32 v6, 0xc0135761, v81
  v_mul_f32 v82, v81, v81
  v_mfma_f32_32x32x16_bf16 v[32:47], v[116:119], v[200:203], v[64:79]
  s_add_u32 s48, s54, 51200
  v_cvt_pk_bf16_f32 v184, v16, v17
  v_cvt_pk_bf16_f32 v185, v18, v19
  v_cvt_pk_bf16_f32 v186, v20, v21
  v_cvt_pk_bf16_f32 v187, v22, v23
  v_mfma_f32_32x32x16_bf16 v[32:47], v[120:123], v[204:207], v[32:47]
  v_cvt_pk_bf16_f32 v188, v24, v25
  v_cvt_pk_bf16_f32 v189, v26, v27
  v_cvt_pk_bf16_f32 v190, v28, v29
  v_cvt_pk_bf16_f32 v191, v30, v31
  buffer_load_dwordx4 v2, s[8:11], s48 offen lds
  v_mul_f32 v82, v82, v81
  v_mul_f32 v7, 0xbdd2d3e8, v82
  v_mul_f32 v80, 0.5, v8
  v_cvt_pk_bf16_f32 v81, v80, v80
  v_mfma_f32_32x32x16_bf16 v[16:31], v[116:119], v[208:211], v[64:79]
  s_add_u32 m0, s56, 2048
  v_cvt_pk_bf16_f32 v192, v48, v49
  v_cvt_pk_bf16_f32 v193, v50, v51
  v_cvt_pk_bf16_f32 v194, v52, v53
  v_cvt_pk_bf16_f32 v195, v54, v55
  v_mfma_f32_32x32x16_bf16 v[16:31], v[120:123], v[212:215], v[16:31]
  s_add_u32 s48, s54, 100352
  v_cvt_pk_bf16_f32 v196, v56, v57
  v_cvt_pk_bf16_f32 v197, v58, v59
  v_cvt_pk_bf16_f32 v198, v60, v61
  v_cvt_pk_bf16_f32 v199, v62, v63
  buffer_load_dwordx4 v2, s[8:11], s48 offen lds
  v_cvt_pk_bf16_f32 v82, v9, v9
  v_and_b32 v81, 0xffff0000, v81
  v_and_b32 v82, 0xffff0000, v82
  v_mfma_f32_32x32x16_bf16 v[48:63], v[116:119], v[216:219], v[64:79]
  s_add_u32 m0, s56, 3072
  v_cvt_pk_bf16_f32 v200, v32, v33
  v_cvt_pk_bf16_f32 v201, v34, v35
  v_cvt_pk_bf16_f32 v202, v36, v37
  v_cvt_pk_bf16_f32 v203, v38, v39
  v_mfma_f32_32x32x16_bf16 v[48:63], v[120:123], v[220:223], v[48:63]
  s_add_u32 s48, s54, 149504
  v_cvt_pk_bf16_f32 v204, v40, v41
  v_cvt_pk_bf16_f32 v205, v42, v43
  v_cvt_pk_bf16_f32 v206, v44, v45
  v_cvt_pk_bf16_f32 v207, v46, v47
  buffer_load_dwordx4 v2, s[8:11], s48 offen lds
  v_sub_f32 v81, v80, v81
  v_sub_f32 v82, v9, v82
  v_cvt_pk_bf16_f32 v84, v80, v81
  v_cvt_pk_bf16_f32 v88, v9, v82
  v_mfma_f32_32x32x16_bf16 v[32:47], v[116:119], v[224:227], v[64:79]
  s_add_u32 m0, s56, 4096
  v_cvt_pk_bf16_f32 v208, v16, v17
  v_cvt_pk_bf16_f32 v209, v18, v19
  v_cvt_pk_bf16_f32 v210, v20, v21
  v_cvt_pk_bf16_f32 v211, v22, v23
  v_mfma_f32_32x32x16_bf16 v[32:47], v[120:123], v[228:231], v[32:47]
  s_add_u32 s48, s54, 198656
  v_cvt_pk_bf16_f32 v212, v24, v25
  v_cvt_pk_bf16_f32 v213, v26, v27
  v_cvt_pk_bf16_f32 v214, v28, v29
  v_cvt_pk_bf16_f32 v215, v30, v31
  buffer_load_dwordx4 v2, s[8:11], s48 offen lds
  v_mov_b32 v92, 0x3f003f00
  v_mov_b32 v85, 0
  v_mov_b32 v86, 0
  v_mfma_f32_32x32x16_bf16 v[16:31], v[116:119], v[232:235], v[64:79]
  s_add_u32 m0, s56, 5120
  v_cvt_pk_bf16_f32 v216, v48, v49
  v_cvt_pk_bf16_f32 v217, v50, v51
  v_cvt_pk_bf16_f32 v218, v52, v53
  v_cvt_pk_bf16_f32 v219, v54, v55
  v_mfma_f32_32x32x16_bf16 v[16:31], v[120:123], v[236:239], v[16:31]
  s_add_u32 s48, s54, 247808
  v_cvt_pk_bf16_f32 v220, v56, v57
  v_cvt_pk_bf16_f32 v221, v58, v59
  v_cvt_pk_bf16_f32 v222, v60, v61
  v_cvt_pk_bf16_f32 v223, v62, v63
  buffer_load_dwordx4 v2, s[8:11], s48 offen lds
  v_mov_b32 v87, 0
  v_mov_b32 v89, 0
  v_mov_b32 v90, 0
  v_mov_b32 v91, 0
  v_mfma_f32_32x32x16_bf16 v[48:63], v[116:119], v[240:243], v[64:79]
  s_add_u32 m0, s56, 6144
  v_cvt_pk_bf16_f32 v224, v32, v33
  v_cvt_pk_bf16_f32 v225, v34, v35
  v_cvt_pk_bf16_f32 v226, v36, v37
  v_cvt_pk_bf16_f32 v227, v38, v39
  v_mfma_f32_32x32x16_bf16 v[48:63], v[120:123], v[244:247], v[48:63]
  s_add_u32 s48, s54, 296960
  v_cvt_pk_bf16_f32 v228, v40, v41
  v_cvt_pk_bf16_f32 v229, v42, v43
  v_cvt_pk_bf16_f32 v230, v44, v45
  v_cvt_pk_bf16_f32 v231, v46, v47
  buffer_load_dwordx4 v2, s[8:11], s48 offen lds
  v_mov_b32 v93, 0
  v_mov_b32 v94, 0
  v_mov_b32 v95, 0
  v_mfma_f32_32x32x16_bf16 v[32:47], v[116:119], v[248:251], v[64:79]
  s_add_u32 m0, s56, 7168
  v_cvt_pk_bf16_f32 v232, v16, v17
  v_cvt_pk_bf16_f32 v233, v18, v19
  v_cvt_pk_bf16_f32 v234, v20, v21
  v_cvt_pk_bf16_f32 v235, v22, v23
  v_mfma_f32_32x32x16_bf16 v[32:47], v[120:123], v[252:255], v[32:47]
  s_add_u32 s48, s54, 346112
  v_cvt_pk_bf16_f32 v236, v24, v25
  v_cvt_pk_bf16_f32 v237, v26, v27
  v_cvt_pk_bf16_f32 v238, v28, v29
  v_cvt_pk_bf16_f32 v239, v30, v31
  buffer_load_dwordx4 v2, s[8:11], s48 offen lds
  s_waitcnt vmcnt(9)
  s_barrier
  v_add_u32 v5, 131072, v4
  ds_read_b64_tr_b16 a[216:217], v5 offset:0
  ds_read_b64_tr_b16 a[218:219], v5 offset:512
  ds_read_b64_tr_b16 a[220:221], v5 offset:1024
  ds_read_b64_tr_b16 a[222:223], v5 offset:1536
  ds_read_b64_tr_b16 a[224:225], v5 offset:2048
  ds_read_b64_tr_b16 a[226:227], v5 offset:2560
  ds_read_b64_tr_b16 a[228:229], v5 offset:3072
  ds_read_b64_tr_b16 a[230:231], v5 offset:3584
  ds_read_b64_tr_b16 a[232:233], v5 offset:4096
  ds_read_b64_tr_b16 a[234:235], v5 offset:4608
  s_waitcnt lgkmcnt(6)
  v_mfma_f32_32x32x16_bf16 v[16:31], a[216:219], v[128:131], 0
  s_add_u32 m0, s56, 32768
  ds_read_b64_tr_b16 a[236:237], v5 offset:5120
  ds_read_b64_tr_b16 a[238:239], v5 offset:5632
  v_mfma_f32_32x32x16_bf16 v[16:31], a[220:223], v[132:135], v[16:31]
  s_waitcnt lgkmcnt(4)
  ds_read_b64_tr_b16 a[240:241], v5 offset:6144
  ds_read_b64_tr_b16 a[242:243], v5 offset:6656
  v_add_u32 v11, 0, v4
  v_cvt_pk_bf16_f32 v240, v48, v49
  v_mfma_f32_32x32x16_bf16 v[16:31], a[224:227], v[136:139], v[16:31]
  s_add_u32 s48, s55, 0
  ds_read_b64_tr_b16 a[244:245], v5 offset:7168
  ds_read_b64_tr_b16 a[246:247], v5 offset:7680
  buffer_load_dwordx4 v3, s[16:19], s48 offen lds
  v_mfma_f32_32x32x16_bf16 v[16:31], a[228:231], v[140:143], v[16:31]
  s_waitcnt lgkmcnt(4)
  ds_read_b64_tr_b16 a[216:217], v5 offset:8192
  ds_read_b64_tr_b16 a[218:219], v5 offset:8704
  v_mfma_f32_32x32x16_bf16 v[16:31], a[232:235], v[144:147], v[16:31]
  s_add_u32 m0, s56, 33792
  ds_read_b64_tr_b16 a[220:221], v5 offset:9216
  ds_read_b64_tr_b16 a[222:223], v5 offset:9728
  s_add_u32 s48, s55, 57344
  buffer_load_dwordx4 v3, s[16:19], s48 offen lds
  v_mfma_f32_32x32x16_bf16 v[16:31], a[236:239], v[148:151], v[16:31]
  s_waitcnt lgkmcnt(4)
  ds_read_b64_tr_b16 a[224:225], v5 offset:10240
  ds_read_b64_tr_b16 a[226:227], v5 offset:10752
  v_cvt_pk_bf16_f32 v241, v50, v51
  v_mfma_f32_32x32x16_bf16 v[16:31], a[240:243], v[152:155], v[16:31]
  s_add_u32 m0, s56, 34816
  ds_read_b64_tr_b16 a[228:229], v5 offset:11264
  ds_read_b64_tr_b16 a[230:231], v5 offset:11776
  v_cvt_pk_bf16_f32 v242, v52, v53
  v_cvt_pk_bf16_f32 v243, v54, v55
  v_mfma_f32_32x32x16_bf16 v[16:31], a[244:247], v[156:159], v[16:31]
  s_waitcnt lgkmcnt(4)
  ds_read_b64_tr_b16 a[232:233], v5 offset:12288
  ds_read_b64_tr_b16 a[234:235], v5 offset:12800
  s_add_u32 s48, s55, 114688
  buffer_load_dwordx4 v3, s[16:19], s48 offen lds
  v_mfma_f32_32x32x16_bf16 v[16:31], a[216:219], v[160:163], v[16:31]
  s_add_u32 m0, s56, 35840
  ds_read_b64_tr_b16 a[236:237], v5 offset:13312
  ds_read_b64_tr_b16 a[238:239], v5 offset:13824
  v_mfma_f32_32x32x16_bf16 v[16:31], a[220:223], v[164:167], v[16:31]
  s_waitcnt lgkmcnt(4)
  ds_read_b64_tr_b16 a[240:241], v5 offset:14336
  ds_read_b64_tr_b16 a[242:243], v5 offset:14848
  v_cvt_pk_bf16_f32 v244, v56, v57
  v_cvt_pk_bf16_f32 v245, v58, v59
  v_mfma_f32_32x32x16_bf16 v[16:31], a[224:227], v[168:171], v[16:31]
  s_add_u32 s48, s55, 172032
  ds_read_b64_tr_b16 a[244:245], v5 offset:15360
  ds_read_b64_tr_b16 a[246:247], v5 offset:15872
  buffer_load_dwordx4 v3, s[16:19], s48 offen lds
  v_mfma_f32_32x32x16_bf16 v[16:31], a[228:231], v[172:175], v[16:31]
  s_waitcnt lgkmcnt(4)
  ds_read_b64_tr_b16 a[216:217], v5 offset:16384
  ds_read_b64_tr_b16 a[218:219], v5 offset:16896
  v_mfma_f32_32x32x16_bf16 v[16:31], a[232:235], v[176:179], v[16:31]
  s_add_u32 m0, s56, 36864
  ds_read_b64_tr_b16 a[220:221], v5 offset:17408
  ds_read_b64_tr_b16 a[222:223], v5 offset:17920
  s_add_u32 s48, s55, 229376
  buffer_load_dwordx4 v3, s[16:19], s48 offen lds
  v_mfma_f32_32x32x16_bf16 v[16:31], a[236:239], v[180:183], v[16:31]
  s_waitcnt lgkmcnt(4)
  ds_read_b64_tr_b16 a[224:225], v5 offset:18432
  ds_read_b64_tr_b16 a[226:227], v5 offset:18944
  v_cvt_pk_bf16_f32 v246, v60, v61
  v_mfma_f32_32x32x16_bf16 v[16:31], a[240:243], v[184:187], v[16:31]
  s_add_u32 m0, s56, 37888
  ds_read_b64_tr_b16 a[228:229], v5 offset:19456
  ds_read_b64_tr_b16 a[230:231], v5 offset:19968
  v_cvt_pk_bf16_f32 v247, v62, v63
  v_cvt_pk_bf16_f32 v248, v32, v33
  v_mfma_f32_32x32x16_bf16 v[16:31], a[244:247], v[188:191], v[16:31]
  s_waitcnt lgkmcnt(4)
  ds_read_b64_tr_b16 a[232:233], v5 offset:20480
  ds_read_b64_tr_b16 a[234:235], v5 offset:20992
  s_add_u32 s48, s55, 286720
  buffer_load_dwordx4 v3, s[16:19], s48 offen lds
  v_mfma_f32_32x32x16_bf16 v[16:31], a[216:219], v[192:195], v[16:31]
  s_add_u32 m0, s56, 38912
  ds_read_b64_tr_b16 a[236:237], v5 offset:21504
  ds_read_b64_tr_b16 a[238:239], v5 offset:22016
  v_mfma_f32_32x32x16_bf16 v[16:31], a[220:223], v[196:199], v[16:31]
  s_waitcnt lgkmcnt(4)
  ds_read_b64_tr_b16 a[240:241], v5 offset:22528
  ds_read_b64_tr_b16 a[242:243], v5 offset:23040
  v_cvt_pk_bf16_f32 v249, v34, v35
  v_cvt_pk_bf16_f32 v250, v36, v37
  v_mfma_f32_32x32x16_bf16 v[16:31], a[224:227], v[200:203], v[16:31]
  s_add_u32 s48, s55, 344064
  ds_read_b64_tr_b16 a[244:245], v5 offset:23552
  ds_read_b64_tr_b16 a[246:247], v5 offset:24064
  buffer_load_dwordx4 v3, s[16:19], s48 offen lds
  v_mfma_f32_32x32x16_bf16 v[16:31], a[228:231], v[204:207], v[16:31]
  s_waitcnt lgkmcnt(4)
  ds_read_b64_tr_b16 a[216:217], v5 offset:24576
  ds_read_b64_tr_b16 a[218:219], v5 offset:25088
  v_mfma_f32_32x32x16_bf16 v[16:31], a[232:235], v[208:211], v[16:31]
  s_add_u32 m0, s56, 39936
  ds_read_b64_tr_b16 a[220:221], v5 offset:25600
  ds_read_b64_tr_b16 a[222:223], v5 offset:26112
  s_add_u32 s48, s55, 401408
  buffer_load_dwordx4 v3, s[16:19], s48 offen lds
  v_mfma_f32_32x32x16_bf16 v[16:31], a[236:239], v[212:215], v[16:31]
  s_waitcnt lgkmcnt(4)
  ds_read_b64_tr_b16 a[224:225], v5 offset:26624
  ds_read_b64_tr_b16 a[226:227], v5 offset:27136
  v_cvt_pk_bf16_f32 v251, v38, v39
  v_mfma_f32_32x32x16_bf16 v[16:31], a[240:243], v[216:219], v[16:31]
  ds_read_b64_tr_b16 a[228:229], v5 offset:27648
  ds_read_b64_tr_b16 a[230:231], v5 offset:28160
  v_cvt_pk_bf16_f32 v252, v40, v41
  v_cvt_pk_bf16_f32 v253, v42, v43
  v_mfma_f32_32x32x16_bf16 v[16:31], a[244:247], v[220:223], v[16:31]
  s_waitcnt lgkmcnt(4)
  ds_read_b64_tr_b16 a[232:233], v5 offset:28672
  ds_read_b64_tr_b16 a[234:235], v5 offset:29184
  v_cvt_pk_bf16_f32 v254, v44, v45
  v_mfma_f32_32x32x16_bf16 v[16:31], a[216:219], v[224:227], v[16:31]
  ds_read_b64_tr_b16 a[236:237], v5 offset:29696
  ds_read_b64_tr_b16 a[238:239], v5 offset:30208
  v_cvt_pk_bf16_f32 v255, v46, v47
  v_mfma_f32_32x32x16_bf16 v[64:79], v[88:91], v[92:95], 0
  v_mfma_f32_32x32x16_bf16 v[16:31], a[220:223], v[228:231], v[16:31]
  s_waitcnt lgkmcnt(4)
  ds_read_b64_tr_b16 a[240:241], v5 offset:30720
  ds_read_b64_tr_b16 a[242:243], v5 offset:31232
  v_mov_b32 v121, 0
  v_mfma_f32_32x32x16_bf16 v[16:31], a[224:227], v[232:235], v[16:31]
  ds_read_b64_tr_b16 a[244:245], v5 offset:31744
  ds_read_b64_tr_b16 a[246:247], v5 offset:32256
  v_mov_b32 v122, 0
  v_mov_b32 v123, 0
  v_mfma_f32_32x32x16_bf16 v[16:31], a[228:231], v[236:239], v[16:31]
  s_waitcnt lgkmcnt(4)
  s_waitcnt vmcnt(8)
  s_barrier
  ds_read_b64_tr_b16 a[216:217], v11 offset:0
  ds_read_b64_tr_b16 a[218:219], v11 offset:512
  v_mfma_f32_32x32x16_bf16 v[16:31], a[232:235], v[240:243], v[16:31]
  ds_read_b64_tr_b16 a[220:221], v11 offset:1024
  ds_read_b64_tr_b16 a[222:223], v11 offset:1536
  v_readfirstlane_b32 s43, v13
  s_nop 0
  s_mul_i32 s43, s43, 0x41c64e6d
  s_add_u32 s43, s43, 0x3039
  v_mfma_f32_32x32x16_bf16 v[16:31], a[236:239], v[244:247], v[16:31]
  s_waitcnt lgkmcnt(4)
  ds_read_b64_tr_b16 a[224:225], v11 offset:2048
  ds_read_b64_tr_b16 a[226:227], v11 offset:2560
  v_mov_b32 v13, s43
  v_mfma_f32_32x32x16_bf16 v[16:31], a[240:243], v[248:251], v[16:31]
  s_add_u32 m0, s56, 65536
  ds_read_b64_tr_b16 a[228:229], v11 offset:3072
  ds_read_b64_tr_b16 a[230:231], v11 offset:3584
  v_mfma_f32_32x32x16_bf16 v[16:31], a[244:247], v[252:255], v[16:31]
  s_waitcnt lgkmcnt(4)
  ds_read_b64_tr_b16 a[232:233], v11 offset:4096
  ds_read_b64_tr_b16 a[234:235], v11 offset:4608
  v_mfma_f32_32x32x16_bf16 v[32:47], v[128:131], a[216:219], 0
  s_add_u32 s48, s55, 64
  ds_read_b64_tr_b16 a[236:237], v11 offset:5120
  ds_read_b64_tr_b16 a[238:239], v11 offset:5632
  v_mfma_f32_32x32x16_bf16 v[32:47], v[132:135], a[220:223], v[32:47]
  s_waitcnt lgkmcnt(4)
  ds_read_b64_tr_b16 a[240:241], v11 offset:6144
  ds_read_b64_tr_b16 a[242:243], v11 offset:6656
  buffer_load_dwordx4 v3, s[16:19], s48 offen lds
  v_mfma_f32_32x32x16_bf16 v[32:47], v[136:139], a[224:227], v[32:47]
  s_add_u32 m0, s56, 66560
  ds_read_b64_tr_b16 a[244:245], v11 offset:7168
  ds_read_b64_tr_b16 a[246:247], v11 offset:7680
  v_add_u32 v5, 32768, v4
  v_mul_f32 v16, v16, v9
  v_mfma_f32_32x32x16_bf16 v[32:47], v[140:143], a[228:231], v[32:47]
  s_waitcnt lgkmcnt(4)
  ds_read_b64_tr_b16 a[216:217], v11 offset:8192
  ds_read_b64_tr_b16 a[218:219], v11 offset:8704
  s_add_u32 s48, s55, 57408
  buffer_load_dwordx4 v3, s[16:19], s48 offen lds
  v_mfma_f32_32x32x16_bf16 v[32:47], v[144:147], a[232:235], v[32:47]
  s_add_u32 m0, s56, 67584
  ds_read_b64_tr_b16 a[220:221], v11 offset:9216
  ds_read_b64_tr_b16 a[222:223], v11 offset:9728
  v_mfma_f32_32x32x16_bf16 v[32:47], v[148:151], a[236:239], v[32:47]
  s_waitcnt lgkmcnt(4)
  ds_read_b64_tr_b16 a[224:225], v11 offset:10240
  ds_read_b64_tr_b16 a[226:227], v11 offset:10752
  v_mul_f32 v17, v17, v9
  v_mul_f32 v18, v18, v9
  v_mfma_f32_32x32x16_bf16 v[32:47], v[152:155], a[240:243], v[32:47]
  s_add_u32 s48, s55, 114752
  ds_read_b64_tr_b16 a[228:229], v11 offset:11264
  ds_read_b64_tr_b16 a[230:231], v11 offset:11776
  buffer_load_dwordx4 v3, s[16:19], s48 offen lds
  v_mfma_f32_32x32x16_bf16 v[32:47], v[156:159], a[244:247], v[32:47]
  s_waitcnt lgkmcnt(4)
  ds_read_b64_tr_b16 a[232:233], v11 offset:12288
  ds_read_b64_tr_b16 a[234:235], v11 offset:12800
  v_mfma_f32_32x32x16_bf16 v[32:47], v[160:163], a[216:219], v[32:47]
  s_add_u32 m0, s56, 68608
  ds_read_b64_tr_b16 a[236:237], v11 offset:13312
  ds_read_b64_tr_b16 a[238:239], v11 offset:13824
  v_mul_f32 v19, v19, v9
  v_cvt_pk_bf16_f32 v96, v16, v17
  v_mfma_f32_32x32x16_bf16 v[32:47], v[164:167], a[220:223], v[32:47]
  s_waitcnt lgkmcnt(4)
  ds_read_b64_tr_b16 a[240:241], v11 offset:14336
  ds_read_b64_tr_b16 a[242:243], v11 offset:14848
  s_add_u32 s48, s55, 172096
  buffer_load_dwordx4 v3, s[16:19], s48 offen lds
  v_mfma_f32_32x32x16_bf16 v[32:47], v[168:171], a[224:227], v[32:47]
  s_add_u32 m0, s56, 69632
  ds_read_b64_tr_b16 a[244:245], v11 offset:15360
  ds_read_b64_tr_b16 a[246:247], v11 offset:15872
  v_mfma_f32_32x32x16_bf16 v[32:47], v[172:175], a[228:231], v[32:47]
  s_waitcnt lgkmcnt(4)
  ds_read_b64_tr_b16 a[216:217], v11 offset:16384
  ds_read_b64_tr_b16 a[218:219], v11 offset:16896
  s_add_u32 s48, s55, 229440
  buffer_load_dwordx4 v3, s[16:19], s48 offen lds
  v_mfma_f32_32x32x16_bf16 v[32:47], v[176:179], a[232:235], v[32:47]
  s_add_u32 m0, s56, 70656
  ds_read_b64_tr_b16 a[220:221], v11 offset:17408
  ds_read_b64_tr_b16 a[222:223], v11 offset:17920
  v_cvt_pk_bf16_f32 v97, v18, v19
  v_mfma_f32_32x32x16_bf16 v[32:47], v[180:183], a[236:239], v[32:47]
  s_waitcnt lgkmcnt(4)
  ds_read_b64_tr_b16 a[224:225], v11 offset:18432
  ds_read_b64_tr_b16 a[226:227], v11 offset:18944
  v_mul_f32 v20, v20, v9
  v_mul_f32 v21, v21, v9
  v_mfma_f32_32x32x16_bf16 v[32:47], v[184:187], a[240:243], v[32:47]
  s_add_u32 s48, s55, 286784
  ds_read_b64_tr_b16 a[228:229], v11 offset:19456
  ds_read_b64_tr_b16 a[230:231], v11 offset:19968
  buffer_load_dwordx4 v3, s[16:19], s48 offen lds
  v_mfma_f32_32x32x16_bf16 v[32:47], v[188:191], a[244:247], v[32:47]
  s_waitcnt lgkmcnt(4)
  ds_read_b64_tr_b16 a[232:233], v11 offset:20480
  ds_read_b64_tr_b16 a[234:235], v11 offset:20992
  v_mfma_f32_32x32x16_bf16 v[32:47], v[192:195], a[216:219], v[32:47]
  s_add_u32 m0, s56, 71680
  ds_read_b64_tr_b16 a[236:237], v11 offset:21504
  ds_read_b64_tr_b16 a[238:239], v11 offset:22016
  v_mul_f32 v22, v22, v9
  v_mul_f32 v23, v23, v9
  v_mfma_f32_32x32x16_bf16 v[32:47], v[196:199], a[220:223], v[32:47]
  s_waitcnt lgkmcnt(4)
  ds_read_b64_tr_b16 a[240:241], v11 offset:22528
  ds_read_b64_tr_b16 a[242:243], v11 offset:23040
  s_add_u32 s48, s55, 344128
  buffer_load_dwordx4 v3, s[16:19], s48 offen lds
  v_mfma_f32_32x32x16_bf16 v[32:47], v[200:203], a[224:227], v[32:47]
  s_add_u32 m0, s56, 72704
  ds_read_b64_tr_b16 a[244:245], v11 offset:23552
  ds_read_b64_tr_b16 a[246:247], v11 offset:24064
  v_mfma_f32_32x32x16_bf16 v[32:47], v[204:207], a[228:231], v[32:47]
  s_waitcnt lgkmcnt(4)
  ds_read_b64_tr_b16 a[216:217], v11 offset:24576
  ds_read_b64_tr_b16 a[218:219], v11 offset:25088
  s_add_u32 s48, s55, 401472
  buffer_load_dwordx4 v3, s[16:19], s48 offen lds
  v_mfma_f32_32x32x16_bf16 v[32:47], v[208:211], a[232:235], v[32:47]
  ds_read_b64_tr_b16 a[220:221], v11 offset:25600
  ds_read_b64_tr_b16 a[222:223], v11 offset:26112
  v_cvt_pk_bf16_f32 v98, v20, v21
  v_mfma_f32_32x32x16_bf16 v[32:47], v[212:215], a[236:239], v[32:47]
  s_waitcnt lgkmcnt(4)
  ds_read_b64_tr_b16 a[224:225], v11 offset:26624
  ds_read_b64_tr_b16 a[226:227], v11 offset:27136
  v_cvt_pk_bf16_f32 v99, v22, v23
  v_mfma_f32_32x32x16_bf16 v[32:47], v[216:219], a[240:243], v[32:47]
  ds_read_b64_tr_b16 a[228:229], v11 offset:27648
  ds_read_b64_tr_b16 a[230:231], v11 offset:28160
  v_mul_f32 v24, v24, v9
  v_mul_f32 v25, v25, v9
  v_mfma_f32_32x32x16_bf16 v[32:47], v[220:223], a[244:247], v[32:47]
  s_waitcnt lgkmcnt(4)
  ds_read_b64_tr_b16 a[232:233], v11 offset:28672
  ds_read_b64_tr_b16 a[234:235], v11 offset:29184
  v_mul_f32 v26, v26, v9
  v_mul_f32 v27, v27, v9
  v_mfma_f32_32x32x16_bf16 v[32:47], v[224:227], a[216:219], v[32:47]
  s_add_u32 m0, s56, 98304
  ds_read_b64_tr_b16 a[236:237], v11 offset:29696
  ds_read_b64_tr_b16 a[238:239], v11 offset:30208
  buffer_store_dwordx4 v[96:99], v1, s[28:31], s57 offen offset:0 sc1
  v_mfma_f32_32x32x16_bf16 v[32:47], v[228:231], a[220:223], v[32:47]
  s_waitcnt lgkmcnt(4)
  ds_read_b64_tr_b16 a[240:241], v11 offset:30720
  ds_read_b64_tr_b16 a[242:243], v11 offset:31232
  v_cvt_pk_bf16_f32 v100, v24, v25
  v_cvt_pk_bf16_f32 v101, v26, v27
  v_mfma_f32_32x32x16_bf16 v[32:47], v[232:235], a[224:227], v[32:47]
  s_add_u32 s48, s55, 128
  ds_read_b64_tr_b16 a[244:245], v11 offset:31744
  ds_read_b64_tr_b16 a[246:247], v11 offset:32256
  v_mul_f32 v28, v28, v9
  v_mul_f32 v29, v29, v9
  v_mfma_f32_32x32x16_bf16 v[32:47], v[236:239], a[228:231], v[32:47]
  s_waitcnt lgkmcnt(4)
  s_waitcnt vmcnt(9)
  s_barrier
  ds_read_b64_tr_b16 a[216:217], v5 offset:0
  ds_read_b64_tr_b16 a[218:219], v5 offset:512
  v_mul_f32 v30, v30, v9
  v_mul_f32 v31, v31, v9
  v_mfma_f32_32x32x16_bf16 v[32:47], v[240:243], a[232:235], v[32:47]
  ds_read_b64_tr_b16 a[220:221], v5 offset:1024
  ds_read_b64_tr_b16 a[222:223], v5 offset:1536
  v_cvt_pk_bf16_f32 v102, v28, v29
  v_mfma_f32_32x32x16_bf16 v[32:47], v[244:247], a[236:239], v[32:47]
  s_waitcnt lgkmcnt(4)
  ds_read_b64_tr_b16 a[224:225], v5 offset:2048
  ds_read_b64_tr_b16 a[226:227], v5 offset:2560
  v_cvt_pk_bf16_f32 v103, v30, v31
  v_lshl_or_b32 v120, v124, 16, v124
  v_mfma_f32_32x32x16_bf16 v[32:47], v[248:251], a[240:243], v[32:47]
  ds_read_b64_tr_b16 a[228:229], v5 offset:3072
  ds_read_b64_tr_b16 a[230:231], v5 offset:3584
  buffer_store_dwordx4 v[100:103], v1, s[28:31], s57 offen offset:1024 sc1
  v_mfma_f32_32x32x16_bf16 v[32:47], v[252:255], a[244:247], v[32:47]
  s_waitcnt lgkmcnt(4)
  ds_read_b64_tr_b16 a[232:233], v5 offset:4096
  ds_read_b64_tr_b16 a[234:235], v5 offset:4608
  v_mfma_f32_32x32x16_bf16 v[16:31], v[120:123], v[84:87], 0
  v_mfma_f32_32x32x16_bf16 v[16:31], a[216:219], v[128:131], v[16:31]
  ds_read_b64_tr_b16 a[236:237], v5 offset:5120
  ds_read_b64_tr_b16 a[238:239], v5 offset:5632
  v_mfma_f32_32x32x16_bf16 v[16:31], a[220:223], v[132:135], v[16:31]
  s_waitcnt lgkmcnt(4)
  ds_read_b64_tr_b16 a[240:241], v5 offset:6144
  ds_read_b64_tr_b16 a[242:243], v5 offset:6656
  buffer_load_dwordx4 v3, s[16:19], s48 offen lds
  v_mfma_f32_32x32x16_bf16 v[16:31], a[224:227], v[136:139], v[16:31]
  s_add_u32 m0, s56, 99328
  ds_read_b64_tr_b16 a[244:245], v5 offset:7168
  ds_read_b64_tr_b16 a[246:247], v5 offset:7680
  v_add_u32 v11, 65536, v4
  v_mul_f32 v32, v32, v64
  v_mul_f32 v33, v33, v65
  s_cmp_eq_u32 s47, 1
  s_cbranch_scc1 L_var1
  v_mfma_f32_32x32x16_bf16 v[16:31], a[228:231], v[140:143], v[16:31]
  s_waitcnt lgkmcnt(4)
  ds_read_b64_tr_b16 a[216:217], v5 offset:8192
  ds_read_b64_tr_b16 a[218:219], v5 offset:8704
  s_add_u32 s48, s55, 57472
  buffer_load_dwordx4 v3, s[16:19], s48 offen lds
  v_mfma_f32_32x32x16_bf16 v[16:31], a[232:235], v[144:147], v[16:31]
  s_add_u32 m0, s56, 100352
  ds_read_b64_tr_b16 a[220:221], v5 offset:9216
  ds_read_b64_tr_b16 a[222:223], v5 offset:9728
  v_mul_f32 v34, v34, v66
  v_mul_f32 v35, v35, v67
  v_cvt_pk_bf16_f32 v104, v32, v33
  v_mfma_f32_32x32x16_bf16 v[16:31], a[236:239], v[148:151], v[16:31]
  s_waitcnt lgkmcnt(4)
  ds_read_b64_tr_b16 a[224:225], v5 offset:10240
  ds_read_b64_tr_b16 a[226:227], v5 offset:10752
  v_cvt_pk_bf16_f32 v105, v34, v35
  v_mul_f32 v36, v36, v68
  v_mfma_f32_32x32x16_bf16 v[16:31], a[240:243], v[152:155], v[16:31]
  s_add_u32 s48, s55, 114816
  ds_read_b64_tr_b16 a[228:229], v5 offset:11264
  ds_read_b64_tr_b16 a[230:231], v5 offset:11776
  buffer_load_dwordx4 v3, s[16:19], s48 offen lds
  v_mfma_f32_32x32x16_bf16 v[16:31], a[244:247], v[156:159], v[16:31]
  s_waitcnt lgkmcnt(4)
  ds_read_b64_tr_b16 a[232:233], v5 offset:12288
  ds_read_b64_tr_b16 a[234:235], v5 offset:12800
  v_mul_f32 v37, v37, v69
  v_mul_f32 v38, v38, v70
  v_mul_f32 v39, v39, v71
  v_mfma_f32_32x32x16_bf16 v[16:31], a[216:219], v[160:163], v[16:31]
  s_add_u32 m0, s56, 101376
  ds_read_b64_tr_b16 a[236:237], v5 offset:13312
  ds_read_b64_tr_b16 a[238:239], v5 offset:13824
  v_cvt_pk_bf16_f32 v106, v36, v37
  v_cvt_pk_bf16_f32 v107, v38, v39
  v_mul_f32 v40, v40, v72
  v_mfma_f32_32x32x16_bf16 v[16:31], a[220:223], v[164:167], v[16:31]
  s_waitcnt lgkmcnt(4)
  ds_read_b64_tr_b16 a[240:241], v5 offset:14336
  ds_read_b64_tr_b16 a[242:243], v5 offset:14848
  s_add_u32 s48, s55, 172160
  buffer_load_dwordx4 v3, s[16:19], s48 offen lds
  v_mfma_f32_32x32x16_bf16 v[16:31], a[224:227], v[168:171], v[16:31]
  s_add_u32 m0, s56, 102400
  ds_read_b64_tr_b16 a[244:245], v5 offset:15360
  ds_read_b64_tr_b16 a[246:247], v5 offset:15872
  v_mul_f32 v41, v41, v73
  v_mul_f32 v42, v42, v74
  v_mul_f32 v43, v43, v75
  v_mfma_f32_32x32x16_bf16 v[16:31], a[228:231], v[172:175], v[16:31]
  s_waitcnt lgkmcnt(4)
  ds_read_b64_tr_b16 a[216:217], v5 offset:16384
  ds_read_b64_tr_b16 a[218:219], v5 offset:16896
  s_add_u32 s48, s55, 229504
  buffer_load_dwordx4 v3, s[16:19], s48 offen lds
  v_mfma_f32_32x32x16_bf16 v[16:31], a[232:235], v[176:179], v[16:31]
  s_add_u32 m0, s56, 103424
  ds_read_b64_tr_b16 a[220:221], v5 offset:17408
  ds_read_b64_tr_b16 a[222:223], v5 offset:17920
  v_cvt_pk_bf16_f32 v108, v40, v41
  v_cvt_pk_bf16_f32 v109, v42, v43
  v_mfma_f32_32x32x16_bf16 v[16:31], a[236:239], v[180:183], v[16:31]
  s_waitcnt lgkmcnt(4)
  ds_read_b64_tr_b16 a[224:225], v5 offset:18432
  ds_read_b64_tr_b16 a[226:227], v5 offset:18944
  v_mul_f32 v44, v44, v76
  v_mul_f32 v45, v45, v77
  v_mul_f32 v46, v46, v78
  v_mfma_f32_32x32x16_bf16 v[16:31], a[240:243], v[184:187], v[16:31]
  s_add_u32 s48, s55, 286848
  ds_read_b64_tr_b16 a[228:229], v5 offset:19456
  ds_read_b64_tr_b16 a[230:231], v5 offset:19968
  buffer_load_dwordx4 v3, s[16:19], s48 offen lds
  v_mfma_f32_32x32x16_bf16 v[16:31], a[244:247], v[188:191], v[16:31]
  s_waitcnt lgkmcnt(4)
  ds_read_b64_tr_b16 a[232:233], v5 offset:20480
  ds_read_b64_tr_b16 a[234:235], v5 offset:20992
  v_mul_f32 v47, v47, v79
  v_cvt_pk_bf16_f32 v110, v44, v45
  v_cvt_pk_bf16_f32 v111, v46, v47
  v_mfma_f32_32x32x16_bf16 v[16:31], a[216:219], v[192:195], v[16:31]
  s_add_u32 m0, s56, 104448
  ds_read_b64_tr_b16 a[236:237], v5 offset:21504
  ds_read_b64_tr_b16 a[238:239], v5 offset:22016
  v_lshl_or_b32 v120, v125, 16, v125
  v_mfma_f32_32x32x16_bf16 v[16:31], a[220:223], v[196:199], v[16:31]
  s_waitcnt lgkmcnt(4)
  ds_read_b64_tr_b16 a[240:241], v5 offset:22528
  ds_read_b64_tr_b16 a[242:243], v5 offset:23040
  s_add_u32 s48, s55, 344192
  buffer_load_dwordx4 v3, s[16:19], s48 offen lds
  v_mfma_f32_32x32x16_bf16 v[16:31], a[224:227], v[200:203], v[16:31]
  s_mov_b32 s50, 0xffff
  ds_read_b64_tr_b16 a[244:245], v5 offset:23552
  ds_read_b64_tr_b16 a[246:247], v5 offset:24064
  v_cndmask_b32 v88, 0, -1, s[70:71]
  v_cndmask_b32 v15, 0, -1, s[72:73]
  v_bfi_b32 v88, s50, v88, v15
  v_mfma_f32_32x32x16_bf16 v[16:31], a[228:231], v[204:207], v[16:31]
  s_waitcnt lgkmcnt(4)
  ds_read_b64_tr_b16 a[216:217], v5 offset:24576
  ds_read_b64_tr_b16 a[218:219], v5 offset:25088
  s_add_u32 m0, s56, 105472
  s_add_u32 s48, s55, 401536
  buffer_load_dwordx4 v3, s[16:19], s48 offen lds
  v_mfma_f32_32x32x16_bf16 v[16:31], a[232:235], v[208:211], v[16:31]
  s_mov_b32 s50, 0xffff
  ds_read_b64_tr_b16 a[220:221], v5 offset:25600
  ds_read_b64_tr_b16 a[222:223], v5 offset:26112
  v_cndmask_b32 v89, 0, -1, s[74:75]
  v_cndmask_b32 v15, 0, -1, s[76:77]
  v_bfi_b32 v89, s50, v89, v15
  v_mfma_f32_32x32x16_bf16 v[16:31], a[236:239], v[212:215], v[16:31]
  s_waitcnt lgkmcnt(4)
  ds_read_b64_tr_b16 a[224:225], v5 offset:26624
  ds_read_b64_tr_b16 a[226:227], v5 offset:27136
  v_cndmask_b32 v90, 0, -1, s[78:79]
  v_cndmask_b32 v15, 0, -1, s[80:81]
  s_mov_b32 s50, 0xffff
  v_bfi_b32 v90, s50, v90, v15
  v_mfma_f32_32x32x16_bf16 v[16:31], a[240:243], v[216:219], v[16:31]
  s_mov_b32 s50, 0xffff
  ds_read_b64_tr_b16 a[228:229], v5 offset:27648
  ds_read_b64_tr_b16 a[230:231], v5 offset:28160
  v_mfma_f32_32x32x16_bf16 v[16:31], a[244:247], v[220:223], v[16:31]
  s_waitcnt lgkmcnt(4)
  ds_read_b64_tr_b16 a[232:233], v5 offset:28672
  ds_read_b64_tr_b16 a[234:235], v5 offset:29184
  v_cndmask_b32 v91, 0, -1, s[82:83]
  v_cndmask_b32 v15, 0, -1, s[84:85]
  v_bfi_b32 v91, s50, v91, v15
  v_mfma_f32_32x32x16_bf16 v[16:31], a[216:219], v[224:227], v[16:31]
  s_mov_b32 s50, 0xffff
  ds_read_b64_tr_b16 a[236:237], v5 offset:29696
  ds_read_b64_tr_b16 a[238:239], v5 offset:30208
  buffer_store_dwordx4 v[104:107], v1, s[28:31], s57 offen offset:2048 sc1
  v_mfma_f32_32x32x16_bf16 v[16:31], a[220:223], v[228:231], v[16:31]
  s_waitcnt lgkmcnt(4)
  ds_read_b64_tr_b16 a[240:241], v5 offset:30720
  ds_read_b64_tr_b16 a[242:243], v5 offset:31232
  v_cndmask_b32 v92, 0, -1, s[86:87]
  v_cndmask_b32 v15, 0, -1, s[88:89]
  v_bfi_b32 v92, s50, v92, v15
  v_mfma_f32_32x32x16_bf16 v[16:31], a[224:227], v[232:235], v[16:31]
  s_mov_b32 s50, 0xffff
  ds_read_b64_tr_b16 a[244:245], v5 offset:31744
  ds_read_b64_tr_b16 a[246:247], v5 offset:32256
  v_cndmask_b32 v93, 0, -1, s[90:91]
  v_cndmask_b32 v15, 0, -1, s[92:93]
  v_bfi_b32 v93, s50, v93, v15
  v_mfma_f32_32x32x16_bf16 v[16:31], a[228:231], v[236:239], v[16:31]
  s_waitcnt lgkmcnt(4)
  s_waitcnt vmcnt(11)
  s_barrier
  ds_read_b64_tr_b16 a[216:217], v11 offset:0
  ds_read_b64_tr_b16 a[218:219], v11 offset:512
  v_cndmask_b32 v94, 0, -1, s[94:95]
  v_cndmask_b32 v15, 0, -1, s[96:97]
  s_mov_b32 s50, 0xffff
  v_bfi_b32 v94, s50, v94, v15
  v_mfma_f32_32x32x16_bf16 v[16:31], a[232:235], v[240:243], v[16:31]
  s_mov_b32 s50, 0xffff
  ds_read_b64_tr_b16 a[220:221], v11 offset:1024
  ds_read_b64_tr_b16 a[222:223], v11 offset:1536
  v_mfma_f32_32x32x16_bf16 v[16:31], a[236:239], v[244:247], v[16:31]
  s_waitcnt lgkmcnt(4)
  ds_read_b64_tr_b16 a[224:225], v11 offset:2048
  ds_read_b64_tr_b16 a[226:227], v11 offset:2560
  v_cndmask_b32 v95, 0, -1, s[98:99]
  v_cndmask_b32 v15, 0, -1, s[100:101]
  v_bfi_b32 v95, s50, v95, v15
  v_mfma_f32_32x32x16_bf16 v[16:31], a[240:243], v[248:251], v[16:31]
  s_add_u32 m0, s56, 0
  ds_read_b64_tr_b16 a[228:229], v11 offset:3072
  ds_read_b64_tr_b16 a[230:231], v11 offset:3584
  buffer_store_dwordx4 v[108:111], v1, s[28:31], s57 offen offset:3072 sc1
  v_mfma_f32_32x32x16_bf16 v[16:31], a[244:247], v[252:255], v[16:31]
  s_waitcnt lgkmcnt(4)
  ds_read_b64_tr_b16 a[232:233], v11 offset:4096
  ds_read_b64_tr_b16 a[234:235], v11 offset:4608
  v_mfma_f32_32x32x16_bf16 v[32:47], v[120:123], v[84:87], 0
  s_add_u32 s48, s55, 192
  v_mfma_f32_32x32x16_bf16 v[32:47], a[216:219], v[128:131], v[32:47]
  ds_read_b64_tr_b16 a[236:237], v11 offset:5120
  ds_read_b64_tr_b16 a[238:239], v11 offset:5632
  buffer_load_dwordx4 v3, s[16:19], s48 offen lds
  v_mfma_f32_32x32x16_bf16 v[32:47], a[220:223], v[132:135], v[32:47]
  s_waitcnt lgkmcnt(4)
  ds_read_b64_tr_b16 a[240:241], v11 offset:6144
  ds_read_b64_tr_b16 a[242:243], v11 offset:6656
  v_mfma_f32_32x32x16_bf16 v[32:47], a[224:227], v[136:139], v[32:47]
  s_add_u32 m0, s56, 1024
  ds_read_b64_tr_b16 a[244:245], v11 offset:7168
  ds_read_b64_tr_b16 a[246:247], v11 offset:7680
  s_add_u32 s48, s55, 57536
  buffer_load_dwordx4 v3, s[16:19], s48 offen lds
  v_add_u32 v5, 98304, v4
  v_mul_f32 v80, v16, v16
  v_mul_f32 v81, v17, v17
  v_mul_f32 v82, v18, v18
  v_mfma_f32_32x32x16_bf16 v[32:47], a[228:231], v[140:143], v[32:47]
  s_waitcnt lgkmcnt(4)
  ds_read_b64_tr_b16 a[216:217], v11 offset:8192
  ds_read_b64_tr_b16 a[218:219], v11 offset:8704
  v_mul_f32 v83, v19, v19
  v_fma_f32 v80, v80, v7, v6
  v_fma_f32 v81, v81, v7, v6
  v_fma_f32 v82, v82, v7, v6
  v_fma_f32 v83, v83, v7, v6
  v_mul_f32 v80, v16, v80
  v_mul_f32 v81, v17, v81
  v_mul_f32 v82, v18, v82
  v_mfma_f32_32x32x16_bf16 v[32:47], a[232:235], v[144:147], v[32:47]
  s_add_u32 m0, s56, 2048
  ds_read_b64_tr_b16 a[220:221], v11 offset:9216
  ds_read_b64_tr_b16 a[222:223], v11 offset:9728
  v_mul_f32 v83, v19, v83
  v_exp_f32 v80, v80
  s_add_u32 s48, s55, 114880
  v_exp_f32 v81, v81
  v_exp_f32 v82, v82
  v_mfma_f32_32x32x16_bf16 v[32:47], a[236:239], v[148:151], v[32:47]
  s_waitcnt lgkmcnt(4)
  ds_read_b64_tr_b16 a[224:225], v11 offset:10240
  ds_read_b64_tr_b16 a[226:227], v11 offset:10752
  buffer_load_dwordx4 v3, s[16:19], s48 offen lds
  v_exp_f32 v83, v83
  s_add_u32 m0, s56, 3072
  v_fma_f32 v80, v80, v8, v8
  v_fma_f32 v81, v81, v8, v8
  v_fma_f32 v82, v82, v8, v8
  v_mfma_f32_32x32x16_bf16 v[32:47], a[240:243], v[152:155], v[32:47]
  s_add_u32 s48, s55, 172224
  ds_read_b64_tr_b16 a[228:229], v11 offset:11264
  ds_read_b64_tr_b16 a[230:231], v11 offset:11776
  v_fma_f32 v83, v83, v8, v8
  v_rcp_f32 v80, v80
  v_rcp_f32 v81, v81
  v_rcp_f32 v82, v82
  v_mfma_f32_32x32x16_bf16 v[32:47], a[244:247], v[156:159], v[32:47]
  s_waitcnt lgkmcnt(4)
  ds_read_b64_tr_b16 a[232:233], v11 offset:12288
  ds_read_b64_tr_b16 a[234:235], v11 offset:12800
  v_rcp_f32 v83, v83
  v_mul_f32 v80, v16, v80
  v_mul_f32 v81, v17, v81
  v_mul_f32 v82, v18, v82
  v_mul_f32 v83, v19, v83
  v_cvt_pk_bf16_f32 v96, v80, v81
  v_cvt_pk_bf16_f32 v97, v82, v83
  v_mfma_f32_32x32x16_bf16 v[32:47], a[216:219], v[160:163], v[32:47]
  ds_read_b64_tr_b16 a[236:237], v11 offset:13312
  ds_read_b64_tr_b16 a[238:239], v11 offset:13824
  buffer_load_dwordx4 v3, s[16:19], s48 offen lds
  v_mul_f32 v80, v20, v20
  v_mul_f32 v81, v21, v21
  v_mul_f32 v82, v22, v22
  v_mul_f32 v83, v23, v23
  v_mfma_f32_32x32x16_bf16 v[32:47], a[220:223], v[164:167], v[32:47]
  s_waitcnt lgkmcnt(4)
  ds_read_b64_tr_b16 a[240:241], v11 offset:14336
  ds_read_b64_tr_b16 a[242:243], v11 offset:14848
  v_fma_f32 v80, v80, v7, v6
  v_fma_f32 v81, v81, v7, v6
  v_fma_f32 v82, v82, v7, v6
  v_fma_f32 v83, v83, v7, v6
  v_mul_f32 v80, v20, v80
  v_mul_f32 v81, v21, v81
  v_mul_f32 v82, v22, v82
  v_mul_f32 v83, v23, v83
  v_mfma_f32_32x32x16_bf16 v[32:47], a[224:227], v[168:171], v[32:47]
  s_add_u32 m0, s56, 4096
  ds_read_b64_tr_b16 a[244:245], v11 offset:15360
  ds_read_b64_tr_b16 a[246:247], v11 offset:15872
  s_add_u32 s48, s55, 229568
  buffer_load_dwordx4 v3, s[16:19], s48 offen lds
  v_exp_f32 v80, v80
  s_add_u32 m0, s56, 5120
  v_exp_f32 v81, v81
  s_add_u32 s48, s55, 286912
  v_mfma_f32_32x32x16_bf16 v[32:47], a[228:231], v[172:175], v[32:47]
  s_waitcnt lgkmcnt(4)
  ds_read_b64_tr_b16 a[216:217], v11 offset:16384
  ds_read_b64_tr_b16 a[218:219], v11 offset:16896
  v_exp_f32 v82, v82
  v_exp_f32 v83, v83
  v_fma_f32 v80, v80, v8, v8
  v_fma_f32 v81, v81, v8, v8
  v_fma_f32 v82, v82, v8, v8
  v_fma_f32 v83, v83, v8, v8
  v_mfma_f32_32x32x16_bf16 v[32:47], a[232:235], v[176:179], v[32:47]
  ds_read_b64_tr_b16 a[220:221], v11 offset:17408
  ds_read_b64_tr_b16 a[222:223], v11 offset:17920
  v_rcp_f32 v80, v80
  v_rcp_f32 v81, v81
  v_rcp_f32 v82, v82
  v_rcp_f32 v83, v83
  v_mfma_f32_32x32x16_bf16 v[32:47], a[236:239], v[180:183], v[32:47]
  s_waitcnt lgkmcnt(4)
  ds_read_b64_tr_b16 a[224:225], v11 offset:18432
  ds_read_b64_tr_b16 a[226:227], v11 offset:18944
  buffer_load_dwordx4 v3, s[16:19], s48 offen lds
  v_mul_f32 v80, v20, v80
  v_mul_f32 v81, v21, v81
  v_mul_f32 v82, v22, v82
  v_mul_f32 v83, v23, v83
  v_mfma_f32_32x32x16_bf16 v[32:47], a[240:243], v[184:187], v[32:47]
  s_add_u32 m0, s56, 6144
  ds_read_b64_tr_b16 a[228:229], v11 offset:19456
  ds_read_b64_tr_b16 a[230:231], v11 offset:19968
  v_cvt_pk_bf16_f32 v98, v80, v81
  v_cvt_pk_bf16_f32 v99, v82, v83
  v_mul_f32 v80, v24, v24
  v_mul_f32 v81, v25, v25
  v_mul_f32 v82, v26, v26
  v_mul_f32 v83, v27, v27
  v_fma_f32 v80, v80, v7, v6
  v_mfma_f32_32x32x16_bf16 v[32:47], a[244:247], v[188:191], v[32:47]
  s_waitcnt lgkmcnt(4)
  ds_read_b64_tr_b16 a[232:233], v11 offset:20480
  ds_read_b64_tr_b16 a[234:235], v11 offset:20992
  v_fma_f32 v81, v81, v7, v6
  v_fma_f32 v82, v82, v7, v6
  v_fma_f32 v83, v83, v7, v6
  v_mul_f32 v80, v24, v80
  v_mul_f32 v81, v25, v81
  v_mul_f32 v82, v26, v82
  v_mul_f32 v83, v27, v83
  v_mfma_f32_32x32x16_bf16 v[32:47], a[216:219], v[192:195], v[32:47]
  s_add_u32 s48, s55, 344256
  ds_read_b64_tr_b16 a[236:237], v11 offset:21504
  ds_read_b64_tr_b16 a[238:239], v11 offset:22016
  buffer_load_dwordx4 v3, s[16:19], s48 offen lds
  v_exp_f32 v80, v80
  s_add_u32 m0, s56, 7168
  v_exp_f32 v81, v81
  s_add_u32 s48, s55, 401600
  v_mfma_f32_32x32x16_bf16 v[32:47], a[220:223], v[196:199], v[32:47]
  s_waitcnt lgkmcnt(4)
  ds_read_b64_tr_b16 a[240:241], v11 offset:22528
  ds_read_b64_tr_b16 a[242:243], v11 offset:23040
  v_exp_f32 v82, v82
  v_exp_f32 v83, v83
  s_movk_i32 s50, 3072
  v_fma_f32 v80, v80, v8, v8
  v_fma_f32 v81, v81, v8, v8
  v_fma_f32 v82, v82, v8, v8
  v_fma_f32 v83, v83, v8, v8
  v_mfma_f32_32x32x16_bf16 v[32:47], a[224:227], v[200:203], v[32:47]
  ds_read_b64_tr_b16 a[244:245], v11 offset:23552
  ds_read_b64_tr_b16 a[246:247], v11 offset:24064
  buffer_load_dwordx4 v3, s[16:19], s48 offen lds
  v_rcp_f32 v80, v80
  v_rcp_f32 v81, v81
  v_mfma_f32_32x32x16_bf16 v[32:47], a[228:231], v[204:207], v[32:47]
  s_waitcnt lgkmcnt(4)
  ds_read_b64_tr_b16 a[216:217], v11 offset:24576
  ds_read_b64_tr_b16 a[218:219], v11 offset:25088
  v_rcp_f32 v82, v82
  v_rcp_f32 v83, v83
  v_mul_f32 v80, v24, v80
  v_mul_f32 v81, v25, v81
  v_mul_f32 v82, v26, v82
  v_mul_f32 v83, v27, v83
  v_mfma_f32_32x32x16_bf16 v[32:47], a[232:235], v[208:211], v[32:47]
  ds_read_b64_tr_b16 a[220:221], v11 offset:25600
  ds_read_b64_tr_b16 a[222:223], v11 offset:26112
  v_cvt_pk_bf16_f32 v100, v80, v81
  v_cvt_pk_bf16_f32 v101, v82, v83
  v_mul_f32 v80, v28, v28
  v_mul_f32 v81, v29, v29
  v_mul_f32 v82, v30, v30
  v_mul_f32 v83, v31, v31
  v_fma_f32 v80, v80, v7, v6
  v_fma_f32 v81, v81, v7, v6
  v_mfma_f32_32x32x16_bf16 v[32:47], a[236:239], v[212:215], v[32:47]
  s_waitcnt lgkmcnt(4)
  ds_read_b64_tr_b16 a[224:225], v11 offset:26624
  ds_read_b64_tr_b16 a[226:227], v11 offset:27136
  v_fma_f32 v82, v82, v7, v6
  v_fma_f32 v83, v83, v7, v6
  v_mul_f32 v80, v28, v80
  v_mul_f32 v81, v29, v81
  v_mul_f32 v82, v30, v82
  v_mul_f32 v83, v31, v83
  v_exp_f32 v80, v80
  v_mfma_f32_32x32x16_bf16 v[32:47], a[240:243], v[216:219], v[32:47]
  ds_read_b64_tr_b16 a[228:229], v11 offset:27648
  ds_read_b64_tr_b16 a[230:231], v11 offset:28160
  v_bfe_u32 v12, v0, 2, 2
  v_and_b32 v15, 3, v0
  v_lshlrev_b32 v15, 7, v15
  v_mad_u32_u24 v15, v12, s50, v15
  s_lshl_b32 s50, s46, 2
  s_add_u32 s50, s50, s42
  s_mul_i32 s50, s50, 12288
  s_lshr_b32 s51, s41, 3
  s_lshl_b32 s51, s51, 9
  s_add_u32 s50, s50, s51
  buffer_load_dword a252, v15, s[8:11], s50 offen
  v_mfma_f32_32x32x16_bf16 v[32:47], a[244:247], v[220:223], v[32:47]
  s_waitcnt lgkmcnt(4)
  ds_read_b64_tr_b16 a[232:233], v11 offset:28672
  ds_read_b64_tr_b16 a[234:235], v11 offset:29184
  v_and_b32 v15, 15, v0
  v_lshlrev_b32 v15, 7, v15
  s_lshl_b32 s50, s2, 2
  s_add_u32 s50, s50, s42
  s_lshl_b32 s50, s50, 11
  buffer_load_dword a251, v15, s[20:23], s50 offen
  v_mfma_f32_32x32x16_bf16 v[32:47], a[216:219], v[224:227], v[32:47]
  s_lshl_b32 s50, s2, 2
  ds_read_b64_tr_b16 a[236:237], v11 offset:29696
  ds_read_b64_tr_b16 a[238:239], v11 offset:30208
  v_and_b32 v15, 3, v0
  v_lshlrev_b32 v15, 7, v15
  s_add_u32 s50, s50, s42
  s_lshl_b32 s50, s50, 9
  buffer_load_dword a250, v15, s[12:15], s50 offen
  s_add_u32 s49, s58, 0
  buffer_store_dwordx4 v[96:99], v1, s[28:31], s49 offen offset:0 sc1
  v_mfma_f32_32x32x16_bf16 v[32:47], a[220:223], v[228:231], v[32:47]
  s_waitcnt lgkmcnt(4)
  ds_read_b64_tr_b16 a[240:241], v11 offset:30720
  ds_read_b64_tr_b16 a[242:243], v11 offset:31232
  v_exp_f32 v81, v81
  s_lshl_b32 s49, s41, 8
  v_exp_f32 v82, v82
  s_lshl_b32 s50, s44, 2
  v_mfma_f32_32x32x16_bf16 v[32:47], a[224:227], v[232:235], v[32:47]
  s_add_u32 s49, s49, s50
  ds_read_b64_tr_b16 a[244:245], v11 offset:31744
  ds_read_b64_tr_b16 a[246:247], v11 offset:32256
  s_waitcnt vmcnt(12)
  s_add_u32 s49, s49, 4096
  s_mov_b64 exec, 1
  buffer_store_dword v13, off, s[28:31], s49 sc0 sc1
  s_mov_b64 exec, -1
  v_mfma_f32_32x32x16_bf16 v[32:47], a[228:231], v[236:239], v[32:47]
  s_waitcnt lgkmcnt(4)
  s_barrier
  ds_read_b64_tr_b16 a[216:217], v5 offset:0
  ds_read_b64_tr_b16 a[218:219], v5 offset:512
  v_exp_f32 v83, v83
  s_add_u32 s49, s58, 0
  v_fma_f32 v80, v80, v8, v8
  v_fma_f32 v81, v81, v8, v8
  v_fma_f32 v82, v82, v8, v8
  v_fma_f32 v83, v83, v8, v8
  v_mfma_f32_32x32x16_bf16 v[32:47], a[232:235], v[240:243], v[32:47]
  ds_read_b64_tr_b16 a[220:221], v5 offset:1024
  ds_read_b64_tr_b16 a[222:223], v5 offset:1536
  v_rcp_f32 v80, v80
  v_rcp_f32 v81, v81
  v_rcp_f32 v82, v82
  v_rcp_f32 v83, v83
  v_mfma_f32_32x32x16_bf16 v[32:47], a[236:239], v[244:247], v[32:47]
  s_waitcnt lgkmcnt(4)
  ds_read_b64_tr_b16 a[224:225], v5 offset:2048
  ds_read_b64_tr_b16 a[226:227], v5 offset:2560
  v_mul_f32 v80, v28, v80
  v_mul_f32 v81, v29, v81
  v_mul_f32 v82, v30, v82
  v_mul_f32 v83, v31, v83
  v_cvt_pk_bf16_f32 v102, v80, v81
  v_cvt_pk_bf16_f32 v103, v82, v83
  v_lshl_or_b32 v120, v126, 16, v126
  v_mfma_f32_32x32x16_bf16 v[32:47], a[240:243], v[248:251], v[32:47]
  ds_read_b64_tr_b16 a[228:229], v5 offset:3072
  ds_read_b64_tr_b16 a[230:231], v5 offset:3584
  buffer_store_dwordx4 v[100:103], v1, s[28:31], s49 offen offset:1024 sc1
  v_mfma_f32_32x32x16_bf16 v[32:47], a[244:247], v[252:255], v[32:47]
  s_waitcnt lgkmcnt(4)
  ds_read_b64_tr_b16 a[232:233], v5 offset:4096
  ds_read_b64_tr_b16 a[234:235], v5 offset:4608
  v_mfma_f32_32x32x16_bf16 v[16:31], v[120:123], v[84:87], 0
  v_mfma_f32_32x32x16_bf16 v[16:31], a[216:219], v[128:131], v[16:31]
  ds_read_b64_tr_b16 a[236:237], v5 offset:5120
  ds_read_b64_tr_b16 a[238:239], v5 offset:5632
  v_mfma_f32_32x32x16_bf16 v[16:31], a[220:223], v[132:135], v[16:31]
  s_waitcnt lgkmcnt(4)
  ds_read_b64_tr_b16 a[240:241], v5 offset:6144
  ds_read_b64_tr_b16 a[242:243], v5 offset:6656
  v_mfma_f32_32x32x16_bf16 v[16:31], a[224:227], v[136:139], v[16:31]
  ds_read_b64_tr_b16 a[244:245], v5 offset:7168
  ds_read_b64_tr_b16 a[246:247], v5 offset:7680
  v_add_u32 v11, 0, v4
  v_mul_f32 v80, v32, v32
  v_mul_f32 v81, v33, v33
  v_mul_f32 v82, v34, v34
  v_mul_f32 v83, v35, v35
  v_fma_f32 v80, v80, v7, v6
  v_fma_f32 v81, v81, v7, v6
  v_mfma_f32_32x32x16_bf16 v[16:31], a[228:231], v[140:143], v[16:31]
  s_waitcnt lgkmcnt(4)
  ds_read_b64_tr_b16 a[216:217], v5 offset:8192
  ds_read_b64_tr_b16 a[218:219], v5 offset:8704
  v_fma_f32 v82, v82, v7, v6
  v_fma_f32 v83, v83, v7, v6
  v_mul_f32 v80, v32, v80
  v_mul_f32 v81, v33, v81
  v_mul_f32 v82, v34, v82
  v_mul_f32 v83, v35, v83
  v_exp_f32 v80, v80
  v_mfma_f32_32x32x16_bf16 v[16:31], a[232:235], v[144:147], v[16:31]
  ds_read_b64_tr_b16 a[220:221], v5 offset:9216
  ds_read_b64_tr_b16 a[222:223], v5 offset:9728
  v_exp_f32 v81, v81
  v_exp_f32 v82, v82
  v_exp_f32 v83, v83
  v_fma_f32 v80, v80, v8, v8
  v_mfma_f32_32x32x16_bf16 v[16:31], a[236:239], v[148:151], v[16:31]
  s_waitcnt lgkmcnt(4)
  ds_read_b64_tr_b16 a[224:225], v5 offset:10240
  ds_read_b64_tr_b16 a[226:227], v5 offset:10752
  v_fma_f32 v81, v81, v8, v8
  v_fma_f32 v82, v82, v8, v8
  v_fma_f32 v83, v83, v8, v8
  v_rcp_f32 v80, v80
  v_rcp_f32 v81, v81
  v_mfma_f32_32x32x16_bf16 v[16:31], a[240:243], v[152:155], v[16:31]
  ds_read_b64_tr_b16 a[228:229], v5 offset:11264
  ds_read_b64_tr_b16 a[230:231], v5 offset:11776
  v_rcp_f32 v82, v82
  v_rcp_f32 v83, v83
  v_mul_f32 v80, v32, v80
  v_mul_f32 v81, v33, v81
  v_mul_f32 v82, v34, v82
  v_mfma_f32_32x32x16_bf16 v[16:31], a[244:247], v[156:159], v[16:31]
  s_waitcnt lgkmcnt(4)
  ds_read_b64_tr_b16 a[232:233], v5 offset:12288
  ds_read_b64_tr_b16 a[234:235], v5 offset:12800
  v_mul_f32 v83, v35, v83
  v_cvt_pk_bf16_f32 v104, v80, v81
  v_cvt_pk_bf16_f32 v105, v82, v83
  v_mul_f32 v80, v36, v36
  v_mul_f32 v81, v37, v37
  v_mul_f32 v82, v38, v38
  v_mul_f32 v83, v39, v39
  v_mfma_f32_32x32x16_bf16 v[16:31], a[216:219], v[160:163], v[16:31]
  ds_read_b64_tr_b16 a[236:237], v5 offset:13312
  ds_read_b64_tr_b16 a[238:239], v5 offset:13824
  v_fma_f32 v80, v80, v7, v6
  v_fma_f32 v81, v81, v7, v6
  v_fma_f32 v82, v82, v7, v6
  v_fma_f32 v83, v83, v7, v6
  v_mul_f32 v80, v36, v80
  v_mul_f32 v81, v37, v81
  v_mul_f32 v82, v38, v82
  v_mul_f32 v83, v39, v83
  v_mfma_f32_32x32x16_bf16 v[16:31], a[220:223], v[164:167], v[16:31]
  s_waitcnt lgkmcnt(4)
  ds_read_b64_tr_b16 a[240:241], v5 offset:14336
  ds_read_b64_tr_b16 a[242:243], v5 offset:14848
  v_exp_f32 v80, v80
  v_exp_f32 v81, v81
  v_exp_f32 v82, v82
  v_mfma_f32_32x32x16_bf16 v[16:31], a[224:227], v[168:171], v[16:31]
  ds_read_b64_tr_b16 a[244:245], v5 offset:15360
  ds_read_b64_tr_b16 a[246:247], v5 offset:15872
  v_exp_f32 v83, v83
  v_fma_f32 v80, v80, v8, v8
  v_fma_f32 v81, v81, v8, v8
  v_fma_f32 v82, v82, v8, v8
  v_fma_f32 v83, v83, v8, v8
  v_rcp_f32 v80, v80
  v_mfma_f32_32x32x16_bf16 v[16:31], a[228:231], v[172:175], v[16:31]
  s_waitcnt lgkmcnt(4)
  ds_read_b64_tr_b16 a[216:217], v5 offset:16384
  ds_read_b64_tr_b16 a[218:219], v5 offset:16896
  v_rcp_f32 v81, v81
  s_add_u32 m0, s56, 131072
  v_rcp_f32 v82, v82
  s_add_u32 s48, s54, 0
  v_rcp_f32 v83, v83
  v_mul_f32 v80, v36, v80
  v_mfma_f32_32x32x16_bf16 v[16:31], a[232:235], v[176:179], v[16:31]
  ds_read_b64_tr_b16 a[220:221], v5 offset:17408
  ds_read_b64_tr_b16 a[222:223], v5 offset:17920
  v_mul_f32 v81, v37, v81
  v_mul_f32 v82, v38, v82
  v_mul_f32 v83, v39, v83
  v_cvt_pk_bf16_f32 v106, v80, v81
  v_cvt_pk_bf16_f32 v107, v82, v83
  v_mul_f32 v80, v40, v40
  v_mul_f32 v81, v41, v41
  v_mfma_f32_32x32x16_bf16 v[16:31], a[236:239], v[180:183], v[16:31]
  s_waitcnt lgkmcnt(4)
  ds_read_b64_tr_b16 a[224:225], v5 offset:18432
  ds_read_b64_tr_b16 a[226:227], v5 offset:18944
  v_mul_f32 v82, v42, v42
  v_mul_f32 v83, v43, v43
  v_fma_f32 v80, v80, v7, v6
  v_fma_f32 v81, v81, v7, v6
  v_fma_f32 v82, v82, v7, v6
  v_fma_f32 v83, v83, v7, v6
  v_mul_f32 v80, v40, v80
  v_mul_f32 v81, v41, v81
  v_mfma_f32_32x32x16_bf16 v[16:31], a[240:243], v[184:187], v[16:31]
  ds_read_b64_tr_b16 a[228:229], v5 offset:19456
  ds_read_b64_tr_b16 a[230:231], v5 offset:19968
  v_mul_f32 v82, v42, v82
  v_mul_f32 v83, v43, v83
  v_exp_f32 v80, v80
  v_exp_f32 v81, v81
  v_mfma_f32_32x32x16_bf16 v[16:31], a[244:247], v[188:191], v[16:31]
  s_waitcnt lgkmcnt(4)
  ds_read_b64_tr_b16 a[232:233], v5 offset:20480
  ds_read_b64_tr_b16 a[234:235], v5 offset:20992
  v_exp_f32 v82, v82
  v_exp_f32 v83, v83
  v_fma_f32 v80, v80, v8, v8
  v_fma_f32 v81, v81, v8, v8
  v_fma_f32 v82, v82, v8, v8
  v_fma_f32 v83, v83, v8, v8
  v_mfma_f32_32x32x16_bf16 v[16:31], a[216:219], v[192:195], v[16:31]
  ds_read_b64_tr_b16 a[236:237], v5 offset:21504
  ds_read_b64_tr_b16 a[238:239], v5 offset:22016
  buffer_load_dwordx4 v2, s[8:11], s48 offen lds
  v_rcp_f32 v80, v80
  s_add_u32 m0, s56, 132096
  v_rcp_f32 v81, v81
  s_add_u32 s48, s54, 49152
  v_mfma_f32_32x32x16_bf16 v[16:31], a[220:223], v[196:199], v[16:31]
  s_waitcnt lgkmcnt(4)
  ds_read_b64_tr_b16 a[240:241], v5 offset:22528
  ds_read_b64_tr_b16 a[242:243], v5 offset:23040
  v_rcp_f32 v82, v82
  v_rcp_f32 v83, v83
  v_mul_f32 v80, v40, v80
  v_mul_f32 v81, v41, v81
  v_mul_f32 v82, v42, v82
  v_mfma_f32_32x32x16_bf16 v[16:31], a[224:227], v[200:203], v[16:31]
  ds_read_b64_tr_b16 a[244:245], v5 offset:23552
  ds_read_b64_tr_b16 a[246:247], v5 offset:24064
  buffer_load_dwordx4 v2, s[8:11], s48 offen lds
  v_mul_f32 v83, v43, v83
  v_cvt_pk_bf16_f32 v108, v80, v81
  v_cvt_pk_bf16_f32 v109, v82, v83
  v_mul_f32 v80, v44, v44
  v_mul_f32 v81, v45, v45
  v_mfma_f32_32x32x16_bf16 v[16:31], a[228:231], v[204:207], v[16:31]
  s_waitcnt lgkmcnt(4)
  ds_read_b64_tr_b16 a[216:217], v5 offset:24576
  ds_read_b64_tr_b16 a[218:219], v5 offset:25088
  v_mul_f32 v82, v46, v46
  v_mul_f32 v83, v47, v47
  v_fma_f32 v80, v80, v7, v6
  v_fma_f32 v81, v81, v7, v6
  v_fma_f32 v82, v82, v7, v6
  v_fma_f32 v83, v83, v7, v6
  v_mul_f32 v80, v44, v80
  v_mfma_f32_32x32x16_bf16 v[16:31], a[232:235], v[208:211], v[16:31]
  s_add_u32 m0, s56, 133120
  ds_read_b64_tr_b16 a[220:221], v5 offset:25600
  ds_read_b64_tr_b16 a[222:223], v5 offset:26112
  v_mul_f32 v81, v45, v81
  v_mul_f32 v82, v46, v82
  v_mul_f32 v83, v47, v83
  v_exp_f32 v80, v80
  s_add_u32 s48, s54, 98304
  v_exp_f32 v81, v81
  s_lshl_b32 s50, s40, 2
  v_mfma_f32_32x32x16_bf16 v[16:31], a[236:239], v[212:215], v[16:31]
  s_waitcnt lgkmcnt(4)
  ds_read_b64_tr_b16 a[224:225], v5 offset:26624
  ds_read_b64_tr_b16 a[226:227], v5 offset:27136
  buffer_load_dwordx4 v2, s[8:11], s48 offen lds
  v_exp_f32 v82, v82
  s_sub_u32 s50, s50, 8
  v_exp_f32 v83, v83
  v_mfma_f32_32x32x16_bf16 v[16:31], a[240:243], v[216:219], v[16:31]
  ds_read_b64_tr_b16 a[228:229], v5 offset:27648
  ds_read_b64_tr_b16 a[230:231], v5 offset:28160
  v_min_u32 v12, 11, v0
  v_add_u32 v12, s50, v12
  v_max_i32 v12, 0, v12
  v_lshlrev_b32 v12, 2, v12
  s_lshl_b32 s50, s41, 8
  s_add_u32 s50, s50, 4096
  buffer_load_dword v14, v12, s[28:31], s50 offen sc1
  v_mfma_f32_32x32x16_bf16 v[16:31], a[244:247], v[220:223], v[16:31]
  s_waitcnt lgkmcnt(4)
  ds_read_b64_tr_b16 a[232:233], v5 offset:28672
  ds_read_b64_tr_b16 a[234:235], v5 offset:29184
  v_fma_f32 v80, v80, v8, v8
  v_fma_f32 v81, v81, v8, v8
  v_fma_f32 v82, v82, v8, v8
  v_fma_f32 v83, v83, v8, v8
  v_rcp_f32 v80, v80
  s_add_u32 s49, s58, 2048
  v_mfma_f32_32x32x16_bf16 v[16:31], a[216:219], v[224:227], v[16:31]
  s_add_u32 m0, s56, 134144
  ds_read_b64_tr_b16 a[236:237], v5 offset:29696
  ds_read_b64_tr_b16 a[238:239], v5 offset:30208
  buffer_store_dwordx4 v[104:107], v1, s[28:31], s49 offen offset:0 sc1
  s_add_u32 s48, s54, 147456
  buffer_load_dwordx4 v2, s[8:11], s48 offen lds
  v_rcp_f32 v81, v81
  s_add_u32 m0, s56, 135168
  v_mfma_f32_32x32x16_bf16 v[16:31], a[220:223], v[228:231], v[16:31]
  s_waitcnt lgkmcnt(4)
  ds_read_b64_tr_b16 a[240:241], v5 offset:30720
  ds_read_b64_tr_b16 a[242:243], v5 offset:31232
  v_rcp_f32 v82, v82
  s_add_u32 s48, s54, 196608
  v_rcp_f32 v83, v83
  s_mul_i32 s50, s42, 4160
  v_mul_f32 v80, v44, v80
  v_mul_f32 v81, v45, v81
  v_mul_f32 v82, v46, v82
  v_mfma_f32_32x32x16_bf16 v[16:31], a[224:227], v[232:235], v[16:31]
  s_add_u32 s50, s50, 32768
  ds_read_b64_tr_b16 a[244:245], v5 offset:31744
  ds_read_b64_tr_b16 a[246:247], v5 offset:32256
  buffer_load_dwordx4 v2, s[8:11], s48 offen lds
  v_mul_f32 v83, v47, v83
  v_cvt_pk_bf16_f32 v110, v80, v81
  v_cvt_pk_bf16_f32 v111, v82, v83
  v_lshl_or_b32 v120, v127, 16, v127
  v_mfma_f32_32x32x16_bf16 v[16:31], a[228:231], v[236:239], v[16:31]
  s_waitcnt lgkmcnt(4)
  s_waitcnt vmcnt(13)
  s_barrier
  ds_read_b64_tr_b16 a[216:217], v11 offset:0
  ds_read_b64_tr_b16 a[218:219], v11 offset:512
  v_add_u32 v3, s50, v1
  v_add_u32 v124, 2048, v3
  v_add_u32 v125, 3072, v3
  s_add_u32 s50, s50, 4096
  v_mov_b32 v15, s50
  v_cndmask_b32 v126, v15, v124, s[68:69]
  v_mfma_f32_32x32x16_bf16 v[16:31], a[232:235], v[240:243], v[16:31]
  s_add_u32 m0, s56, 136192
  ds_read_b64_tr_b16 a[220:221], v11 offset:1024
  ds_read_b64_tr_b16 a[222:223], v11 offset:1536
  v_cndmask_b32 v127, v15, v125, s[68:69]
  v_cndmask_b32 v124, v124, v15, s[68:69]
  v_cndmask_b32 v125, v125, v15, s[68:69]
  v_mfma_f32_32x32x16_bf16 v[16:31], a[236:239], v[244:247], v[16:31]
  s_waitcnt lgkmcnt(4)
  ds_read_b64_tr_b16 a[224:225], v11 offset:2048
  ds_read_b64_tr_b16 a[226:227], v11 offset:2560
  s_add_u32 s48, s54, 245760
  buffer_load_dwordx4 v2, s[8:11], s48 offen lds
  s_lshl_b32 s50, s41, 6
  s_lshl_b32 s51, s40, 2
  s_add_u32 s50, s50, s51
  s_mul_i32 s51, s42, 3
  s_add_u32 s50, s50, s51
  s_lshl_b32 s16, s50, 12
  s_add_u32 s16, s16, 32768
  s_mul_i32 s17, s42, 12480
  v_mfma_f32_32x32x16_bf16 v[16:31], a[240:243], v[248:251], v[16:31]
  s_add_u32 s49, s58, 2048
  ds_read_b64_tr_b16 a[228:229], v11 offset:3072
  ds_read_b64_tr_b16 a[230:231], v11 offset:3584
  buffer_store_dwordx4 v[108:111], v1, s[28:31], s49 offen offset:1024 sc1
  v_mfma_f32_32x32x16_bf16 v[16:31], a[244:247], v[252:255], v[16:31]
  s_waitcnt lgkmcnt(4)
  ds_read_b64_tr_b16 a[232:233], v11 offset:4096
  ds_read_b64_tr_b16 a[234:235], v11 offset:4608
  v_mfma_f32_32x32x16_bf16 v[32:47], v[120:123], v[84:87], 0
  s_add_u32 m0, s56, 137216
  v_mfma_f32_32x32x16_bf16 v[32:47], a[216:219], v[128:131], v[32:47]
  s_add_u32 s48, s54, 294912
  ds_read_b64_tr_b16 a[236:237], v11 offset:5120
  ds_read_b64_tr_b16 a[238:239], v11 offset:5632
  buffer_load_dwordx4 v2, s[8:11], s48 offen lds
  v_mfma_f32_32x32x16_bf16 v[32:47], a[220:223], v[132:135], v[32:47]
  s_waitcnt lgkmcnt(4)
  ds_read_b64_tr_b16 a[240:241], v11 offset:6144
  ds_read_b64_tr_b16 a[242:243], v11 offset:6656
  v_mfma_f32_32x32x16_bf16 v[32:47], a[224:227], v[136:139], v[32:47]
  s_add_u32 m0, s56, 138240
  ds_read_b64_tr_b16 a[244:245], v11 offset:7168
  ds_read_b64_tr_b16 a[246:247], v11 offset:7680
  s_add_u32 s48, s54, 344064
  buffer_load_dwordx4 v2, s[8:11], s48 offen lds
  s_waitcnt vmcnt(7)
  v_cmp_ne_u32 vcc, s43, v14
  s_nop 0
  s_cbranch_vccnz L_spin_kv0
L_back_kv0:
  v_min_u32 v15, 11, v0
  s_lshl_b32 s50, s40, 2
  s_sub_u32 s50, s50, 8
  v_add_u32 v14, s50, v15
  v_cmp_le_i32 s[18:19], 0, v14
  s_movk_i32 s50, 4160
  v_mul_u32_u24 v15, s50, v15
  v_add_u32 v15, 36864, v15
  v_mov_b32 v14, 0x3f803f80
  v_cndmask_b32 v14, 0, v14, s[18:19]
  ds_write2_b32 v15, v14, v14 offset0:0 offset1:1
  ds_write2_b32 v15, v14, v14 offset0:2 offset1:3
  v_mfma_f32_32x32x16_bf16 v[32:47], a[228:231], v[140:143], v[32:47]
  s_waitcnt lgkmcnt(6)
  ds_read_b64_tr_b16 a[216:217], v11 offset:8192
  ds_read_b64_tr_b16 a[218:219], v11 offset:8704
  s_mul_i32 s50, s42, 3
  s_lshl_b32 s51, s40, 2
  s_add_u32 s50, s50, s51
  s_add_u32 s50, s50, 0
  s_cmp_lt_u32 s50, 8
  s_cselect_b32 s50, 0x40000000, 0
  v_add_u32 v12, s50, v1
  s_add_u32 m0, s17, 32768
  s_add_u32 s18, s16, 0
  buffer_load_dwordx4 v12, s[28:31], s18 offen offset:0 sc1 lds
  v_mfma_f32_32x32x16_bf16 v[32:47], a[232:235], v[144:147], v[32:47]
  s_mul_i32 s50, s42, 3
  ds_read_b64_tr_b16 a[220:221], v11 offset:9216
  ds_read_b64_tr_b16 a[222:223], v11 offset:9728
  buffer_load_dwordx4 v12, s[28:31], s18 offen offset:1024 sc1 lds
  v_mfma_f32_32x32x16_bf16 v[32:47], a[236:239], v[148:151], v[32:47]
  s_waitcnt lgkmcnt(6)
  ds_read_b64_tr_b16 a[224:225], v11 offset:10240
  ds_read_b64_tr_b16 a[226:227], v11 offset:10752
  buffer_load_dwordx4 v12, s[28:31], s18 offen offset:2048 sc1 lds
  v_add_u32 v5, 131072, v4
  v_mfma_f32_32x32x16_bf16 v[32:47], a[240:243], v[152:155], v[32:47]
  s_lshl_b32 s51, s40, 2
  ds_read_b64_tr_b16 a[228:229], v11 offset:11264
  ds_read_b64_tr_b16 a[230:231], v11 offset:11776
  buffer_load_dwordx4 v12, s[28:31], s18 offen offset:3072 sc1 lds
  v_mul_f32 v80, v16, v16
  v_mul_f32 v81, v17, v17
  v_mul_f32 v82, v18, v18
  v_mul_f32 v83, v19, v19
  v_fma_f32 v80, v80, v7, v6
  v_fma_f32 v81, v81, v7, v6
  v_mfma_f32_32x32x16_bf16 v[32:47], a[244:247], v[156:159], v[32:47]
  s_waitcnt lgkmcnt(4)
  ds_read_b64_tr_b16 a[232:233], v11 offset:12288
  ds_read_b64_tr_b16 a[234:235], v11 offset:12800
  v_fma_f32 v82, v82, v7, v6
  v_fma_f32 v83, v83, v7, v6
  v_mul_f32 v80, v16, v80
  v_mul_f32 v81, v17, v81
  v_mul_f32 v82, v18, v82
  v_mul_f32 v83, v19, v83
  v_exp_f32 v80, v80
  s_add_u32 s50, s50, s51
  v_mfma_f32_32x32x16_bf16 v[32:47], a[216:219], v[160:163], v[32:47]
  s_add_u32 s50, s50, 1
  ds_read_b64_tr_b16 a[236:237], v11 offset:13312
  ds_read_b64_tr_b16 a[238:239], v11 offset:13824
  s_cmp_lt_u32 s50, 8
  s_cselect_b32 s50, 0x40000000, 0
  v_add_u32 v12, s50, v1
  s_add_u32 m0, s17, 36928
  s_add_u32 s18, s16, 4096
  buffer_load_dwordx4 v12, s[28:31], s18 offen offset:0 sc1 lds
  v_mfma_f32_32x32x16_bf16 v[32:47], a[220:223], v[164:167], v[32:47]
  s_waitcnt lgkmcnt(4)
  ds_read_b64_tr_b16 a[240:241], v11 offset:14336
  ds_read_b64_tr_b16 a[242:243], v11 offset:14848
  buffer_load_dwordx4 v12, s[28:31], s18 offen offset:1024 sc1 lds
  v_exp_f32 v81, v81
  s_mul_i32 s50, s42, 3
  v_exp_f32 v82, v82
  s_lshl_b32 s51, s40, 2
  v_exp_f32 v83, v83
  s_add_u32 s50, s50, s51
  v_mfma_f32_32x32x16_bf16 v[32:47], a[224:227], v[168:171], v[32:47]
  s_add_u32 s50, s50, 2
  ds_read_b64_tr_b16 a[244:245], v11 offset:15360
  ds_read_b64_tr_b16 a[246:247], v11 offset:15872
  buffer_load_dwordx4 v12, s[28:31], s18 offen offset:2048 sc1 lds
  v_fma_f32 v80, v80, v8, v8
  v_fma_f32 v81, v81, v8, v8
  v_fma_f32 v82, v82, v8, v8
  v_fma_f32 v83, v83, v8, v8
  v_rcp_f32 v80, v80
  s_cmp_lt_u32 s50, 8
  v_mfma_f32_32x32x16_bf16 v[32:47], a[228:231], v[172:175], v[32:47]
  s_waitcnt lgkmcnt(4)
  ds_read_b64_tr_b16 a[216:217], v11 offset:16384
  ds_read_b64_tr_b16 a[218:219], v11 offset:16896
  v_rcp_f32 v81, v81
  s_cselect_b32 s50, 0x40000000, 0
  v_rcp_f32 v82, v82
  v_rcp_f32 v83, v83
  v_mul_f32 v80, v16, v80
  v_mul_f32 v81, v17, v81
  v_mfma_f32_32x32x16_bf16 v[32:47], a[232:235], v[176:179], v[32:47]
  ds_read_b64_tr_b16 a[220:221], v11 offset:17408
  ds_read_b64_tr_b16 a[222:223], v11 offset:17920
  buffer_load_dwordx4 v12, s[28:31], s18 offen offset:3072 sc1 lds
  v_mul_f32 v82, v18, v82
  v_mul_f32 v83, v19, v83
  v_cvt_pk_bf16_f32 v96, v80, v81
  v_cvt_pk_bf16_f32 v97, v82, v83
  v_mul_f32 v80, v20, v20
  v_mul_f32 v81, v21, v21
  v_mul_f32 v82, v22, v22
  v_mfma_f32_32x32x16_bf16 v[32:47], a[236:239], v[180:183], v[32:47]
  s_waitcnt lgkmcnt(4)
  ds_read_b64_tr_b16 a[224:225], v11 offset:18432
  ds_read_b64_tr_b16 a[226:227], v11 offset:18944
  v_add_u32 v12, s50, v1
  s_add_u32 m0, s17, 41088
  s_add_u32 s18, s16, 8192
  buffer_load_dwordx4 v12, s[28:31], s18 offen offset:0 sc1 lds
  v_mfma_f32_32x32x16_bf16 v[32:47], a[240:243], v[184:187], v[32:47]
  ds_read_b64_tr_b16 a[228:229], v11 offset:19456
  ds_read_b64_tr_b16 a[230:231], v11 offset:19968
  buffer_load_dwordx4 v12, s[28:31], s18 offen offset:1024 sc1 lds
  v_mul_f32 v83, v23, v23
  v_fma_f32 v80, v80, v7, v6
  v_fma_f32 v81, v81, v7, v6
  v_fma_f32 v82, v82, v7, v6
  v_fma_f32 v83, v83, v7, v6
  v_mfma_f32_32x32x16_bf16 v[32:47], a[244:247], v[188:191], v[32:47]
  s_waitcnt lgkmcnt(4)
  ds_read_b64_tr_b16 a[232:233], v11 offset:20480
  ds_read_b64_tr_b16 a[234:235], v11 offset:20992
  v_mul_f32 v80, v20, v80
  v_mul_f32 v81, v21, v81
  v_mul_f32 v82, v22, v82
  v_mul_f32 v83, v23, v83
  v_exp_f32 v80, v80
  v_exp_f32 v81, v81
  v_mfma_f32_32x32x16_bf16 v[32:47], a[216:219], v[192:195], v[32:47]
  ds_read_b64_tr_b16 a[236:237], v11 offset:21504
  ds_read_b64_tr_b16 a[238:239], v11 offset:22016
  buffer_load_dwordx4 v12, s[28:31], s18 offen offset:2048 sc1 lds
  v_exp_f32 v82, v82
  v_exp_f32 v83, v83
  v_fma_f32 v80, v80, v8, v8
  v_fma_f32 v81, v81, v8, v8
  v_mfma_f32_32x32x16_bf16 v[32:47], a[220:223], v[196:199], v[32:47]
  s_waitcnt lgkmcnt(4)
  ds_read_b64_tr_b16 a[240:241], v11 offset:22528
  ds_read_b64_tr_b16 a[242:243], v11 offset:23040
  buffer_load_dwordx4 v12, s[28:31], s18 offen offset:3072 sc1 lds
  v_fma_f32 v82, v82, v8, v8
  v_fma_f32 v83, v83, v8, v8
  v_rcp_f32 v80, v80
  v_rcp_f32 v81, v81
  v_rcp_f32 v82, v82
  v_mfma_f32_32x32x16_bf16 v[32:47], a[224:227], v[200:203], v[32:47]
  ds_read_b64_tr_b16 a[244:245], v11 offset:23552
  ds_read_b64_tr_b16 a[246:247], v11 offset:24064
  v_rcp_f32 v83, v83
  v_mul_f32 v80, v20, v80
  v_mul_f32 v81, v21, v81
  v_mul_f32 v82, v22, v82
  v_mul_f32 v83, v23, v83
  v_cvt_pk_bf16_f32 v98, v80, v81
  v_mfma_f32_32x32x16_bf16 v[32:47], a[228:231], v[204:207], v[32:47]
  s_waitcnt lgkmcnt(4)
  ds_read_b64_tr_b16 a[216:217], v11 offset:24576
  ds_read_b64_tr_b16 a[218:219], v11 offset:25088
  v_cvt_pk_bf16_f32 v99, v82, v83
  v_mul_f32 v80, v24, v24
  v_mul_f32 v81, v25, v25
  v_mul_f32 v82, v26, v26
  v_mul_f32 v83, v27, v27
  v_fma_f32 v80, v80, v7, v6
  v_fma_f32 v81, v81, v7, v6
  v_fma_f32 v82, v82, v7, v6
  v_mfma_f32_32x32x16_bf16 v[32:47], a[232:235], v[208:211], v[32:47]
  s_add_u32 s49, s58, 4096
  ds_read_b64_tr_b16 a[220:221], v11 offset:25600
  ds_read_b64_tr_b16 a[222:223], v11 offset:26112
  v_fma_f32 v83, v83, v7, v6
  v_mul_f32 v80, v24, v80
  v_mul_f32 v81, v25, v81
  v_mul_f32 v82, v26, v82
  v_mul_f32 v83, v27, v83
  v_exp_f32 v80, v80
  v_mfma_f32_32x32x16_bf16 v[32:47], a[236:239], v[212:215], v[32:47]
  s_waitcnt lgkmcnt(4)
  ds_read_b64_tr_b16 a[224:225], v11 offset:26624
  ds_read_b64_tr_b16 a[226:227], v11 offset:27136
  v_exp_f32 v81, v81
  v_exp_f32 v82, v82
  v_exp_f32 v83, v83
  v_fma_f32 v80, v80, v8, v8
  v_fma_f32 v81, v81, v8, v8
  v_fma_f32 v82, v82, v8, v8
  v_mfma_f32_32x32x16_bf16 v[32:47], a[240:243], v[216:219], v[32:47]
  ds_read_b64_tr_b16 a[228:229], v11 offset:27648
  ds_read_b64_tr_b16 a[230:231], v11 offset:28160
  v_fma_f32 v83, v83, v8, v8
  v_rcp_f32 v80, v80
  v_rcp_f32 v81, v81
  v_rcp_f32 v82, v82
  v_mfma_f32_32x32x16_bf16 v[32:47], a[244:247], v[220:223], v[32:47]
  s_waitcnt lgkmcnt(4)
  ds_read_b64_tr_b16 a[232:233], v11 offset:28672
  ds_read_b64_tr_b16 a[234:235], v11 offset:29184
  v_rcp_f32 v83, v83
  v_mul_f32 v80, v24, v80
  v_mul_f32 v81, v25, v81
  v_mul_f32 v82, v26, v82
  v_mul_f32 v83, v27, v83
  v_cvt_pk_bf16_f32 v100, v80, v81
  v_cvt_pk_bf16_f32 v101, v82, v83
  v_mul_f32 v80, v28, v28
  v_mfma_f32_32x32x16_bf16 v[32:47], a[216:219], v[224:227], v[32:47]
  s_lshl_b32 s50, s46, 2
  ds_read_b64_tr_b16 a[236:237], v11 offset:29696
  ds_read_b64_tr_b16 a[238:239], v11 offset:30208
  buffer_store_dwordx4 v[96:99], v1, s[28:31], s49 offen offset:0 sc1
  v_mul_f32 v81, v29, v29
  v_mul_f32 v82, v30, v30
  v_mul_f32 v83, v31, v31
  v_fma_f32 v80, v80, v7, v6
  v_fma_f32 v81, v81, v7, v6
  v_fma_f32 v82, v82, v7, v6
  v_mfma_f32_32x32x16_bf16 v[32:47], a[220:223], v[228:231], v[32:47]
  s_waitcnt lgkmcnt(4)
  ds_read_b64_tr_b16 a[240:241], v11 offset:30720
  ds_read_b64_tr_b16 a[242:243], v11 offset:31232
  v_fma_f32 v83, v83, v7, v6
  v_mul_f32 v80, v28, v80
  v_mul_f32 v81, v29, v81
  v_mul_f32 v82, v30, v82
  v_mul_f32 v83, v31, v83
  v_exp_f32 v80, v80
  s_add_u32 s50, s50, s42
  v_mfma_f32_32x32x16_bf16 v[32:47], a[224:227], v[232:235], v[32:47]
  s_lshl_b32 s50, s50, 12
  ds_read_b64_tr_b16 a[244:245], v11 offset:31744
  ds_read_b64_tr_b16 a[246:247], v11 offset:32256
  v_exp_f32 v81, v81
  s_add_u32 s49, s58, 4096
  v_exp_f32 v82, v82
  v_exp_f32 v83, v83
  v_fma_f32 v80, v80, v8, v8
  v_fma_f32 v81, v81, v8, v8
  v_mfma_f32_32x32x16_bf16 v[32:47], a[228:231], v[236:239], v[32:47]
  s_waitcnt lgkmcnt(4)
  s_waitcnt vmcnt(13)
  s_barrier
  ds_read_b64_tr_b16 a[216:217], v5 offset:0
  ds_read_b64_tr_b16 a[218:219], v5 offset:512
  v_fma_f32 v82, v82, v8, v8
  v_fma_f32 v83, v83, v8, v8
  v_rcp_f32 v80, v80
  v_rcp_f32 v81, v81
  v_rcp_f32 v82, v82
  v_mfma_f32_32x32x16_bf16 v[32:47], a[232:235], v[240:243], v[32:47]
  ds_read_b64_tr_b16 a[220:221], v5 offset:1024
  ds_read_b64_tr_b16 a[222:223], v5 offset:1536
  v_bfe_u32 v14, v0, 3, 2
  v_and_b32 v15, 7, v0
  v_lshlrev_b32 v15, 7, v15
  v_lshl_add_u32 v15, v14, 10, v15
  buffer_load_dword a249, v15, s[12:15], s50 offen
  v_mfma_f32_32x32x16_bf16 v[32:47], a[236:239], v[244:247], v[32:47]
  s_waitcnt lgkmcnt(4)
  ds_read_b64_tr_b16 a[224:225], v5 offset:2048
  ds_read_b64_tr_b16 a[226:227], v5 offset:2560
  v_rcp_f32 v83, v83
  v_mul_f32 v80, v28, v80
  v_mul_f32 v81, v29, v81
  v_mul_f32 v82, v30, v82
  v_mul_f32 v83, v31, v83
  v_cvt_pk_bf16_f32 v102, v80, v81
  v_cvt_pk_bf16_f32 v103, v82, v83
  v_mfma_f32_32x32x16_bf16 v[32:47], a[240:243], v[248:251], v[32:47]
  ds_read_b64_tr_b16 a[228:229], v5 offset:3072
  ds_read_b64_tr_b16 a[230:231], v5 offset:3584
  buffer_store_dwordx4 v[100:103], v1, s[28:31], s49 offen offset:1024 sc1
  v_mfma_f32_32x32x16_bf16 v[32:47], a[244:247], v[252:255], v[32:47]
  s_waitcnt lgkmcnt(4)
  ds_read_b64_tr_b16 a[232:233], v5 offset:4096
  ds_read_b64_tr_b16 a[234:235], v5 offset:4608
  v_mfma_f32_32x32x16_bf16 v[16:31], a[216:219], v[128:131], 0
  ds_read_b64_tr_b16 a[236:237], v5 offset:5120
  ds_read_b64_tr_b16 a[238:239], v5 offset:5632
  v_mfma_f32_32x32x16_bf16 v[16:31], a[220:223], v[132:135], v[16:31]
  s_waitcnt lgkmcnt(4)
  ds_read_b64_tr_b16 a[240:241], v5 offset:6144
  ds_read_b64_tr_b16 a[242:243], v5 offset:6656
  v_mfma_f32_32x32x16_bf16 v[16:31], a[224:227], v[136:139], v[16:31]
  ds_read_b64_tr_b16 a[244:245], v5 offset:7168
  ds_read_b64_tr_b16 a[246:247], v5 offset:7680
  v_mul_f32 v80, v32, v32
  v_mul_f32 v81, v33, v33
  v_mul_f32 v82, v34, v34
  v_mul_f32 v83, v35, v35
  v_fma_f32 v80, v80, v7, v6
  v_fma_f32 v81, v81, v7, v6
  v_mfma_f32_32x32x16_bf16 v[16:31], a[228:231], v[140:143], v[16:31]
  s_waitcnt lgkmcnt(4)
  ds_read_b64_tr_b16 a[216:217], v5 offset:8192
  ds_read_b64_tr_b16 a[218:219], v5 offset:8704
  v_fma_f32 v82, v82, v7, v6
  v_fma_f32 v83, v83, v7, v6
  v_mul_f32 v80, v32, v80
  v_mul_f32 v81, v33, v81
  v_mul_f32 v82, v34, v82
  v_mfma_f32_32x32x16_bf16 v[16:31], a[232:235], v[144:147], v[16:31]
  ds_read_b64_tr_b16 a[220:221], v5 offset:9216
  ds_read_b64_tr_b16 a[222:223], v5 offset:9728
  v_mul_f32 v83, v35, v83
  v_exp_f32 v80, v80
  v_exp_f32 v81, v81
  v_mfma_f32_32x32x16_bf16 v[16:31], a[236:239], v[148:151], v[16:31]
  s_waitcnt lgkmcnt(4)
  ds_read_b64_tr_b16 a[224:225], v5 offset:10240
  ds_read_b64_tr_b16 a[226:227], v5 offset:10752
  v_exp_f32 v82, v82
  v_exp_f32 v83, v83
  v_fma_f32 v80, v80, v8, v8
  v_fma_f32 v81, v81, v8, v8
  v_mfma_f32_32x32x16_bf16 v[16:31], a[240:243], v[152:155], v[16:31]
  ds_read_b64_tr_b16 a[228:229], v5 offset:11264
  ds_read_b64_tr_b16 a[230:231], v5 offset:11776
  v_fma_f32 v82, v82, v8, v8
  v_fma_f32 v83, v83, v8, v8
  v_rcp_f32 v80, v80
  v_rcp_f32 v81, v81
  v_mfma_f32_32x32x16_bf16 v[16:31], a[244:247], v[156:159], v[16:31]
  s_waitcnt lgkmcnt(4)
  ds_read_b64_tr_b16 a[232:233], v5 offset:12288
  ds_read_b64_tr_b16 a[234:235], v5 offset:12800
  v_rcp_f32 v82, v82
  v_rcp_f32 v83, v83
  v_mul_f32 v80, v32, v80
  v_mfma_f32_32x32x16_bf16 v[16:31], a[216:219], v[160:163], v[16:31]
  ds_read_b64_tr_b16 a[236:237], v5 offset:13312
  ds_read_b64_tr_b16 a[238:239], v5 offset:13824
  v_mul_f32 v81, v33, v81
  v_mul_f32 v82, v34, v82
  v_mul_f32 v83, v35, v83
  v_cvt_pk_bf16_f32 v104, v80, v81
  v_cvt_pk_bf16_f32 v105, v82, v83
  v_mul_f32 v80, v36, v36
  v_mfma_f32_32x32x16_bf16 v[16:31], a[220:223], v[164:167], v[16:31]
  s_waitcnt lgkmcnt(4)
  ds_read_b64_tr_b16 a[240:241], v5 offset:14336
  ds_read_b64_tr_b16 a[242:243], v5 offset:14848
  v_mul_f32 v81, v37, v37
  v_mul_f32 v82, v38, v38
  v_mul_f32 v83, v39, v39
  v_fma_f32 v80, v80, v7, v6
  v_fma_f32 v81, v81, v7, v6
  v_mfma_f32_32x32x16_bf16 v[16:31], a[224:227], v[168:171], v[16:31]
  ds_read_b64_tr_b16 a[244:245], v5 offset:15360
  ds_read_b64_tr_b16 a[246:247], v5 offset:15872
  v_fma_f32 v82, v82, v7, v6
  v_fma_f32 v83, v83, v7, v6
  v_mul_f32 v80, v36, v80
  v_mul_f32 v81, v37, v81
  v_mul_f32 v82, v38, v82
  v_mul_f32 v83, v39, v83
  v_mfma_f32_32x32x16_bf16 v[16:31], a[228:231], v[172:175], v[16:31]
  s_waitcnt lgkmcnt(4)
  ds_read_b64_tr_b16 a[216:217], v5 offset:16384
  ds_read_b64_tr_b16 a[218:219], v5 offset:16896
  v_exp_f32 v80, v80
  v_exp_f32 v81, v81
  v_exp_f32 v82, v82
  v_mfma_f32_32x32x16_bf16 v[16:31], a[232:235], v[176:179], v[16:31]
  ds_read_b64_tr_b16 a[220:221], v5 offset:17408
  ds_read_b64_tr_b16 a[222:223], v5 offset:17920
  v_exp_f32 v83, v83
  v_fma_f32 v80, v80, v8, v8
  v_fma_f32 v81, v81, v8, v8
  v_fma_f32 v82, v82, v8, v8
  v_mfma_f32_32x32x16_bf16 v[16:31], a[236:239], v[180:183], v[16:31]
  s_waitcnt lgkmcnt(4)
  ds_read_b64_tr_b16 a[224:225], v5 offset:18432
  ds_read_b64_tr_b16 a[226:227], v5 offset:18944
  v_fma_f32 v83, v83, v8, v8
  v_rcp_f32 v80, v80
  v_rcp_f32 v81, v81
  v_mfma_f32_32x32x16_bf16 v[16:31], a[240:243], v[184:187], v[16:31]
  ds_read_b64_tr_b16 a[228:229], v5 offset:19456
  ds_read_b64_tr_b16 a[230:231], v5 offset:19968
  v_rcp_f32 v82, v82
  v_rcp_f32 v83, v83
  v_mul_f32 v80, v36, v80
  v_mul_f32 v81, v37, v81
  v_mfma_f32_32x32x16_bf16 v[16:31], a[244:247], v[188:191], v[16:31]
  s_waitcnt lgkmcnt(4)
  ds_read_b64_tr_b16 a[232:233], v5 offset:20480
  ds_read_b64_tr_b16 a[234:235], v5 offset:20992
  v_mul_f32 v82, v38, v82
  v_mul_f32 v83, v39, v83
  v_cvt_pk_bf16_f32 v106, v80, v81
  v_cvt_pk_bf16_f32 v107, v82, v83
  v_mul_f32 v80, v40, v40
  v_mfma_f32_32x32x16_bf16 v[16:31], a[216:219], v[192:195], v[16:31]
  ds_read_b64_tr_b16 a[236:237], v5 offset:21504
  ds_read_b64_tr_b16 a[238:239], v5 offset:22016
  v_mul_f32 v81, v41, v41
  v_mul_f32 v82, v42, v42
  v_mul_f32 v83, v43, v43
  v_fma_f32 v80, v80, v7, v6
  v_fma_f32 v81, v81, v7, v6
  v_fma_f32 v82, v82, v7, v6
  v_mfma_f32_32x32x16_bf16 v[16:31], a[220:223], v[196:199], v[16:31]
  s_waitcnt lgkmcnt(4)
  ds_read_b64_tr_b16 a[240:241], v5 offset:22528
  ds_read_b64_tr_b16 a[242:243], v5 offset:23040
  v_fma_f32 v83, v83, v7, v6
  v_mul_f32 v80, v40, v80
  v_mul_f32 v81, v41, v81
  v_mul_f32 v82, v42, v82
  v_mul_f32 v83, v43, v83
  v_mfma_f32_32x32x16_bf16 v[16:31], a[224:227], v[200:203], v[16:31]
  s_add_u32 s49, s58, 6144
  ds_read_b64_tr_b16 a[244:245], v5 offset:23552
  ds_read_b64_tr_b16 a[246:247], v5 offset:24064
  v_exp_f32 v80, v80
  v_exp_f32 v81, v81
  v_exp_f32 v82, v82
  v_mfma_f32_32x32x16_bf16 v[16:31], a[228:231], v[204:207], v[16:31]
  s_waitcnt lgkmcnt(4)
  ds_read_b64_tr_b16 a[216:217], v5 offset:24576
  ds_read_b64_tr_b16 a[218:219], v5 offset:25088
  v_exp_f32 v83, v83
  v_fma_f32 v80, v80, v8, v8
  v_fma_f32 v81, v81, v8, v8
  v_fma_f32 v82, v82, v8, v8
  v_mfma_f32_32x32x16_bf16 v[16:31], a[232:235], v[208:211], v[16:31]
  ds_read_b64_tr_b16 a[220:221], v5 offset:25600
  ds_read_b64_tr_b16 a[222:223], v5 offset:26112
  v_fma_f32 v83, v83, v8, v8
  v_rcp_f32 v80, v80
  v_rcp_f32 v81, v81
  v_mfma_f32_32x32x16_bf16 v[16:31], a[236:239], v[212:215], v[16:31]
  s_waitcnt lgkmcnt(4)
  ds_read_b64_tr_b16 a[224:225], v5 offset:26624
  ds_read_b64_tr_b16 a[226:227], v5 offset:27136
  v_rcp_f32 v82, v82
  v_rcp_f32 v83, v83
  v_mul_f32 v80, v40, v80
  v_mul_f32 v81, v41, v81
  v_mfma_f32_32x32x16_bf16 v[16:31], a[240:243], v[216:219], v[16:31]
  ds_read_b64_tr_b16 a[228:229], v5 offset:27648
  ds_read_b64_tr_b16 a[230:231], v5 offset:28160
  v_mul_f32 v82, v42, v82
  v_mul_f32 v83, v43, v83
  v_cvt_pk_bf16_f32 v108, v80, v81
  v_cvt_pk_bf16_f32 v109, v82, v83
  v_mul_f32 v80, v44, v44
  v_mul_f32 v81, v45, v45
  v_mfma_f32_32x32x16_bf16 v[16:31], a[244:247], v[220:223], v[16:31]
  s_waitcnt lgkmcnt(4)
  ds_read_b64_tr_b16 a[232:233], v5 offset:28672
  ds_read_b64_tr_b16 a[234:235], v5 offset:29184
  v_mul_f32 v82, v46, v46
  v_mul_f32 v83, v47, v47
  v_fma_f32 v80, v80, v7, v6
  v_fma_f32 v81, v81, v7, v6
  v_fma_f32 v82, v82, v7, v6
  v_mfma_f32_32x32x16_bf16 v[16:31], a[216:219], v[224:227], v[16:31]
  ds_read_b64_tr_b16 a[236:237], v5 offset:29696
  ds_read_b64_tr_b16 a[238:239], v5 offset:30208
  buffer_store_dwordx4 v[104:107], v1, s[28:31], s49 offen offset:0 sc1
  v_fma_f32 v83, v83, v7, v6
  v_mul_f32 v80, v44, v80
  v_mul_f32 v81, v45, v81
  v_mul_f32 v82, v46, v82
  v_mfma_f32_32x32x16_bf16 v[16:31], a[220:223], v[228:231], v[16:31]
  s_waitcnt lgkmcnt(4)
  ds_read_b64_tr_b16 a[240:241], v5 offset:30720
  ds_read_b64_tr_b16 a[242:243], v5 offset:31232
  v_mul_f32 v83, v47, v83
  v_exp_f32 v80, v80
  v_exp_f32 v81, v81
  v_mfma_f32_32x32x16_bf16 v[16:31], a[224:227], v[232:235], v[16:31]
  ds_read_b64_tr_b16 a[244:245], v5 offset:31744
  ds_read_b64_tr_b16 a[246:247], v5 offset:32256
  v_exp_f32 v82, v82
  v_exp_f32 v83, v83
  v_fma_f32 v80, v80, v8, v8
  v_fma_f32 v81, v81, v8, v8
  v_mfma_f32_32x32x16_bf16 v[16:31], a[228:231], v[236:239], v[16:31]
  s_waitcnt lgkmcnt(4)
  v_fma_f32 v82, v82, v8, v8
  v_fma_f32 v83, v83, v8, v8
  v_rcp_f32 v80, v80
  v_rcp_f32 v81, v81
  v_mfma_f32_32x32x16_bf16 v[16:31], a[232:235], v[240:243], v[16:31]
  v_rcp_f32 v82, v82
  v_rcp_f32 v83, v83
  v_mul_f32 v80, v44, v80
  v_mfma_f32_32x32x16_bf16 v[16:31], a[236:239], v[244:247], v[16:31]
  s_waitcnt lgkmcnt(0)
  v_mul_f32 v81, v45, v81
  v_mul_f32 v82, v46, v82
  v_mul_f32 v83, v47, v83
  v_cvt_pk_bf16_f32 v110, v80, v81
  v_cvt_pk_bf16_f32 v111, v82, v83
  v_mfma_f32_32x32x16_bf16 v[16:31], a[240:243], v[248:251], v[16:31]
  s_add_u32 s49, s58, 6144
  buffer_store_dwordx4 v[108:111], v1, s[28:31], s49 offen offset:1024 sc1
  v_mfma_f32_32x32x16_bf16 v[16:31], a[244:247], v[252:255], v[16:31]
  s_waitcnt vmcnt(5)
  s_barrier
  ds_read_b128 a[0:3], v3 offset:0
  ds_read_b128 a[64:67], v3 offset:33280
  ds_read_b128 a[8:11], v3 offset:4160
  ds_read_b128 a[16:19], v3 offset:8320
  s_nop 5
  v_mul_f32 v16, v16, v10
  v_mul_f32 v17, v17, v10
  v_mul_f32 v18, v18, v10
  v_mul_f32 v19, v19, v10
  v_cvt_pk_bf16_f32 v112, v16, v17
  v_cvt_pk_bf16_f32 v113, v18, v19
  v_mul_f32 v20, v20, v10
  v_mul_f32 v21, v21, v10
  v_mul_f32 v22, v22, v10
  v_mul_f32 v23, v23, v10
  v_cvt_pk_bf16_f32 v114, v20, v21
  v_cvt_pk_bf16_f32 v115, v22, v23
  v_mul_f32 v24, v24, v10
  v_mul_f32 v25, v25, v10
  v_mul_f32 v26, v26, v10
  v_mul_f32 v27, v27, v10
  v_cvt_pk_bf16_f32 v116, v24, v25
  v_cvt_pk_bf16_f32 v117, v26, v27
  v_mul_f32 v28, v28, v10
  v_mul_f32 v29, v29, v10
  v_mul_f32 v30, v30, v10
  v_mul_f32 v31, v31, v10
  v_cvt_pk_bf16_f32 v118, v28, v29
  v_cvt_pk_bf16_f32 v119, v30, v31
  s_branch L_join1
L_var1:
  v_mul_f32 v34, v34, v66
  v_mfma_f32_32x32x16_bf16 v[16:31], a[228:231], v[140:143], v[16:31]
  s_waitcnt lgkmcnt(4)
  ds_read_b64_tr_b16 a[216:217], v5 offset:8192
  ds_read_b64_tr_b16 a[218:219], v5 offset:8704
  s_add_u32 s48, s55, 57472
  buffer_load_dwordx4 v3, s[16:19], s48 offen lds
  v_mfma_f32_32x32x16_bf16 v[16:31], a[232:235], v[144:147], v[16:31]
  s_add_u32 m0, s56, 100352
  ds_read_b64_tr_b16 a[220:221], v5 offset:9216
  ds_read_b64_tr_b16 a[222:223], v5 offset:9728
  v_mul_f32 v35, v35, v67
  v_cvt_pk_bf16_f32 v104, v32, v33
  v_cvt_pk_bf16_f32 v105, v34, v35
  v_mul_f32 v36, v36, v68
  v_mfma_f32_32x32x16_bf16 v[16:31], a[236:239], v[148:151], v[16:31]
  s_waitcnt lgkmcnt(4)
  ds_read_b64_tr_b16 a[224:225], v5 offset:10240
  ds_read_b64_tr_b16 a[226:227], v5 offset:10752
  v_mul_f32 v37, v37, v69
  v_mul_f32 v38, v38, v70
  v_mul_f32 v39, v39, v71
  v_cvt_pk_bf16_f32 v106, v36, v37
  v_mfma_f32_32x32x16_bf16 v[16:31], a[240:243], v[152:155], v[16:31]
  s_add_u32 s48, s55, 114816
  ds_read_b64_tr_b16 a[228:229], v5 offset:11264
  ds_read_b64_tr_b16 a[230:231], v5 offset:11776
  buffer_load_dwordx4 v3, s[16:19], s48 offen lds
  v_cvt_pk_bf16_f32 v107, v38, v39
  v_mfma_f32_32x32x16_bf16 v[16:31], a[244:247], v[156:159], v[16:31]
  s_waitcnt lgkmcnt(4)
  ds_read_b64_tr_b16 a[232:233], v5 offset:12288
  ds_read_b64_tr_b16 a[234:235], v5 offset:12800
  v_mul_f32 v40, v40, v72
  v_mul_f32 v41, v41, v73
  v_mul_f32 v42, v42, v74
  v_mfma_f32_32x32x16_bf16 v[16:31], a[216:219], v[160:163], v[16:31]
  s_add_u32 m0, s56, 101376
  ds_read_b64_tr_b16 a[236:237], v5 offset:13312
  ds_read_b64_tr_b16 a[238:239], v5 offset:13824
  v_mul_f32 v43, v43, v75
  v_cvt_pk_bf16_f32 v108, v40, v41
  v_cvt_pk_bf16_f32 v109, v42, v43
  v_mul_f32 v44, v44, v76
  v_mfma_f32_32x32x16_bf16 v[16:31], a[220:223], v[164:167], v[16:31]
  s_waitcnt lgkmcnt(4)
  ds_read_b64_tr_b16 a[240:241], v5 offset:14336
  ds_read_b64_tr_b16 a[242:243], v5 offset:14848
  s_add_u32 s48, s55, 172160
  buffer_load_dwordx4 v3, s[16:19], s48 offen lds
  v_mul_f32 v45, v45, v77
  v_mfma_f32_32x32x16_bf16 v[16:31], a[224:227], v[168:171], v[16:31]
  s_add_u32 m0, s56, 102400
  ds_read_b64_tr_b16 a[244:245], v5 offset:15360
  ds_read_b64_tr_b16 a[246:247], v5 offset:15872
  v_mul_f32 v46, v46, v78
  v_mul_f32 v47, v47, v79
  v_cvt_pk_bf16_f32 v110, v44, v45
  v_mfma_f32_32x32x16_bf16 v[16:31], a[228:231], v[172:175], v[16:31]
  s_waitcnt lgkmcnt(4)
  ds_read_b64_tr_b16 a[216:217], v5 offset:16384
  ds_read_b64_tr_b16 a[218:219], v5 offset:16896
  s_add_u32 s48, s55, 229504
  buffer_load_dwordx4 v3, s[16:19], s48 offen lds
  v_cvt_pk_bf16_f32 v111, v46, v47
  v_mfma_f32_32x32x16_bf16 v[16:31], a[232:235], v[176:179], v[16:31]
  s_mov_b32 s50, 0xffff
  ds_read_b64_tr_b16 a[220:221], v5 offset:17408
  ds_read_b64_tr_b16 a[222:223], v5 offset:17920
  v_lshl_or_b32 v120, v125, 16, v125
  v_cndmask_b32 v88, 0, -1, s[70:71]
  v_cndmask_b32 v15, 0, -1, s[72:73]
  v_bfi_b32 v88, s50, v88, v15
  v_mfma_f32_32x32x16_bf16 v[16:31], a[236:239], v[180:183], v[16:31]
  s_waitcnt lgkmcnt(4)
  ds_read_b64_tr_b16 a[224:225], v5 offset:18432
  ds_read_b64_tr_b16 a[226:227], v5 offset:18944
  v_cndmask_b32 v89, 0, -1, s[74:75]
  v_cndmask_b32 v15, 0, -1, s[76:77]
  s_mov_b32 s50, 0xffff
  v_bfi_b32 v89, s50, v89, v15
  v_mfma_f32_32x32x16_bf16 v[16:31], a[240:243], v[184:187], v[16:31]
  s_add_u32 m0, s56, 103424
  ds_read_b64_tr_b16 a[228:229], v5 offset:19456
  ds_read_b64_tr_b16 a[230:231], v5 offset:19968
  s_add_u32 s48, s55, 286848
  buffer_load_dwordx4 v3, s[16:19], s48 offen lds
  v_mfma_f32_32x32x16_bf16 v[16:31], a[244:247], v[188:191], v[16:31]
  s_waitcnt lgkmcnt(4)
  ds_read_b64_tr_b16 a[232:233], v5 offset:20480
  ds_read_b64_tr_b16 a[234:235], v5 offset:20992
  v_cndmask_b32 v90, 0, -1, s[78:79]
  v_cndmask_b32 v15, 0, -1, s[80:81]
  s_mov_b32 s50, 0xffff
  v_bfi_b32 v90, s50, v90, v15
  v_mfma_f32_32x32x16_bf16 v[16:31], a[216:219], v[192:195], v[16:31]
  s_mov_b32 s50, 0xffff
  ds_read_b64_tr_b16 a[236:237], v5 offset:21504
  ds_read_b64_tr_b16 a[238:239], v5 offset:22016
  v_cndmask_b32 v91, 0, -1, s[82:83]
  v_cndmask_b32 v15, 0, -1, s[84:85]
  v_bfi_b32 v91, s50, v91, v15
  v_mfma_f32_32x32x16_bf16 v[16:31], a[220:223], v[196:199], v[16:31]
  s_waitcnt lgkmcnt(4)
  ds_read_b64_tr_b16 a[240:241], v5 offset:22528
  ds_read_b64_tr_b16 a[242:243], v5 offset:23040
  s_add_u32 m0, s56, 104448
  s_add_u32 s48, s55, 344192
  buffer_load_dwordx4 v3, s[16:19], s48 offen lds
  v_mfma_f32_32x32x16_bf16 v[16:31], a[224:227], v[200:203], v[16:31]
  s_mov_b32 s50, 0xffff
  ds_read_b64_tr_b16 a[244:245], v5 offset:23552
  ds_read_b64_tr_b16 a[246:247], v5 offset:24064
  v_cndmask_b32 v92, 0, -1, s[86:87]
  v_cndmask_b32 v15, 0, -1, s[88:89]
  v_bfi_b32 v92, s50, v92, v15
  v_mfma_f32_32x32x16_bf16 v[16:31], a[228:231], v[204:207], v[16:31]
  s_waitcnt lgkmcnt(4)
  ds_read_b64_tr_b16 a[216:217], v5 offset:24576
  ds_read_b64_tr_b16 a[218:219], v5 offset:25088
  s_add_u32 m0, s56, 105472
  s_add_u32 s48, s55, 401536
  buffer_load_dwordx4 v3, s[16:19], s48 offen lds
  v_mfma_f32_32x32x16_bf16 v[16:31], a[232:235], v[208:211], v[16:31]
  s_mov_b32 s50, 0xffff
  ds_read_b64_tr_b16 a[220:221], v5 offset:25600
  ds_read_b64_tr_b16 a[222:223], v5 offset:26112
  v_cndmask_b32 v93, 0, -1, s[90:91]
  v_cndmask_b32 v15, 0, -1, s[92:93]
  v_bfi_b32 v93, s50, v93, v15
  v_mfma_f32_32x32x16_bf16 v[16:31], a[236:239], v[212:215], v[16:31]
  s_waitcnt lgkmcnt(4)
  ds_read_b64_tr_b16 a[224:225], v5 offset:26624
  ds_read_b64_tr_b16 a[226:227], v5 offset:27136
  v_cndmask_b32 v94, 0, -1, s[94:95]
  v_cndmask_b32 v15, 0, -1, s[96:97]
  s_mov_b32 s50, 0xffff
  v_bfi_b32 v94, s50, v94, v15
  v_mfma_f32_32x32x16_bf16 v[16:31], a[240:243], v[216:219], v[16:31]
  s_mov_b32 s50, 0xffff
  ds_read_b64_tr_b16 a[228:229], v5 offset:27648
  ds_read_b64_tr_b16 a[230:231], v5 offset:28160
  v_cndmask_b32 v95, 0, -1, s[98:99]
  v_cndmask_b32 v15, 0, -1, s[100:101]
  v_bfi_b32 v95, s50, v95, v15
  v_mfma_f32_32x32x16_bf16 v[16:31], a[244:247], v[220:223], v[16:31]
  s_waitcnt lgkmcnt(4)
  ds_read_b64_tr_b16 a[232:233], v5 offset:28672
  ds_read_b64_tr_b16 a[234:235], v5 offset:29184
  v_mfma_f32_32x32x16_bf16 v[16:31], a[216:219], v[224:227], v[16:31]
  s_movk_i32 s50, 3072
  ds_read_b64_tr_b16 a[236:237], v5 offset:29696
  ds_read_b64_tr_b16 a[238:239], v5 offset:30208
  buffer_store_dwordx4 v[104:107], v1, s[28:31], s57 offen offset:2048 sc1
  v_mfma_f32_32x32x16_bf16 v[16:31], a[220:223], v[228:231], v[16:31]
  s_waitcnt lgkmcnt(4)
  ds_read_b64_tr_b16 a[240:241], v5 offset:30720
  ds_read_b64_tr_b16 a[242:243], v5 offset:31232
  v_mfma_f32_32x32x16_bf16 v[16:31], a[224:227], v[232:235], v[16:31]
  ds_read_b64_tr_b16 a[244:245], v5 offset:31744
  ds_read_b64_tr_b16 a[246:247], v5 offset:32256
  v_bfe_u32 v12, v0, 2, 2
  v_and_b32 v15, 3, v0
  v_lshlrev_b32 v15, 7, v15
  v_mad_u32_u24 v15, v12, s50, v15
  s_lshl_b32 s50, s46, 2
  s_add_u32 s50, s50, s42
  s_mul_i32 s50, s50, 12288
  s_lshr_b32 s51, s41, 3
  s_lshl_b32 s51, s51, 9
  s_add_u32 s50, s50, s51
  buffer_load_dword a252, v15, s[8:11], s50 offen
  v_mfma_f32_32x32x16_bf16 v[16:31], a[228:231], v[236:239], v[16:31]
  s_waitcnt lgkmcnt(4)
  s_waitcnt vmcnt(12)
  s_barrier
  ds_read_b64_tr_b16 a[216:217], v11 offset:0
  ds_read_b64_tr_b16 a[218:219], v11 offset:512
  v_and_b32 v15, 15, v0
  v_lshlrev_b32 v15, 7, v15
  s_lshl_b32 s50, s2, 2
  s_add_u32 s50, s50, s42
  s_lshl_b32 s50, s50, 11
  buffer_load_dword a251, v15, s[20:23], s50 offen
  v_mfma_f32_32x32x16_bf16 v[16:31], a[232:235], v[240:243], v[16:31]
  s_lshl_b32 s50, s2, 2
  ds_read_b64_tr_b16 a[220:221], v11 offset:1024
  ds_read_b64_tr_b16 a[222:223], v11 offset:1536
  v_and_b32 v15, 3, v0
  v_lshlrev_b32 v15, 7, v15
  s_add_u32 s50, s50, s42
  s_lshl_b32 s50, s50, 9
  buffer_load_dword a250, v15, s[12:15], s50 offen
  v_mfma_f32_32x32x16_bf16 v[16:31], a[236:239], v[244:247], v[16:31]
  s_waitcnt lgkmcnt(4)
  ds_read_b64_tr_b16 a[224:225], v11 offset:2048
  ds_read_b64_tr_b16 a[226:227], v11 offset:2560
  v_mfma_f32_32x32x16_bf16 v[16:31], a[240:243], v[248:251], v[16:31]
  ds_read_b64_tr_b16 a[228:229], v11 offset:3072
  ds_read_b64_tr_b16 a[230:231], v11 offset:3584
  buffer_store_dwordx4 v[108:111], v1, s[28:31], s57 offen offset:3072 sc1
  v_mfma_f32_32x32x16_bf16 v[16:31], a[244:247], v[252:255], v[16:31]
  s_waitcnt lgkmcnt(4)
  ds_read_b64_tr_b16 a[232:233], v11 offset:4096
  ds_read_b64_tr_b16 a[234:235], v11 offset:4608
  v_mfma_f32_32x32x16_bf16 v[32:47], v[120:123], v[84:87], 0
  v_mfma_f32_32x32x16_bf16 v[32:47], a[216:219], v[128:131], v[32:47]
  ds_read_b64_tr_b16 a[236:237], v11 offset:5120
  ds_read_b64_tr_b16 a[238:239], v11 offset:5632
  v_mfma_f32_32x32x16_bf16 v[32:47], a[220:223], v[132:135], v[32:47]
  s_waitcnt lgkmcnt(4)
  ds_read_b64_tr_b16 a[240:241], v11 offset:6144
  ds_read_b64_tr_b16 a[242:243], v11 offset:6656
  v_mfma_f32_32x32x16_bf16 v[32:47], a[224:227], v[136:139], v[32:47]
  ds_read_b64_tr_b16 a[244:245], v11 offset:7168
  ds_read_b64_tr_b16 a[246:247], v11 offset:7680
  v_add_u32 v5, 98304, v4
  v_mul_f32 v80, v16, v16
  v_mul_f32 v81, v17, v17
  v_mul_f32 v82, v18, v18
  v_mul_f32 v83, v19, v19
  v_fma_f32 v80, v80, v7, v6
  v_fma_f32 v81, v81, v7, v6
  v_mfma_f32_32x32x16_bf16 v[32:47], a[228:231], v[140:143], v[32:47]
  s_waitcnt lgkmcnt(4)
  ds_read_b64_tr_b16 a[216:217], v11 offset:8192
  ds_read_b64_tr_b16 a[218:219], v11 offset:8704
  v_fma_f32 v82, v82, v7, v6
  v_fma_f32 v83, v83, v7, v6
  v_mul_f32 v80, v16, v80
  v_mul_f32 v81, v17, v81
  v_mul_f32 v82, v18, v82
  v_mul_f32 v83, v19, v83
  v_mfma_f32_32x32x16_bf16 v[32:47], a[232:235], v[144:147], v[32:47]
  ds_read_b64_tr_b16 a[220:221], v11 offset:9216
  ds_read_b64_tr_b16 a[222:223], v11 offset:9728
  v_exp_f32 v80, v80
  v_exp_f32 v81, v81
  v_exp_f32 v82, v82
  v_mfma_f32_32x32x16_bf16 v[32:47], a[236:239], v[148:151], v[32:47]
  s_waitcnt lgkmcnt(4)
  ds_read_b64_tr_b16 a[224:225], v11 offset:10240
  ds_read_b64_tr_b16 a[226:227], v11 offset:10752
  v_exp_f32 v83, v83
  v_fma_f32 v80, v80, v8, v8
  v_fma_f32 v81, v81, v8, v8
  v_fma_f32 v82, v82, v8, v8
  v_fma_f32 v83, v83, v8, v8
  v_rcp_f32 v80, v80
  v_mfma_f32_32x32x16_bf16 v[32:47], a[240:243], v[152:155], v[32:47]
  ds_read_b64_tr_b16 a[228:229], v11 offset:11264
  ds_read_b64_tr_b16 a[230:231], v11 offset:11776
  v_rcp_f32 v81, v81
  v_rcp_f32 v82, v82
  v_rcp_f32 v83, v83
  v_mfma_f32_32x32x16_bf16 v[32:47], a[244:247], v[156:159], v[32:47]
  s_waitcnt lgkmcnt(4)
  ds_read_b64_tr_b16 a[232:233], v11 offset:12288
  ds_read_b64_tr_b16 a[234:235], v11 offset:12800
  v_mul_f32 v80, v16, v80
  v_mul_f32 v81, v17, v81
  v_mul_f32 v82, v18, v82
  v_mul_f32 v83, v19, v83
  v_cvt_pk_bf16_f32 v96, v80, v81
  v_cvt_pk_bf16_f32 v97, v82, v83
  v_mfma_f32_32x32x16_bf16 v[32:47], a[216:219], v[160:163], v[32:47]
  ds_read_b64_tr_b16 a[236:237], v11 offset:13312
  ds_read_b64_tr_b16 a[238:239], v11 offset:13824
  v_mul_f32 v80, v20, v20
  v_mul_f32 v81, v21, v21
  v_mul_f32 v82, v22, v22
  v_mul_f32 v83, v23, v23
  v_fma_f32 v80, v80, v7, v6
  v_fma_f32 v81, v81, v7, v6
  v_fma_f32 v82, v82, v7, v6
  v_mfma_f32_32x32x16_bf16 v[32:47], a[220:223], v[164:167], v[32:47]
  s_waitcnt lgkmcnt(4)
  ds_read_b64_tr_b16 a[240:241], v11 offset:14336
  ds_read_b64_tr_b16 a[242:243], v11 offset:14848
  v_fma_f32 v83, v83, v7, v6
  v_mul_f32 v80, v20, v80
  v_mul_f32 v81, v21, v81
  v_mul_f32 v82, v22, v82
  v_mul_f32 v83, v23, v83
  v_exp_f32 v80, v80
  v_mfma_f32_32x32x16_bf16 v[32:47], a[224:227], v[168:171], v[32:47]
  ds_read_b64_tr_b16 a[244:245], v11 offset:15360
  ds_read_b64_tr_b16 a[246:247], v11 offset:15872
  v_exp_f32 v81, v81
  v_exp_f32 v82, v82
  v_exp_f32 v83, v83
  s_add_u32 m0, s56, 131072
  v_mfma_f32_32x32x16_bf16 v[32:47], a[228:231], v[172:175], v[32:47]
  s_waitcnt lgkmcnt(4)
  ds_read_b64_tr_b16 a[216:217], v11 offset:16384
  ds_read_b64_tr_b16 a[218:219], v11 offset:16896
  v_fma_f32 v80, v80, v8, v8
  v_fma_f32 v81, v81, v8, v8
  v_fma_f32 v82, v82, v8, v8
  v_fma_f32 v83, v83, v8, v8
  v_rcp_f32 v80, v80
  s_add_u32 s48, s54, 0
  v_mfma_f32_32x32x16_bf16 v[32:47], a[232:235], v[176:179], v[32:47]
  ds_read_b64_tr_b16 a[220:221], v11 offset:17408
  ds_read_b64_tr_b16 a[222:223], v11 offset:17920
  v_rcp_f32 v81, v81
  v_rcp_f32 v82, v82
  v_rcp_f32 v83, v83
  v_mul_f32 v80, v20, v80
  v_mfma_f32_32x32x16_bf16 v[32:47], a[236:239], v[180:183], v[32:47]
  s_waitcnt lgkmcnt(4)
  ds_read_b64_tr_b16 a[224:225], v11 offset:18432
  ds_read_b64_tr_b16 a[226:227], v11 offset:18944
  v_mul_f32 v81, v21, v81
  v_mul_f32 v82, v22, v82
  v_mul_f32 v83, v23, v83
  v_cvt_pk_bf16_f32 v98, v80, v81
  v_cvt_pk_bf16_f32 v99, v82, v83
  v_mul_f32 v80, v24, v24
  v_mfma_f32_32x32x16_bf16 v[32:47], a[240:243], v[184:187], v[32:47]
  ds_read_b64_tr_b16 a[228:229], v11 offset:19456
  ds_read_b64_tr_b16 a[230:231], v11 offset:19968
  v_mul_f32 v81, v25, v25
  v_mul_f32 v82, v26, v26
  v_mul_f32 v83, v27, v27
  v_fma_f32 v80, v80, v7, v6
  v_fma_f32 v81, v81, v7, v6
  v_fma_f32 v82, v82, v7, v6
  v_fma_f32 v83, v83, v7, v6
  v_mfma_f32_32x32x16_bf16 v[32:47], a[244:247], v[188:191], v[32:47]
  s_waitcnt lgkmcnt(4)
  ds_read_b64_tr_b16 a[232:233], v11 offset:20480
  ds_read_b64_tr_b16 a[234:235], v11 offset:20992
  v_mul_f32 v80, v24, v80
  v_mul_f32 v81, v25, v81
  v_mul_f32 v82, v26, v82
  v_mul_f32 v83, v27, v83
  v_exp_f32 v80, v80
  v_mfma_f32_32x32x16_bf16 v[32:47], a[216:219], v[192:195], v[32:47]
  ds_read_b64_tr_b16 a[236:237], v11 offset:21504
  ds_read_b64_tr_b16 a[238:239], v11 offset:22016
  buffer_load_dwordx4 v2, s[8:11], s48 offen lds
  v_exp_f32 v81, v81
  s_add_u32 m0, s56, 132096
  v_exp_f32 v82, v82
  s_add_u32 s48, s54, 49152
  v_mfma_f32_32x32x16_bf16 v[32:47], a[220:223], v[196:199], v[32:47]
  s_waitcnt lgkmcnt(4)
  ds_read_b64_tr_b16 a[240:241], v11 offset:22528
  ds_read_b64_tr_b16 a[242:243], v11 offset:23040
  v_exp_f32 v83, v83
  v_fma_f32 v80, v80, v8, v8
  v_fma_f32 v81, v81, v8, v8
  v_fma_f32 v82, v82, v8, v8
  v_fma_f32 v83, v83, v8, v8
  v_mfma_f32_32x32x16_bf16 v[32:47], a[224:227], v[200:203], v[32:47]
  ds_read_b64_tr_b16 a[244:245], v11 offset:23552
  ds_read_b64_tr_b16 a[246:247], v11 offset:24064
  buffer_load_dwordx4 v2, s[8:11], s48 offen lds
  v_rcp_f32 v80, v80
  s_add_u32 m0, s56, 133120
  v_rcp_f32 v81, v81
  s_add_u32 s48, s54, 98304
  v_mfma_f32_32x32x16_bf16 v[32:47], a[228:231], v[204:207], v[32:47]
  s_waitcnt lgkmcnt(4)
  ds_read_b64_tr_b16 a[216:217], v11 offset:24576
  ds_read_b64_tr_b16 a[218:219], v11 offset:25088
  v_rcp_f32 v82, v82
  s_add_u32 s49, s58, 0
  v_rcp_f32 v83, v83
  v_mul_f32 v80, v24, v80
  v_mul_f32 v81, v25, v81
  v_mfma_f32_32x32x16_bf16 v[32:47], a[232:235], v[208:211], v[32:47]
  ds_read_b64_tr_b16 a[220:221], v11 offset:25600
  ds_read_b64_tr_b16 a[222:223], v11 offset:26112
  v_mul_f32 v82, v26, v82
  v_mul_f32 v83, v27, v83
  v_cvt_pk_bf16_f32 v100, v80, v81
  v_cvt_pk_bf16_f32 v101, v82, v83
  v_mul_f32 v80, v28, v28
  v_mul_f32 v81, v29, v29
  v_mul_f32 v82, v30, v30
  v_mfma_f32_32x32x16_bf16 v[32:47], a[236:239], v[212:215], v[32:47]
  s_waitcnt lgkmcnt(4)
  ds_read_b64_tr_b16 a[224:225], v11 offset:26624
  ds_read_b64_tr_b16 a[226:227], v11 offset:27136
  buffer_load_dwordx4 v2, s[8:11], s48 offen lds
  v_mul_f32 v83, v31, v31
  v_fma_f32 v80, v80, v7, v6
  v_fma_f32 v81, v81, v7, v6
  v_mfma_f32_32x32x16_bf16 v[32:47], a[240:243], v[216:219], v[32:47]
  s_add_u32 m0, s56, 134144
  ds_read_b64_tr_b16 a[228:229], v11 offset:27648
  ds_read_b64_tr_b16 a[230:231], v11 offset:28160
  v_fma_f32 v82, v82, v7, v6
  v_fma_f32 v83, v83, v7, v6
  v_mul_f32 v80, v28, v80
  v_mul_f32 v81, v29, v81
  v_mul_f32 v82, v30, v82
  v_mul_f32 v83, v31, v83
  v_mfma_f32_32x32x16_bf16 v[32:47], a[244:247], v[220:223], v[32:47]
  s_waitcnt lgkmcnt(4)
  ds_read_b64_tr_b16 a[232:233], v11 offset:28672
  ds_read_b64_tr_b16 a[234:235], v11 offset:29184
  v_exp_f32 v80, v80
  s_add_u32 s48, s54, 147456
  v_exp_f32 v81, v81
  v_exp_f32 v82, v82
  v_exp_f32 v83, v83
  v_mfma_f32_32x32x16_bf16 v[32:47], a[216:219], v[224:227], v[32:47]
  ds_read_b64_tr_b16 a[236:237], v11 offset:29696
  ds_read_b64_tr_b16 a[238:239], v11 offset:30208
  buffer_store_dwordx4 v[96:99], v1, s[28:31], s49 offen offset:0 sc1
  buffer_load_dwordx4 v2, s[8:11], s48 offen lds
  v_fma_f32 v80, v80, v8, v8
  v_mfma_f32_32x32x16_bf16 v[32:47], a[220:223], v[228:231], v[32:47]
  s_waitcnt lgkmcnt(4)
  ds_read_b64_tr_b16 a[240:241], v11 offset:30720
  ds_read_b64_tr_b16 a[242:243], v11 offset:31232
  v_fma_f32 v81, v81, v8, v8
  v_fma_f32 v82, v82, v8, v8
  v_fma_f32 v83, v83, v8, v8
  v_rcp_f32 v80, v80
  s_lshl_b32 s49, s41, 8
  v_rcp_f32 v81, v81
  s_lshl_b32 s50, s44, 2
  v_mfma_f32_32x32x16_bf16 v[32:47], a[224:227], v[232:235], v[32:47]
  s_add_u32 s49, s49, s50
  ds_read_b64_tr_b16 a[244:245], v11 offset:31744
  ds_read_b64_tr_b16 a[246:247], v11 offset:32256
  s_waitcnt vmcnt(5)
  s_add_u32 s49, s49, 4096
  s_mov_b64 exec, 1
  buffer_store_dword v13, off, s[28:31], s49 sc0 sc1
  s_mov_b64 exec, -1
  s_add_u32 m0, s56, 135168
  s_add_u32 s48, s54, 196608
  buffer_load_dwordx4 v2, s[8:11], s48 offen lds
  v_mfma_f32_32x32x16_bf16 v[32:47], a[228:231], v[236:239], v[32:47]
  s_waitcnt lgkmcnt(4)
  s_barrier
  ds_read_b64_tr_b16 a[216:217], v5 offset:0
  ds_read_b64_tr_b16 a[218:219], v5 offset:512
  v_rcp_f32 v82, v82
  s_add_u32 m0, s56, 136192
  v_mfma_f32_32x32x16_bf16 v[32:47], a[232:235], v[240:243], v[32:47]
  s_add_u32 s48, s54, 245760
  ds_read_b64_tr_b16 a[220:221], v5 offset:1024
  ds_read_b64_tr_b16 a[222:223], v5 offset:1536
  v_rcp_f32 v83, v83
  s_add_u32 s49, s58, 0
  v_mul_f32 v80, v28, v80
  v_mul_f32 v81, v29, v81
  v_mul_f32 v82, v30, v82
  v_mul_f32 v83, v31, v83
  v_mfma_f32_32x32x16_bf16 v[32:47], a[236:239], v[244:247], v[32:47]
  s_waitcnt lgkmcnt(4)
  ds_read_b64_tr_b16 a[224:225], v5 offset:2048
  ds_read_b64_tr_b16 a[226:227], v5 offset:2560
  buffer_load_dwordx4 v2, s[8:11], s48 offen lds
  v_cvt_pk_bf16_f32 v102, v80, v81
  v_cvt_pk_bf16_f32 v103, v82, v83
  v_lshl_or_b32 v120, v126, 16, v126
  v_mfma_f32_32x32x16_bf16 v[32:47], a[240:243], v[248:251], v[32:47]
  s_add_u32 m0, s56, 137216
  ds_read_b64_tr_b16 a[228:229], v5 offset:3072
  ds_read_b64_tr_b16 a[230:231], v5 offset:3584
  buffer_store_dwordx4 v[100:103], v1, s[28:31], s49 offen offset:1024 sc1
  v_mfma_f32_32x32x16_bf16 v[32:47], a[244:247], v[252:255], v[32:47]
  s_waitcnt lgkmcnt(4)
  ds_read_b64_tr_b16 a[232:233], v5 offset:4096
  ds_read_b64_tr_b16 a[234:235], v5 offset:4608
  v_mfma_f32_32x32x16_bf16 v[16:31], v[120:123], v[84:87], 0
  s_add_u32 s48, s54, 294912
  v_mfma_f32_32x32x16_bf16 v[16:31], a[216:219], v[128:131], v[16:31]
  ds_read_b64_tr_b16 a[236:237], v5 offset:5120
  ds_read_b64_tr_b16 a[238:239], v5 offset:5632
  buffer_load_dwordx4 v2, s[8:11], s48 offen lds
  v_mfma_f32_32x32x16_bf16 v[16:31], a[220:223], v[132:135], v[16:31]
  s_waitcnt lgkmcnt(4)
  ds_read_b64_tr_b16 a[240:241], v5 offset:6144
  ds_read_b64_tr_b16 a[242:243], v5 offset:6656
  v_mfma_f32_32x32x16_bf16 v[16:31], a[224:227], v[136:139], v[16:31]
  s_add_u32 m0, s56, 138240
  ds_read_b64_tr_b16 a[244:245], v5 offset:7168
  ds_read_b64_tr_b16 a[246:247], v5 offset:7680
  s_add_u32 s48, s54, 344064
  buffer_load_dwordx4 v2, s[8:11], s48 offen lds
  v_add_u32 v11, 131072, v4
  v_mul_f32 v80, v32, v32
  v_mul_f32 v81, v33, v33
  v_mul_f32 v82, v34, v34
  v_mfma_f32_32x32x16_bf16 v[16:31], a[228:231], v[140:143], v[16:31]
  s_waitcnt lgkmcnt(4)
  ds_read_b64_tr_b16 a[216:217], v5 offset:8192
  ds_read_b64_tr_b16 a[218:219], v5 offset:8704
  v_mul_f32 v83, v35, v35
  v_fma_f32 v80, v80, v7, v6
  v_fma_f32 v81, v81, v7, v6
  v_fma_f32 v82, v82, v7, v6
  v_fma_f32 v83, v83, v7, v6
  v_mul_f32 v80, v32, v80
  v_mfma_f32_32x32x16_bf16 v[16:31], a[232:235], v[144:147], v[16:31]
  ds_read_b64_tr_b16 a[220:221], v5 offset:9216
  ds_read_b64_tr_b16 a[222:223], v5 offset:9728
  v_mul_f32 v81, v33, v81
  v_mul_f32 v82, v34, v82
  v_mul_f32 v83, v35, v83
  v_exp_f32 v80, v80
  v_exp_f32 v81, v81
  v_mfma_f32_32x32x16_bf16 v[16:31], a[236:239], v[148:151], v[16:31]
  s_waitcnt lgkmcnt(4)
  ds_read_b64_tr_b16 a[224:225], v5 offset:10240
  ds_read_b64_tr_b16 a[226:227], v5 offset:10752
  v_exp_f32 v82, v82
  v_exp_f32 v83, v83
  v_fma_f32 v80, v80, v8, v8
  v_fma_f32 v81, v81, v8, v8
  v_fma_f32 v82, v82, v8, v8
  v_mfma_f32_32x32x16_bf16 v[16:31], a[240:243], v[152:155], v[16:31]
  ds_read_b64_tr_b16 a[228:229], v5 offset:11264
  ds_read_b64_tr_b16 a[230:231], v5 offset:11776
  v_fma_f32 v83, v83, v8, v8
  v_rcp_f32 v80, v80
  v_rcp_f32 v81, v81
  v_rcp_f32 v82, v82
  v_mfma_f32_32x32x16_bf16 v[16:31], a[244:247], v[156:159], v[16:31]
  s_waitcnt lgkmcnt(4)
  ds_read_b64_tr_b16 a[232:233], v5 offset:12288
  ds_read_b64_tr_b16 a[234:235], v5 offset:12800
  v_rcp_f32 v83, v83
  v_mul_f32 v80, v32, v80
  v_mul_f32 v81, v33, v81
  v_mul_f32 v82, v34, v82
  v_mul_f32 v83, v35, v83
  v_mfma_f32_32x32x16_bf16 v[16:31], a[216:219], v[160:163], v[16:31]
  ds_read_b64_tr_b16 a[236:237], v5 offset:13312
  ds_read_b64_tr_b16 a[238:239], v5 offset:13824
  v_cvt_pk_bf16_f32 v104, v80, v81
  v_cvt_pk_bf16_f32 v105, v82, v83
  v_mul_f32 v80, v36, v36
  v_mul_f32 v81, v37, v37
  v_mul_f32 v82, v38, v38
  v_mul_f32 v83, v39, v39
  v_fma_f32 v80, v80, v7, v6
  v_mfma_f32_32x32x16_bf16 v[16:31], a[220:223], v[164:167], v[16:31]
  s_waitcnt lgkmcnt(4)
  ds_read_b64_tr_b16 a[240:241], v5 offset:14336
  ds_read_b64_tr_b16 a[242:243], v5 offset:14848
  v_fma_f32 v81, v81, v7, v6
  v_fma_f32 v82, v82, v7, v6
  v_fma_f32 v83, v83, v7, v6
  v_mul_f32 v80, v36, v80
  v_mul_f32 v81, v37, v81
  v_mul_f32 v82, v38, v82
  v_mfma_f32_32x32x16_bf16 v[16:31], a[224:227], v[168:171], v[16:31]
  ds_read_b64_tr_b16 a[244:245], v5 offset:15360
  ds_read_b64_tr_b16 a[246:247], v5 offset:15872
  v_mul_f32 v83, v39, v83
  v_exp_f32 v80, v80
  v_exp_f32 v81, v81
  v_exp_f32 v82, v82
  v_mfma_f32_32x32x16_bf16 v[16:31], a[228:231], v[172:175], v[16:31]
  s_waitcnt lgkmcnt(4)
  ds_read_b64_tr_b16 a[216:217], v5 offset:16384
  ds_read_b64_tr_b16 a[218:219], v5 offset:16896
  v_exp_f32 v83, v83
  v_fma_f32 v80, v80, v8, v8
  v_fma_f32 v81, v81, v8, v8
  v_fma_f32 v82, v82, v8, v8
  v_fma_f32 v83, v83, v8, v8
  v_mfma_f32_32x32x16_bf16 v[16:31], a[232:235], v[176:179], v[16:31]
  ds_read_b64_tr_b16 a[220:221], v5 offset:17408
  ds_read_b64_tr_b16 a[222:223], v5 offset:17920
  v_rcp_f32 v80, v80
  v_rcp_f32 v81, v81
  v_rcp_f32 v82, v82
  v_rcp_f32 v83, v83
  v_mfma_f32_32x32x16_bf16 v[16:31], a[236:239], v[180:183], v[16:31]
  s_waitcnt lgkmcnt(4)
  ds_read_b64_tr_b16 a[224:225], v5 offset:18432
  ds_read_b64_tr_b16 a[226:227], v5 offset:18944
  v_mul_f32 v80, v36, v80
  v_mul_f32 v81, v37, v81
  v_mul_f32 v82, v38, v82
  v_mul_f32 v83, v39, v83
  v_cvt_pk_bf16_f32 v106, v80, v81
  v_cvt_pk_bf16_f32 v107, v82, v83
  v_mfma_f32_32x32x16_bf16 v[16:31], a[240:243], v[184:187], v[16:31]
  ds_read_b64_tr_b16 a[228:229], v5 offset:19456
  ds_read_b64_tr_b16 a[230:231], v5 offset:19968
  v_mul_f32 v80, v40, v40
  v_mul_f32 v81, v41, v41
  v_mul_f32 v82, v42, v42
  v_mul_f32 v83, v43, v43
  v_fma_f32 v80, v80, v7, v6
  v_fma_f32 v81, v81, v7, v6
  v_mfma_f32_32x32x16_bf16 v[16:31], a[244:247], v[188:191], v[16:31]
  s_waitcnt lgkmcnt(4)
  ds_read_b64_tr_b16 a[232:233], v5 offset:20480
  ds_read_b64_tr_b16 a[234:235], v5 offset:20992
  v_fma_f32 v82, v82, v7, v6
  v_fma_f32 v83, v83, v7, v6
  v_mul_f32 v80, v40, v80
  v_mul_f32 v81, v41, v81
  v_mul_f32 v82, v42, v82
  v_mul_f32 v83, v43, v83
  v_exp_f32 v80, v80
  v_mfma_f32_32x32x16_bf16 v[16:31], a[216:219], v[192:195], v[16:31]
  ds_read_b64_tr_b16 a[236:237], v5 offset:21504
  ds_read_b64_tr_b16 a[238:239], v5 offset:22016
  v_exp_f32 v81, v81
  v_exp_f32 v82, v82
  v_exp_f32 v83, v83
  v_mfma_f32_32x32x16_bf16 v[16:31], a[220:223], v[196:199], v[16:31]
  s_waitcnt lgkmcnt(4)
  ds_read_b64_tr_b16 a[240:241], v5 offset:22528
  ds_read_b64_tr_b16 a[242:243], v5 offset:23040
  v_fma_f32 v80, v80, v8, v8
  v_fma_f32 v81, v81, v8, v8
  v_fma_f32 v82, v82, v8, v8
  v_fma_f32 v83, v83, v8, v8
  v_rcp_f32 v80, v80
  s_lshl_b32 s50, s40, 2
  v_mfma_f32_32x32x16_bf16 v[16:31], a[224:227], v[200:203], v[16:31]
  s_sub_u32 s50, s50, 8
  ds_read_b64_tr_b16 a[244:245], v5 offset:23552
  ds_read_b64_tr_b16 a[246:247], v5 offset:24064
  v_rcp_f32 v81, v81
  v_rcp_f32 v82, v82
  v_rcp_f32 v83, v83
  v_mul_f32 v80, v40, v80
  v_mfma_f32_32x32x16_bf16 v[16:31], a[228:231], v[204:207], v[16:31]
  s_waitcnt lgkmcnt(4)
  ds_read_b64_tr_b16 a[216:217], v5 offset:24576
  ds_read_b64_tr_b16 a[218:219], v5 offset:25088
  v_mul_f32 v81, v41, v81
  v_mul_f32 v82, v42, v82
  v_mul_f32 v83, v43, v83
  v_cvt_pk_bf16_f32 v108, v80, v81
  v_cvt_pk_bf16_f32 v109, v82, v83
  v_mul_f32 v80, v44, v44
  v_mul_f32 v81, v45, v45
  v_mfma_f32_32x32x16_bf16 v[16:31], a[232:235], v[208:211], v[16:31]
  ds_read_b64_tr_b16 a[220:221], v5 offset:25600
  ds_read_b64_tr_b16 a[222:223], v5 offset:26112
  v_mul_f32 v82, v46, v46
  v_mul_f32 v83, v47, v47
  v_fma_f32 v80, v80, v7, v6
  v_fma_f32 v81, v81, v7, v6
  v_fma_f32 v82, v82, v7, v6
  v_fma_f32 v83, v83, v7, v6
  v_mfma_f32_32x32x16_bf16 v[16:31], a[236:239], v[212:215], v[16:31]
  s_waitcnt lgkmcnt(4)
  ds_read_b64_tr_b16 a[224:225], v5 offset:26624
  ds_read_b64_tr_b16 a[226:227], v5 offset:27136
  v_mul_f32 v80, v44, v80
  v_mul_f32 v81, v45, v81
  v_mul_f32 v82, v46, v82
  v_mul_f32 v83, v47, v83
  v_exp_f32 v80, v80
  v_mfma_f32_32x32x16_bf16 v[16:31], a[240:243], v[216:219], v[16:31]
  ds_read_b64_tr_b16 a[228:229], v5 offset:27648
  ds_read_b64_tr_b16 a[230:231], v5 offset:28160
  v_min_u32 v12, 11, v0
  v_add_u32 v12, s50, v12
  v_max_i32 v12, 0, v12
  v_lshlrev_b32 v12, 2, v12
  s_lshl_b32 s50, s41, 8
  s_add_u32 s50, s50, 4096
  buffer_load_dword v14, v12, s[28:31], s50 offen sc1
  v_mfma_f32_32x32x16_bf16 v[16:31], a[244:247], v[220:223], v[16:31]
  s_waitcnt lgkmcnt(4)
  ds_read_b64_tr_b16 a[232:233], v5 offset:28672
  ds_read_b64_tr_b16 a[234:235], v5 offset:29184
  v_exp_f32 v81, v81
  s_add_u32 s49, s58, 2048
  v_exp_f32 v82, v82
  s_mul_i32 s50, s42, 4160
  v_exp_f32 v83, v83
  s_add_u32 s50, s50, 32768
  v_mfma_f32_32x32x16_bf16 v[16:31], a[216:219], v[224:227], v[16:31]
  ds_read_b64_tr_b16 a[236:237], v5 offset:29696
  ds_read_b64_tr_b16 a[238:239], v5 offset:30208
  buffer_store_dwordx4 v[104:107], v1, s[28:31], s49 offen offset:0 sc1
  v_fma_f32 v80, v80, v8, v8
  v_fma_f32 v81, v81, v8, v8
  v_fma_f32 v82, v82, v8, v8
  v_fma_f32 v83, v83, v8, v8
  v_mfma_f32_32x32x16_bf16 v[16:31], a[220:223], v[228:231], v[16:31]
  s_waitcnt lgkmcnt(4)
  ds_read_b64_tr_b16 a[240:241], v5 offset:30720
  ds_read_b64_tr_b16 a[242:243], v5 offset:31232
  v_rcp_f32 v80, v80
  s_mul_i32 s17, s42, 12480
  v_rcp_f32 v81, v81
  v_rcp_f32 v82, v82
  v_mfma_f32_32x32x16_bf16 v[16:31], a[224:227], v[232:235], v[16:31]
  ds_read_b64_tr_b16 a[244:245], v5 offset:31744
  ds_read_b64_tr_b16 a[246:247], v5 offset:32256
  v_rcp_f32 v83, v83
  v_mul_f32 v80, v44, v80
  v_mul_f32 v81, v45, v81
  v_mul_f32 v82, v46, v82
  v_mul_f32 v83, v47, v83
  v_cvt_pk_bf16_f32 v110, v80, v81
  v_mfma_f32_32x32x16_bf16 v[16:31], a[228:231], v[236:239], v[16:31]
  s_waitcnt lgkmcnt(4)
  s_waitcnt vmcnt(2)
  s_barrier
  ds_read_b64_tr_b16 a[216:217], v11 offset:0
  ds_read_b64_tr_b16 a[218:219], v11 offset:512
  v_cvt_pk_bf16_f32 v111, v82, v83
  v_add_u32 v3, s50, v1
  v_add_u32 v124, 2048, v3
  v_add_u32 v125, 3072, v3
  s_add_u32 s50, s50, 4096
  v_mov_b32 v15, s50
  v_mfma_f32_32x32x16_bf16 v[16:31], a[232:235], v[240:243], v[16:31]
  s_lshl_b32 s50, s41, 6
  ds_read_b64_tr_b16 a[220:221], v11 offset:1024
  ds_read_b64_tr_b16 a[222:223], v11 offset:1536
  v_cndmask_b32 v126, v15, v124, s[68:69]
  v_cndmask_b32 v127, v15, v125, s[68:69]
  v_cndmask_b32 v124, v124, v15, s[68:69]
  v_cndmask_b32 v125, v125, v15, s[68:69]
  v_mfma_f32_32x32x16_bf16 v[16:31], a[236:239], v[244:247], v[16:31]
  s_waitcnt lgkmcnt(4)
  ds_read_b64_tr_b16 a[224:225], v11 offset:2048
  ds_read_b64_tr_b16 a[226:227], v11 offset:2560
  s_lshl_b32 s51, s40, 2
  s_add_u32 s50, s50, s51
  s_mul_i32 s51, s42, 3
  s_add_u32 s50, s50, s51
  s_lshl_b32 s16, s50, 12
  s_add_u32 s16, s16, 32768
  v_mfma_f32_32x32x16_bf16 v[16:31], a[240:243], v[248:251], v[16:31]
  s_add_u32 s49, s58, 2048
  ds_read_b64_tr_b16 a[228:229], v11 offset:3072
  ds_read_b64_tr_b16 a[230:231], v11 offset:3584
  buffer_store_dwordx4 v[108:111], v1, s[28:31], s49 offen offset:1024 sc1
  v_mfma_f32_32x32x16_bf16 v[16:31], a[244:247], v[252:255], v[16:31]
  s_waitcnt lgkmcnt(4)
  ds_read_b64_tr_b16 a[232:233], v11 offset:4096
  ds_read_b64_tr_b16 a[234:235], v11 offset:4608
  v_mfma_f32_32x32x16_bf16 v[32:47], a[216:219], v[128:131], 0
  ds_read_b64_tr_b16 a[236:237], v11 offset:5120
  ds_read_b64_tr_b16 a[238:239], v11 offset:5632
  v_mfma_f32_32x32x16_bf16 v[32:47], a[220:223], v[132:135], v[32:47]
  s_waitcnt lgkmcnt(4)
  ds_read_b64_tr_b16 a[240:241], v11 offset:6144
  ds_read_b64_tr_b16 a[242:243], v11 offset:6656
  v_mfma_f32_32x32x16_bf16 v[32:47], a[224:227], v[136:139], v[32:47]
  ds_read_b64_tr_b16 a[244:245], v11 offset:7168
  ds_read_b64_tr_b16 a[246:247], v11 offset:7680
  s_waitcnt vmcnt(2)
  v_cmp_ne_u32 vcc, s43, v14
  s_nop 0
  s_cbranch_vccnz L_spin_kv1
L_back_kv1:
  v_min_u32 v15, 11, v0
  s_lshl_b32 s50, s40, 2
  s_sub_u32 s50, s50, 8
  v_add_u32 v14, s50, v15
  v_cmp_le_i32 s[18:19], 0, v14
  s_movk_i32 s50, 4160
  v_mul_u32_u24 v15, s50, v15
  v_add_u32 v15, 36864, v15
  v_mov_b32 v14, 0x3f803f80
  v_cndmask_b32 v14, 0, v14, s[18:19]
  ds_write2_b32 v15, v14, v14 offset0:0 offset1:1
  ds_write2_b32 v15, v14, v14 offset0:2 offset1:3
  v_mfma_f32_32x32x16_bf16 v[32:47], a[228:231], v[140:143], v[32:47]
  s_waitcnt lgkmcnt(6)
  ds_read_b64_tr_b16 a[216:217], v11 offset:8192
  ds_read_b64_tr_b16 a[218:219], v11 offset:8704
  s_mul_i32 s50, s42, 3
  s_lshl_b32 s51, s40, 2
  s_add_u32 s50, s50, s51
  s_add_u32 s50, s50, 0
  s_cmp_lt_u32 s50, 8
  s_cselect_b32 s50, 0x40000000, 0
  v_add_u32 v12, s50, v1
  s_add_u32 m0, s17, 32768
  s_add_u32 s18, s16, 0
  buffer_load_dwordx4 v12, s[28:31], s18 offen offset:0 sc1 lds
  v_mfma_f32_32x32x16_bf16 v[32:47], a[232:235], v[144:147], v[32:47]
  s_mul_i32 s50, s42, 3
  ds_read_b64_tr_b16 a[220:221], v11 offset:9216
  ds_read_b64_tr_b16 a[222:223], v11 offset:9728
  buffer_load_dwordx4 v12, s[28:31], s18 offen offset:1024 sc1 lds
  v_mfma_f32_32x32x16_bf16 v[32:47], a[236:239], v[148:151], v[32:47]
  s_waitcnt lgkmcnt(6)
  ds_read_b64_tr_b16 a[224:225], v11 offset:10240
  ds_read_b64_tr_b16 a[226:227], v11 offset:10752
  buffer_load_dwordx4 v12, s[28:31], s18 offen offset:2048 sc1 lds
  v_mul_f32 v80, v16, v16
  v_mul_f32 v81, v17, v17
  v_mul_f32 v82, v18, v18
  v_mfma_f32_32x32x16_bf16 v[32:47], a[240:243], v[152:155], v[32:47]
  s_lshl_b32 s51, s40, 2
  ds_read_b64_tr_b16 a[228:229], v11 offset:11264
  ds_read_b64_tr_b16 a[230:231], v11 offset:11776
  buffer_load_dwordx4 v12, s[28:31], s18 offen offset:3072 sc1 lds
  v_mul_f32 v83, v19, v19
  v_fma_f32 v80, v80, v7, v6
  v_fma_f32 v81, v81, v7, v6
  v_fma_f32 v82, v82, v7, v6
  v_fma_f32 v83, v83, v7, v6
  v_mul_f32 v80, v16, v80
  v_mul_f32 v81, v17, v81
  v_mfma_f32_32x32x16_bf16 v[32:47], a[244:247], v[156:159], v[32:47]
  s_waitcnt lgkmcnt(4)
  ds_read_b64_tr_b16 a[232:233], v11 offset:12288
  ds_read_b64_tr_b16 a[234:235], v11 offset:12800
  v_mul_f32 v82, v18, v82
  v_mul_f32 v83, v19, v83
  v_exp_f32 v80, v80
  s_add_u32 s50, s50, s51
  v_exp_f32 v81, v81
  s_add_u32 s50, s50, 1
  v_exp_f32 v82, v82
  s_cmp_lt_u32 s50, 8
  v_mfma_f32_32x32x16_bf16 v[32:47], a[216:219], v[160:163], v[32:47]
  s_cselect_b32 s50, 0x40000000, 0
  ds_read_b64_tr_b16 a[236:237], v11 offset:13312
  ds_read_b64_tr_b16 a[238:239], v11 offset:13824
  v_add_u32 v12, s50, v1
  s_add_u32 m0, s17, 36928
  s_add_u32 s18, s16, 4096
  buffer_load_dwordx4 v12, s[28:31], s18 offen offset:0 sc1 lds
  v_mfma_f32_32x32x16_bf16 v[32:47], a[220:223], v[164:167], v[32:47]
  s_waitcnt lgkmcnt(4)
  ds_read_b64_tr_b16 a[240:241], v11 offset:14336
  ds_read_b64_tr_b16 a[242:243], v11 offset:14848
  buffer_load_dwordx4 v12, s[28:31], s18 offen offset:1024 sc1 lds
  v_exp_f32 v83, v83
  s_mul_i32 s50, s42, 3
  v_fma_f32 v80, v80, v8, v8
  v_fma_f32 v81, v81, v8, v8
  v_mfma_f32_32x32x16_bf16 v[32:47], a[224:227], v[168:171], v[32:47]
  s_lshl_b32 s51, s40, 2
  ds_read_b64_tr_b16 a[244:245], v11 offset:15360
  ds_read_b64_tr_b16 a[246:247], v11 offset:15872
  buffer_load_dwordx4 v12, s[28:31], s18 offen offset:2048 sc1 lds
  v_fma_f32 v82, v82, v8, v8
  v_fma_f32 v83, v83, v8, v8
  v_rcp_f32 v80, v80
  s_add_u32 s50, s50, s51
  v_rcp_f32 v81, v81
  s_add_u32 s50, s50, 2
  v_mfma_f32_32x32x16_bf16 v[32:47], a[228:231], v[172:175], v[32:47]
  s_waitcnt lgkmcnt(4)
  ds_read_b64_tr_b16 a[216:217], v11 offset:16384
  ds_read_b64_tr_b16 a[218:219], v11 offset:16896
  v_rcp_f32 v82, v82
  s_cmp_lt_u32 s50, 8
  v_rcp_f32 v83, v83
  s_cselect_b32 s50, 0x40000000, 0
  v_mul_f32 v80, v16, v80
  v_mul_f32 v81, v17, v81
  v_mul_f32 v82, v18, v82
  v_mul_f32 v83, v19, v83
  v_cvt_pk_bf16_f32 v96, v80, v81
  v_mfma_f32_32x32x16_bf16 v[32:47], a[232:235], v[176:179], v[32:47]
  ds_read_b64_tr_b16 a[220:221], v11 offset:17408
  ds_read_b64_tr_b16 a[222:223], v11 offset:17920
  buffer_load_dwordx4 v12, s[28:31], s18 offen offset:3072 sc1 lds
  v_cvt_pk_bf16_f32 v97, v82, v83
  v_mul_f32 v80, v20, v20
  v_mul_f32 v81, v21, v21
  v_mul_f32 v82, v22, v22
  v_mul_f32 v83, v23, v23
  v_fma_f32 v80, v80, v7, v6
  v_mfma_f32_32x32x16_bf16 v[32:47], a[236:239], v[180:183], v[32:47]
  s_waitcnt lgkmcnt(4)
  ds_read_b64_tr_b16 a[224:225], v11 offset:18432
  ds_read_b64_tr_b16 a[226:227], v11 offset:18944
  v_add_u32 v12, s50, v1
  s_add_u32 m0, s17, 41088
  s_add_u32 s18, s16, 8192
  buffer_load_dwordx4 v12, s[28:31], s18 offen offset:0 sc1 lds
  v_mfma_f32_32x32x16_bf16 v[32:47], a[240:243], v[184:187], v[32:47]
  ds_read_b64_tr_b16 a[228:229], v11 offset:19456
  ds_read_b64_tr_b16 a[230:231], v11 offset:19968
  buffer_load_dwordx4 v12, s[28:31], s18 offen offset:1024 sc1 lds
  v_fma_f32 v81, v81, v7, v6
  v_fma_f32 v82, v82, v7, v6
  v_fma_f32 v83, v83, v7, v6
  v_mul_f32 v80, v20, v80
  v_mul_f32 v81, v21, v81
  v_mfma_f32_32x32x16_bf16 v[32:47], a[244:247], v[188:191], v[32:47]
  s_waitcnt lgkmcnt(4)
  ds_read_b64_tr_b16 a[232:233], v11 offset:20480
  ds_read_b64_tr_b16 a[234:235], v11 offset:20992
  v_mul_f32 v82, v22, v82
  v_mul_f32 v83, v23, v83
  v_exp_f32 v80, v80
  v_exp_f32 v81, v81
  v_exp_f32 v82, v82
  v_mfma_f32_32x32x16_bf16 v[32:47], a[216:219], v[192:195], v[32:47]
  ds_read_b64_tr_b16 a[236:237], v11 offset:21504
  ds_read_b64_tr_b16 a[238:239], v11 offset:22016
  buffer_load_dwordx4 v12, s[28:31], s18 offen offset:2048 sc1 lds
  v_exp_f32 v83, v83
  v_fma_f32 v80, v80, v8, v8
  v_fma_f32 v81, v81, v8, v8
  v_fma_f32 v82, v82, v8, v8
  v_fma_f32 v83, v83, v8, v8
  v_mfma_f32_32x32x16_bf16 v[32:47], a[220:223], v[196:199], v[32:47]
  s_waitcnt lgkmcnt(4)
  ds_read_b64_tr_b16 a[240:241], v11 offset:22528
  ds_read_b64_tr_b16 a[242:243], v11 offset:23040
  buffer_load_dwordx4 v12, s[28:31], s18 offen offset:3072 sc1 lds
  v_rcp_f32 v80, v80
  v_rcp_f32 v81, v81
  v_rcp_f32 v82, v82
  v_rcp_f32 v83, v83
  v_mfma_f32_32x32x16_bf16 v[32:47], a[224:227], v[200:203], v[32:47]
  ds_read_b64_tr_b16 a[244:245], v11 offset:23552
  ds_read_b64_tr_b16 a[246:247], v11 offset:24064
  v_mul_f32 v80, v20, v80
  v_mul_f32 v81, v21, v81
  v_mul_f32 v82, v22, v82
  v_mul_f32 v83, v23, v83
  v_cvt_pk_bf16_f32 v98, v80, v81
  v_cvt_pk_bf16_f32 v99, v82, v83
  v_mul_f32 v80, v24, v24
  v_mfma_f32_32x32x16_bf16 v[32:47], a[228:231], v[204:207], v[32:47]
  s_waitcnt lgkmcnt(4)
  ds_read_b64_tr_b16 a[216:217], v11 offset:24576
  ds_read_b64_tr_b16 a[218:219], v11 offset:25088
  v_mul_f32 v81, v25, v25
  v_mul_f32 v82, v26, v26
  v_mul_f32 v83, v27, v27
  v_fma_f32 v80, v80, v7, v6
  v_fma_f32 v81, v81, v7, v6
  v_fma_f32 v82, v82, v7, v6
  v_fma_f32 v83, v83, v7, v6
  v_mul_f32 v80, v24, v80
  v_mfma_f32_32x32x16_bf16 v[32:47], a[232:235], v[208:211], v[32:47]
  s_add_u32 s49, s58, 4096
  ds_read_b64_tr_b16 a[220:221], v11 offset:25600
  ds_read_b64_tr_b16 a[222:223], v11 offset:26112
  v_mul_f32 v81, v25, v81
  v_mul_f32 v82, v26, v82
  v_mul_f32 v83, v27, v83
  v_exp_f32 v80, v80
  v_exp_f32 v81, v81
  v_mfma_f32_32x32x16_bf16 v[32:47], a[236:239], v[212:215], v[32:47]
  s_waitcnt lgkmcnt(4)
  ds_read_b64_tr_b16 a[224:225], v11 offset:26624
  ds_read_b64_tr_b16 a[226:227], v11 offset:27136
  v_exp_f32 v82, v82
  v_exp_f32 v83, v83
  v_fma_f32 v80, v80, v8, v8
  v_fma_f32 v81, v81, v8, v8
  v_fma_f32 v82, v82, v8, v8
  v_fma_f32 v83, v83, v8, v8
  v_mfma_f32_32x32x16_bf16 v[32:47], a[240:243], v[216:219], v[32:47]
  ds_read_b64_tr_b16 a[228:229], v11 offset:27648
  ds_read_b64_tr_b16 a[230:231], v11 offset:28160
  v_rcp_f32 v80, v80
  v_rcp_f32 v81, v81
  v_rcp_f32 v82, v82
  v_rcp_f32 v83, v83
  v_mfma_f32_32x32x16_bf16 v[32:47], a[244:247], v[220:223], v[32:47]
  s_waitcnt lgkmcnt(4)
  ds_read_b64_tr_b16 a[232:233], v11 offset:28672
  ds_read_b64_tr_b16 a[234:235], v11 offset:29184
  v_mul_f32 v80, v24, v80
  v_mul_f32 v81, v25, v81
  v_mul_f32 v82, v26, v82
  v_mul_f32 v83, v27, v83
  v_cvt_pk_bf16_f32 v100, v80, v81
  v_cvt_pk_bf16_f32 v101, v82, v83
  v_mul_f32 v80, v28, v28
  v_mul_f32 v81, v29, v29
  v_mfma_f32_32x32x16_bf16 v[32:47], a[216:219], v[224:227], v[32:47]
  s_lshl_b32 s50, s46, 2
  ds_read_b64_tr_b16 a[236:237], v11 offset:29696
  ds_read_b64_tr_b16 a[238:239], v11 offset:30208
  buffer_store_dwordx4 v[96:99], v1, s[28:31], s49 offen offset:0 sc1
  v_mul_f32 v82, v30, v30
  v_mul_f32 v83, v31, v31
  v_fma_f32 v80, v80, v7, v6
  v_fma_f32 v81, v81, v7, v6
  v_fma_f32 v82, v82, v7, v6
  v_mfma_f32_32x32x16_bf16 v[32:47], a[220:223], v[228:231], v[32:47]
  s_waitcnt lgkmcnt(4)
  ds_read_b64_tr_b16 a[240:241], v11 offset:30720
  ds_read_b64_tr_b16 a[242:243], v11 offset:31232
  v_fma_f32 v83, v83, v7, v6
  v_mul_f32 v80, v28, v80
  v_mul_f32 v81, v29, v81
  v_mul_f32 v82, v30, v82
  v_mul_f32 v83, v31, v83
  v_exp_f32 v80, v80
  s_add_u32 s50, s50, s42
  v_exp_f32 v81, v81
  s_lshl_b32 s50, s50, 12
  v_mfma_f32_32x32x16_bf16 v[32:47], a[224:227], v[232:235], v[32:47]
  ds_read_b64_tr_b16 a[244:245], v11 offset:31744
  ds_read_b64_tr_b16 a[246:247], v11 offset:32256
  v_exp_f32 v82, v82
  v_exp_f32 v83, v83
  v_fma_f32 v80, v80, v8, v8
  v_fma_f32 v81, v81, v8, v8
  v_fma_f32 v82, v82, v8, v8
  v_mfma_f32_32x32x16_bf16 v[32:47], a[228:231], v[236:239], v[32:47]
  s_waitcnt lgkmcnt(4)
  v_fma_f32 v83, v83, v8, v8
  v_rcp_f32 v80, v80
  v_rcp_f32 v81, v81
  v_rcp_f32 v82, v82
  v_mfma_f32_32x32x16_bf16 v[32:47], a[232:235], v[240:243], v[32:47]
  v_bfe_u32 v14, v0, 3, 2
  v_and_b32 v15, 7, v0
  v_lshlrev_b32 v15, 7, v15
  v_lshl_add_u32 v15, v14, 10, v15
  buffer_load_dword a249, v15, s[12:15], s50 offen
  v_mfma_f32_32x32x16_bf16 v[32:47], a[236:239], v[244:247], v[32:47]
  s_waitcnt lgkmcnt(0)
  v_rcp_f32 v83, v83
  v_mul_f32 v80, v28, v80
  v_mul_f32 v81, v29, v81
  v_mul_f32 v82, v30, v82
  v_mul_f32 v83, v31, v83
  v_cvt_pk_bf16_f32 v102, v80, v81
  v_cvt_pk_bf16_f32 v103, v82, v83
  v_mfma_f32_32x32x16_bf16 v[32:47], a[240:243], v[248:251], v[32:47]
  s_add_u32 s49, s58, 4096
  buffer_store_dwordx4 v[100:103], v1, s[28:31], s49 offen offset:1024 sc1
  v_mfma_f32_32x32x16_bf16 v[32:47], a[244:247], v[252:255], v[32:47]
  s_waitcnt vmcnt(3)
  s_barrier
  ds_read_b128 a[0:3], v3 offset:0
  ds_read_b128 a[64:67], v3 offset:33280
  ds_read_b128 a[8:11], v3 offset:4160
  ds_read_b128 a[16:19], v3 offset:8320
  s_nop 5
  v_mul_f32 v32, v32, v10
  v_mul_f32 v33, v33, v10
  v_mul_f32 v34, v34, v10
  v_mul_f32 v35, v35, v10
  v_cvt_pk_bf16_f32 v112, v32, v33
  v_cvt_pk_bf16_f32 v113, v34, v35
  v_mul_f32 v36, v36, v10
  v_mul_f32 v37, v37, v10
  v_mul_f32 v38, v38, v10
  v_mul_f32 v39, v39, v10
  v_cvt_pk_bf16_f32 v114, v36, v37
  v_cvt_pk_bf16_f32 v115, v38, v39
  v_mul_f32 v40, v40, v10
  v_mul_f32 v41, v41, v10
  v_mul_f32 v42, v42, v10
  v_mul_f32 v43, v43, v10
  v_cvt_pk_bf16_f32 v116, v40, v41
  v_cvt_pk_bf16_f32 v117, v42, v43
  v_mul_f32 v44, v44, v10
  v_mul_f32 v45, v45, v10
  v_mul_f32 v46, v46, v10
  v_mul_f32 v47, v47, v10
  v_cvt_pk_bf16_f32 v118, v44, v45
  v_cvt_pk_bf16_f32 v119, v46, v47
L_join1:
  s_waitcnt lgkmcnt(3)
  v_mfma_f32_32x32x16_bf16 v[16:31], a[0:3], v[112:115], 0
  s_waitcnt lgkmcnt(2)
  v_mfma_f32_32x32x16_bf16 v[64:79], a[64:67], v[112:115], 0
  s_waitcnt lgkmcnt(1)
  v_mfma_f32_32x32x16_bf16 v[32:47], a[8:11], v[112:115], 0
  s_and_b32 s50, s41, 7
  s_nop 8
  v_cndmask_b32 v16, v16, v64, s[70:71]
  v_cndmask_b32 v17, v17, v65, s[72:73]
  v_cndmask_b32 v18, v18, v66, s[74:75]
  v_cndmask_b32 v19, v19, v67, s[76:77]
  ds_read_b128 a[72:75], v124 offset:0
  v_lshrrev_b32 v15, 3, v0
  ds_read_b128 a[80:83], v125 offset:0
  v_lshlrev_b32 v15, 10, v15
  v_cndmask_b32 v20, v20, v68, s[78:79]
  v_cndmask_b32 v21, v21, v69, s[80:81]
  v_cndmask_b32 v22, v22, v70, s[82:83]
  v_cndmask_b32 v23, v23, v71, s[84:85]
  ds_read_b128 a[200:203], v124 offset:33280
  v_bfe_u32 v2, v0, 4, 1
  ds_read_b128 a[208:211], v125 offset:33280
  v_lshlrev_b32 v2, 2, v2
  v_cndmask_b32 v24, v24, v72, s[86:87]
  v_cndmask_b32 v25, v25, v73, s[88:89]
  v_cndmask_b32 v26, v26, v74, s[90:91]
  v_cndmask_b32 v27, v27, v75, s[92:93]
  ds_read_b128 a[24:27], v3 offset:12480
  v_xor_b32 v2, v2, v0
  ds_read_b128 a[88:91], v124 offset:4160
  v_and_b32 v2, 7, v2
  v_cndmask_b32 v28, v28, v76, s[94:95]
  v_cndmask_b32 v29, v29, v77, s[96:97]
  v_cndmask_b32 v30, v30, v78, s[98:99]
  v_cndmask_b32 v31, v31, v79, s[100:101]
  ds_read_b128 a[96:99], v125 offset:4160
  v_lshl_add_u32 v2, v2, 4, v15
  ds_read_b128 a[32:35], v3 offset:16640
  v_exp_f32 v16, v16
  v_exp_f32 v17, v17
  v_exp_f32 v18, v18
  v_exp_f32 v19, v19
  s_and_b32 s51, s40, 3
  s_lshl_b32 s51, s51, 1
  s_add_u32 s10, s50, s51
  s_cmp_ge_u32 s10, 7
  v_exp_f32 v20, v20
  s_cselect_b32 s50, 7, 0
  v_exp_f32 v21, v21
  s_sub_u32 s10, s10, s50
  v_exp_f32 v22, v22
  s_mov_b32 s8, s10
  v_exp_f32 v23, v23
  s_lshr_b32 s50, s42, 1
  v_cvt_pk_bf16_f32 v96, v16, v17
  v_cvt_pk_bf16_f32 v97, v18, v19
  v_exp_f32 v24, v24
  s_mul_i32 s59, s50, 917504
  v_exp_f32 v25, v25
  s_lshl_b32 s52, s50, 18
  v_exp_f32 v26, v26
  s_and_b32 s50, s42, 1
  v_exp_f32 v27, v27
  s_lshl_b32 s50, s50, 16
  v_cvt_pk_bf16_f32 v98, v20, v21
  v_cvt_pk_bf16_f32 v99, v22, v23
  v_exp_f32 v28, v28
  s_add_u32 s59, s59, s50
  v_exp_f32 v29, v29
  s_add_u32 s52, s52, s50
  v_exp_f32 v30, v30
  s_and_b32 s50, s41, 7
  v_exp_f32 v31, v31
  s_lshl_b32 s50, s50, 7
  v_cvt_pk_bf16_f32 v100, v24, v25
  v_cvt_pk_bf16_f32 v101, v26, v27
  v_cvt_pk_bf16_f32 v102, v28, v29
  v_cvt_pk_bf16_f32 v103, v30, v31
  s_add_u32 s59, s59, s50
  s_add_u32 s52, s52, s50
  v_bfi_b32 v80, v88, 0, v96
  v_bfi_b32 v81, v89, 0, v97
  v_bfi_b32 v82, v90, 0, v98
  v_bfi_b32 v83, v91, 0, v99
  v_bfi_b32 v84, v92, 0, v100
  v_bfi_b32 v85, v93, 0, v101
  v_bfi_b32 v86, v94, 0, v102
  v_bfi_b32 v87, v95, 0, v103
  v_and_b32 v96, v88, v96
  v_and_b32 v97, v89, v97
  v_and_b32 v98, v90, v98
  v_and_b32 v99, v91, v99
  v_and_b32 v100, v92, v100
  v_and_b32 v101, v93, v101
  v_and_b32 v102, v94, v102
  v_and_b32 v103, v95, v103
  s_waitcnt lgkmcnt(8)
  v_mfma_f32_32x32x16_bf16 v[16:31], a[16:19], v[112:115], 0
  s_add_u32 s11, s10, 0
  v_exp_f32 v32, v32
  s_cmp_ge_u32 s11, 7
  v_exp_f32 v33, v33
  s_cselect_b32 s51, 7, 0
  v_exp_f32 v34, v34
  s_sub_u32 s11, s11, s51
  v_exp_f32 v35, v35
  s_lshl_b32 s11, s11, 17
  ds_read_b128 a[104:107], v124 offset:8320
  s_add_u32 s11, s11, s59
  s_add_u32 m0, s56, 0
  s_add_u32 s48, s11, 0
  buffer_load_dwordx4 v2, s[20:23], s48 offen lds
  ds_read_b128 a[112:115], v125 offset:8320
  s_waitcnt lgkmcnt(8)
  v_mfma_f32_32x32x16_bf16 v[48:63], a[72:75], v[80:83], 0
  s_add_u32 m0, s56, 1024
  v_exp_f32 v36, v36
  s_add_u32 s48, s11, 8192
  v_exp_f32 v37, v37
  v_exp_f32 v38, v38
  v_exp_f32 v39, v39
  v_cvt_pk_bf16_f32 v104, v32, v33
  v_cvt_pk_bf16_f32 v105, v34, v35
  buffer_load_dwordx4 v2, s[20:23], s48 offen lds
  ds_read_b128 a[40:43], v3 offset:20800
  v_mfma_f32_32x32x16_bf16 v[48:63], a[80:83], v[84:87], v[48:63]
  s_add_u32 m0, s56, 2048
  v_exp_f32 v40, v40
  s_add_u32 s48, s11, 16384
  v_exp_f32 v41, v41
  v_exp_f32 v42, v42
  v_exp_f32 v43, v43
  v_cvt_pk_bf16_f32 v106, v36, v37
  v_cvt_pk_bf16_f32 v107, v38, v39
  buffer_load_dwordx4 v2, s[20:23], s48 offen lds
  ds_read_b128 a[120:123], v124 offset:12480
  s_waitcnt lgkmcnt(8)
  v_mfma_f32_32x32x16_bf16 v[48:63], a[200:203], v[96:99], v[48:63]
  s_add_u32 m0, s56, 3072
  v_exp_f32 v44, v44
  s_add_u32 s48, s11, 24576
  v_exp_f32 v45, v45
  v_exp_f32 v46, v46
  v_exp_f32 v47, v47
  v_cvt_pk_bf16_f32 v108, v40, v41
  v_cvt_pk_bf16_f32 v109, v42, v43
  buffer_load_dwordx4 v2, s[20:23], s48 offen lds
  ds_read_b128 a[128:131], v125 offset:12480
  ds_read_b128 a[48:51], v3 offset:24960
  ds_read_b128 a[136:139], v124 offset:16640
  v_mfma_f32_32x32x16_bf16 v[48:63], a[208:211], v[100:103], v[48:63]
  s_add_u32 m0, s56, 4096
  v_cvt_pk_bf16_f32 v110, v44, v45
  v_cvt_pk_bf16_f32 v111, v46, v47
  s_waitcnt lgkmcnt(10)
  v_mfma_f32_32x32x16_bf16 v[32:47], a[24:27], v[112:115], 0
  s_add_u32 s48, s11, 32768
  v_exp_f32 v16, v16
  v_exp_f32 v17, v17
  v_exp_f32 v18, v18
  v_exp_f32 v19, v19
  ds_read_b128 a[144:147], v125 offset:16640
  buffer_load_dwordx4 v2, s[20:23], s48 offen lds
  ds_read_b128 a[56:59], v3 offset:29120
  s_waitcnt lgkmcnt(10)
  v_mfma_f32_32x32x16_bf16 v[48:63], a[88:91], v[104:107], v[48:63]
  s_add_u32 m0, s56, 5120
  v_exp_f32 v20, v20
  s_add_u32 s48, s11, 40960
  v_exp_f32 v21, v21
  v_exp_f32 v22, v22
  v_exp_f32 v23, v23
  v_cvt_pk_bf16_f32 v96, v16, v17
  v_cvt_pk_bf16_f32 v97, v18, v19
  buffer_load_dwordx4 v2, s[20:23], s48 offen lds
  ds_read_b128 a[152:155], v124 offset:20800
  v_mfma_f32_32x32x16_bf16 v[48:63], a[96:99], v[108:111], v[48:63]
  s_add_u32 m0, s56, 6144
  v_exp_f32 v24, v24
  s_add_u32 s48, s11, 49152
  v_exp_f32 v25, v25
  v_exp_f32 v26, v26
  v_exp_f32 v27, v27
  v_cvt_pk_bf16_f32 v98, v20, v21
  v_cvt_pk_bf16_f32 v99, v22, v23
  buffer_load_dwordx4 v2, s[20:23], s48 offen lds
  ds_read_b128 a[160:163], v125 offset:20800
  v_exp_f32 v28, v28
  s_add_u32 m0, s56, 7168
  v_exp_f32 v29, v29
  s_add_u32 s48, s11, 57344
  v_exp_f32 v30, v30
  s_add_u32 s11, s10, 1
  v_exp_f32 v31, v31
  s_cmp_ge_u32 s11, 7
  v_cvt_pk_bf16_f32 v100, v24, v25
  v_cvt_pk_bf16_f32 v101, v26, v27
  buffer_load_dwordx4 v2, s[20:23], s48 offen lds
  ds_read_b128 a[168:171], v124 offset:24960
  ds_read_b128 a[176:179], v125 offset:24960
  ds_read_b128 a[184:187], v124 offset:29120
  v_cvt_pk_bf16_f32 v102, v28, v29
  v_cvt_pk_bf16_f32 v103, v30, v31
  s_waitcnt lgkmcnt(14)
  v_mfma_f32_32x32x16_bf16 v[16:31], a[32:35], v[112:115], 0
  s_cselect_b32 s51, 7, 0
  v_exp_f32 v32, v32
  s_sub_u32 s11, s11, s51
  v_exp_f32 v33, v33
  s_lshl_b32 s11, s11, 17
  v_exp_f32 v34, v34
  s_add_u32 s11, s11, s59
  v_exp_f32 v35, v35
  s_add_u32 m0, s56, 98304
  ds_read_b128 a[192:195], v125 offset:29120
  s_add_u32 s48, s11, 0
  buffer_load_dwordx4 v2, s[20:23], s48 offen lds
  s_lshr_b32 s50, s41, 3
  s_lshl_b32 s50, s50, 1
  s_and_b32 s51, s42, 1
  s_add_u32 s50, s50, s51
  s_lshl_b32 s51, s40, 2
  s_add_u32 s50, s50, s51
  s_lshr_b32 s51, s42, 1
  s_mul_i32 s53, s50, 112
  s_mul_i32 s54, s51, 56
  s_add_u32 s53, s53, s54
  s_lshl_b32 s53, s53, 10
  s_add_u32 s53, s53, 7340032
  s_lshl_b32 s54, s50, 5
  s_lshl_b32 s55, s51, 4
  s_add_u32 s54, s54, s55
  s_lshl_b32 s54, s54, 10
  s_add_u32 s54, s54, 5242880
  s_lshl_b32 s55, s50, 6
  s_lshl_b32 s45, s51, 5
  s_add_u32 s55, s55, s45
  s_lshl_b32 s45, s50, 15
  s_and_b32 s50, s41, 7
  s_lshl_b32 s50, s50, 7
  s_add_u32 s45, s45, s50
  s_lshl_b32 s51, s51, 6
  s_add_u32 s45, s45, s51
  s_waitcnt lgkmcnt(13)
  v_mfma_f32_32x32x16_bf16 v[48:63], a[104:107], v[96:99], v[48:63]
  s_lshl_b32 s49, s44, 6
  v_exp_f32 v36, v36
  s_lshl_b32 s50, s41, 2
  v_exp_f32 v37, v37
  s_add_u32 s49, s49, s50
  v_exp_f32 v38, v38
  s_add_u32 s49, s49, 8192
  v_exp_f32 v39, v39
  s_add_u32 m0, s56, 99328
  v_cvt_pk_bf16_f32 v104, v32, v33
  v_cvt_pk_bf16_f32 v105, v34, v35
  s_waitcnt vmcnt(9)
  s_mov_b64 exec, 1
  buffer_store_dword v13, off, s[28:31], s49 sc0 sc1
  s_mov_b64 exec, -1
  ds_read_b128 a[4:7], v3 offset:1024
  v_mfma_f32_32x32x16_bf16 v[48:63], a[112:115], v[100:103], v[48:63]
  s_add_u32 s48, s11, 8192
  v_exp_f32 v40, v40
  v_exp_f32 v41, v41
  v_exp_f32 v42, v42
  v_exp_f32 v43, v43
  v_cvt_pk_bf16_f32 v106, v36, v37
  v_cvt_pk_bf16_f32 v107, v38, v39
  buffer_load_dwordx4 v2, s[20:23], s48 offen lds
  v_lshrrev_b32 v8, 5, v0
  ds_read_b128 a[68:71], v3 offset:34304
  v_exp_f32 v44, v44
  s_add_u32 m0, s56, 100352
  v_exp_f32 v45, v45
  s_add_u32 s48, s11, 16384
  v_exp_f32 v46, v46
  v_exp_f32 v47, v47
  v_cvt_pk_bf16_f32 v108, v40, v41
  v_cvt_pk_bf16_f32 v109, v42, v43
  buffer_load_dwordx4 v2, s[20:23], s48 offen lds
  v_lshlrev_b32 v8, 2, v8
  ds_read_b128 a[12:15], v3 offset:5184
  s_add_u32 m0, s56, 101376
  s_add_u32 s48, s11, 24576
  buffer_load_dwordx4 v2, s[20:23], s48 offen lds
  v_bfe_u32 v15, v0, 2, 2
  ds_read_b128 a[76:79], v126 offset:0
  v_add_u32 v8, v8, v15
  ds_read_b128 a[84:87], v127 offset:0
  v_lshlrev_b32 v8, 7, v8
  ds_read_b128 a[204:207], v126 offset:33280
  v_bfe_u32 v15, v0, 4, 1
  v_cvt_pk_bf16_f32 v110, v44, v45
  v_cvt_pk_bf16_f32 v111, v46, v47
  s_waitcnt lgkmcnt(15)
  v_mfma_f32_32x32x16_bf16 v[32:47], a[40:43], v[112:115], 0
  s_add_u32 m0, s56, 102400
  v_exp_f32 v16, v16
  s_add_u32 s48, s11, 32768
  v_exp_f32 v17, v17
  v_exp_f32 v18, v18
  v_exp_f32 v19, v19
  ds_read_b128 a[212:215], v127 offset:33280
  buffer_load_dwordx4 v2, s[20:23], s48 offen lds
  v_lshlrev_b32 v15, 1, v15
  ds_read_b128 a[20:23], v3 offset:9344
  v_mfma_f32_32x32x16_bf16 v[48:63], a[120:123], v[104:107], v[48:63]
  s_add_u32 m0, s56, 103424
  v_exp_f32 v20, v20
  s_add_u32 s48, s11, 40960
  v_exp_f32 v21, v21
  v_exp_f32 v22, v22
  v_exp_f32 v23, v23
  v_cvt_pk_bf16_f32 v96, v16, v17
  v_cvt_pk_bf16_f32 v97, v18, v19
  buffer_load_dwordx4 v2, s[20:23], s48 offen lds
  v_bfe_u32 v9, v0, 1, 1
  ds_read_b128 a[92:95], v126 offset:4160
  v_mfma_f32_32x32x16_bf16 v[48:63], a[128:131], v[108:111], v[48:63]
  s_add_u32 m0, s56, 104448
  v_exp_f32 v24, v24
  s_add_u32 s48, s11, 49152
  v_exp_f32 v25, v25
  v_exp_f32 v26, v26
  v_exp_f32 v27, v27
  v_cvt_pk_bf16_f32 v98, v20, v21
  v_cvt_pk_bf16_f32 v99, v22, v23
  buffer_load_dwordx4 v2, s[20:23], s48 offen lds
  v_add_u32 v15, v15, v9
  ds_read_b128 a[100:103], v127 offset:4160
  v_exp_f32 v28, v28
  s_add_u32 m0, s56, 105472
  v_exp_f32 v29, v29
  s_add_u32 s48, s11, 57344
  v_exp_f32 v30, v30
  s_add_u32 s11, s10, 2
  v_exp_f32 v31, v31
  s_cmp_ge_u32 s11, 7
  v_cvt_pk_bf16_f32 v100, v24, v25
  v_cvt_pk_bf16_f32 v101, v26, v27
  buffer_load_dwordx4 v2, s[20:23], s48 offen lds
  v_bfe_u32 v9, v0, 3, 1
  ds_read_b128 a[28:31], v3 offset:13504
  v_lshl_add_u32 v15, v9, 2, v15
  ds_read_b128 a[108:111], v126 offset:8320
  v_lshl_add_u32 v8, v15, 4, v8
  ds_read_b128 a[116:119], v127 offset:8320
  v_and_b32 v15, 1, v0
  v_cvt_pk_bf16_f32 v102, v28, v29
  v_cvt_pk_bf16_f32 v103, v30, v31
  v_mfma_f32_32x32x16_bf16 v[16:31], a[48:51], v[112:115], 0
  s_cselect_b32 s51, 7, 0
  v_exp_f32 v32, v32
  s_sub_u32 s11, s11, s51
  v_exp_f32 v33, v33
  s_lshl_b32 s11, s11, 17
  v_exp_f32 v34, v34
  s_add_u32 s11, s11, s59
  v_exp_f32 v35, v35
  s_add_u32 m0, s56, 131072
  ds_read_b128 a[36:39], v3 offset:17664
  s_add_u32 s48, s11, 0
  buffer_load_dwordx4 v2, s[20:23], s48 offen lds
  v_lshl_add_u32 v8, v15, 3, v8
  ds_read_b128 a[124:127], v126 offset:12480
  s_waitcnt lgkmcnt(15)
  v_mfma_f32_32x32x16_bf16 v[48:63], a[136:139], v[96:99], v[48:63]
  s_add_u32 m0, s56, 132096
  v_exp_f32 v36, v36
  s_add_u32 s48, s11, 8192
  v_exp_f32 v37, v37
  s_lshr_b32 s51, s42, 1
  v_exp_f32 v38, v38
  s_lshl_b32 s50, s51, 6
  v_exp_f32 v39, v39
  s_lshl_b32 s51, s51, 14
  v_cvt_pk_bf16_f32 v104, v32, v33
  v_cvt_pk_bf16_f32 v105, v34, v35
  buffer_load_dwordx4 v2, s[20:23], s48 offen lds
  v_xor_b32 v8, s50, v8
  v_add_u32 v8, s51, v8
  ds_read_b128 a[132:135], v127 offset:12480
  v_mfma_f32_32x32x16_bf16 v[48:63], a[144:147], v[100:103], v[48:63]
  s_add_u32 m0, s56, 133120
  v_exp_f32 v40, v40
  s_add_u32 s48, s11, 16384
  v_exp_f32 v41, v41
  v_exp_f32 v42, v42
  v_exp_f32 v43, v43
  v_cvt_pk_bf16_f32 v106, v36, v37
  v_cvt_pk_bf16_f32 v107, v38, v39
  buffer_load_dwordx4 v2, s[20:23], s48 offen lds
  v_xor_b32 v9, 64, v8
  ds_read_b128 a[44:47], v3 offset:21824
  v_exp_f32 v44, v44
  s_add_u32 m0, s56, 134144
  v_exp_f32 v45, v45
  s_add_u32 s48, s11, 24576
  v_exp_f32 v46, v46
  s_and_b32 s50, s41, 7
  v_exp_f32 v47, v47
  s_lshl_b32 s50, s50, 7
  v_cvt_pk_bf16_f32 v108, v40, v41
  v_cvt_pk_bf16_f32 v109, v42, v43
  buffer_load_dwordx4 v2, s[20:23], s48 offen lds
  v_and_b32 v12, 7, v0
  ds_read_b128 a[140:143], v126 offset:16640
  v_lshlrev_b32 v12, 2, v12
  ds_read_b128 a[148:151], v127 offset:16640
  v_and_b32 v15, 31, v0
  v_lshlrev_b32 v15, 1, v15
  s_lshr_b32 s51, s42, 1
  s_lshl_b32 s51, s51, 6
  s_add_u32 s50, s50, s51
  buffer_load_ushort v10, v15, s[36:39], s50 offen
  ds_read_b128 a[52:55], v3 offset:25984
  v_cvt_pk_bf16_f32 v110, v44, v45
  v_cvt_pk_bf16_f32 v111, v46, v47
  v_mfma_f32_32x32x16_bf16 v[32:47], a[56:59], v[112:115], 0
  s_add_u32 m0, s56, 135168
  v_exp_f32 v16, v16
  s_add_u32 s48, s11, 32768
  v_exp_f32 v17, v17
  v_exp_f32 v18, v18
  v_exp_f32 v19, v19
  ds_read_b128 a[156:159], v126 offset:20800
  buffer_load_dwordx4 v2, s[20:23], s48 offen lds
  ds_read_b128 a[164:167], v127 offset:20800
  v_mfma_f32_32x32x16_bf16 v[48:63], a[152:155], v[104:107], v[48:63]
  s_add_u32 m0, s56, 136192
  v_exp_f32 v20, v20
  s_add_u32 s48, s11, 40960
  v_exp_f32 v21, v21
  v_exp_f32 v22, v22
  v_exp_f32 v23, v23
  v_cvt_pk_bf16_f32 v96, v16, v17
  v_cvt_pk_bf16_f32 v97, v18, v19
  buffer_load_dwordx4 v2, s[20:23], s48 offen lds
  ds_read_b128 a[60:63], v3 offset:30144
  v_mfma_f32_32x32x16_bf16 v[48:63], a[160:163], v[108:111], v[48:63]
  s_add_u32 m0, s56, 137216
  v_exp_f32 v24, v24
  s_add_u32 s48, s11, 49152
  v_exp_f32 v25, v25
  v_exp_f32 v26, v26
  v_exp_f32 v27, v27
  v_cvt_pk_bf16_f32 v98, v20, v21
  v_cvt_pk_bf16_f32 v99, v22, v23
  buffer_load_dwordx4 v2, s[20:23], s48 offen lds
  ds_read_b128 a[172:175], v126 offset:24960
  v_exp_f32 v28, v28
  s_add_u32 m0, s56, 138240
  v_exp_f32 v29, v29
  s_add_u32 s48, s11, 57344
  v_exp_f32 v30, v30
  v_exp_f32 v31, v31
  v_cvt_pk_bf16_f32 v100, v24, v25
  v_cvt_pk_bf16_f32 v101, v26, v27
  buffer_load_dwordx4 v2, s[20:23], s48 offen lds
  ds_read_b128 a[180:183], v127 offset:24960
  ds_read_b128 a[188:191], v126 offset:29120
  ds_read_b128 a[196:199], v127 offset:29120
  v_cvt_pk_bf16_f32 v102, v28, v29
  v_cvt_pk_bf16_f32 v103, v30, v31
  s_waitcnt lgkmcnt(15)
  v_mfma_f32_32x32x16_bf16 v[16:31], a[4:7], v[116:119], 0
  v_exp_f32 v32, v32
  v_exp_f32 v33, v33
  v_exp_f32 v34, v34
  v_exp_f32 v35, v35
  s_add_u32 s48, s52, 0
  buffer_load_dwordx4 v[192:195], v2, s[12:15], s48 offen
  v_mfma_f32_32x32x16_bf16 v[64:79], a[68:71], v[116:119], 0
  s_add_u32 s48, s52, 8192
  v_exp_f32 v36, v36
  v_exp_f32 v37, v37
  v_exp_f32 v38, v38
  v_exp_f32 v39, v39
  v_cvt_pk_bf16_f32 v104, v32, v33
  v_cvt_pk_bf16_f32 v105, v34, v35
  buffer_load_dwordx4 v[196:199], v2, s[12:15], s48 offen
  v_mfma_f32_32x32x16_bf16 v[48:63], a[168:171], v[96:99], v[48:63]
  s_add_u32 s48, s52, 16384
  v_exp_f32 v40, v40
  v_exp_f32 v41, v41
  v_exp_f32 v42, v42
  v_exp_f32 v43, v43
  v_cvt_pk_bf16_f32 v106, v36, v37
  v_cvt_pk_bf16_f32 v107, v38, v39
  buffer_load_dwordx4 v[200:203], v2, s[12:15], s48 offen
  v_mfma_f32_32x32x16_bf16 v[48:63], a[176:179], v[100:103], v[48:63]
  s_add_u32 s48, s52, 24576
  v_exp_f32 v44, v44
  v_exp_f32 v45, v45
  v_exp_f32 v46, v46
  v_exp_f32 v47, v47
  v_cvt_pk_bf16_f32 v108, v40, v41
  v_cvt_pk_bf16_f32 v109, v42, v43
  buffer_load_dwordx4 v[204:207], v2, s[12:15], s48 offen
  v_cvt_pk_bf16_f32 v110, v44, v45
  v_cvt_pk_bf16_f32 v111, v46, v47
  v_mfma_f32_32x32x16_bf16 v[32:47], a[12:15], v[116:119], 0
  s_add_u32 s48, s52, 32768
  v_cndmask_b32 v16, v16, v64, s[70:71]
  v_cndmask_b32 v17, v17, v65, s[72:73]
  v_cndmask_b32 v18, v18, v66, s[74:75]
  v_cndmask_b32 v19, v19, v67, s[76:77]
  buffer_load_dwordx4 v[208:211], v2, s[12:15], s48 offen
  s_waitcnt lgkmcnt(0)
  s_barrier
  v_mfma_f32_32x32x16_bf16 v[48:63], a[184:187], v[104:107], v[48:63]
  s_add_u32 s48, s52, 40960
  v_cndmask_b32 v20, v20, v68, s[78:79]
  v_cndmask_b32 v21, v21, v69, s[80:81]
  v_cndmask_b32 v22, v22, v70, s[82:83]
  v_cndmask_b32 v23, v23, v71, s[84:85]
  buffer_load_dwordx4 v[212:215], v2, s[12:15], s48 offen
  v_mfma_f32_32x32x16_bf16 v[48:63], a[192:195], v[108:111], v[48:63]
  s_add_u32 s48, s52, 49152
  v_cndmask_b32 v24, v24, v72, s[86:87]
  v_cndmask_b32 v25, v25, v73, s[88:89]
  v_cndmask_b32 v26, v26, v74, s[90:91]
  v_cndmask_b32 v27, v27, v75, s[92:93]
  buffer_load_dwordx4 v[216:219], v2, s[12:15], s48 offen
  v_cndmask_b32 v28, v28, v76, s[94:95]
  v_cndmask_b32 v29, v29, v77, s[96:97]
  v_cndmask_b32 v30, v30, v78, s[98:99]
  v_cndmask_b32 v31, v31, v79, s[100:101]
  s_add_u32 s48, s52, 57344
  buffer_load_dwordx4 v[220:223], v2, s[12:15], s48 offen
  v_exp_f32 v16, v16
  v_exp_f32 v17, v17
  v_exp_f32 v18, v18
  v_exp_f32 v19, v19
  v_exp_f32 v20, v20
  v_exp_f32 v21, v21
  v_exp_f32 v22, v22
  v_exp_f32 v23, v23
  v_cvt_pk_bf16_f32 v96, v16, v17
  v_cvt_pk_bf16_f32 v97, v18, v19
  v_exp_f32 v24, v24
  v_exp_f32 v25, v25
  v_exp_f32 v26, v26
  v_exp_f32 v27, v27
  v_cvt_pk_bf16_f32 v98, v20, v21
  v_cvt_pk_bf16_f32 v99, v22, v23
  v_exp_f32 v28, v28
  v_exp_f32 v29, v29
  v_exp_f32 v30, v30
  v_exp_f32 v31, v31
  v_cvt_pk_bf16_f32 v100, v24, v25
  v_cvt_pk_bf16_f32 v101, v26, v27
  v_cvt_pk_bf16_f32 v102, v28, v29
  v_cvt_pk_bf16_f32 v103, v30, v31
  v_bfi_b32 v80, v88, 0, v96
  v_bfi_b32 v81, v89, 0, v97
  v_bfi_b32 v82, v90, 0, v98
  v_bfi_b32 v83, v91, 0, v99
  v_bfi_b32 v84, v92, 0, v100
  v_bfi_b32 v85, v93, 0, v101
  v_bfi_b32 v86, v94, 0, v102
  v_bfi_b32 v87, v95, 0, v103
  v_and_b32 v96, v88, v96
  v_and_b32 v97, v89, v97
  v_and_b32 v98, v90, v98
  v_and_b32 v99, v91, v99
  v_and_b32 v100, v92, v100
  v_and_b32 v101, v93, v101
  v_and_b32 v102, v94, v102
  v_and_b32 v103, v95, v103
  v_mfma_f32_32x32x16_bf16 v[16:31], a[20:23], v[116:119], 0
  v_exp_f32 v32, v32
  v_exp_f32 v33, v33
  v_exp_f32 v34, v34
  v_exp_f32 v35, v35
  s_add_u32 s48, s52, 131072
  buffer_load_dwordx4 v[224:227], v2, s[12:15], s48 offen
  v_mfma_f32_32x32x16_bf16 v[64:79], a[76:79], v[80:83], 0
  s_add_u32 s48, s52, 139264
  v_exp_f32 v36, v36
  v_exp_f32 v37, v37
  v_exp_f32 v38, v38
  v_exp_f32 v39, v39
  v_cvt_pk_bf16_f32 v104, v32, v33
  v_cvt_pk_bf16_f32 v105, v34, v35
  buffer_load_dwordx4 v[228:231], v2, s[12:15], s48 offen
  v_mfma_f32_32x32x16_bf16 v[64:79], a[84:87], v[84:87], v[64:79]
  s_add_u32 s48, s52, 147456
  v_exp_f32 v40, v40
  v_exp_f32 v41, v41
  v_exp_f32 v42, v42
  v_exp_f32 v43, v43
  v_cvt_pk_bf16_f32 v106, v36, v37
  v_cvt_pk_bf16_f32 v107, v38, v39
  buffer_load_dwordx4 v[232:235], v2, s[12:15], s48 offen
  v_mfma_f32_32x32x16_bf16 v[64:79], a[204:207], v[96:99], v[64:79]
  s_add_u32 s48, s52, 155648
  v_exp_f32 v44, v44
  v_exp_f32 v45, v45
  v_exp_f32 v46, v46
  v_exp_f32 v47, v47
  v_cvt_pk_bf16_f32 v108, v40, v41
  v_cvt_pk_bf16_f32 v109, v42, v43
  buffer_load_dwordx4 v[236:239], v2, s[12:15], s48 offen
  v_mfma_f32_32x32x16_bf16 v[64:79], a[212:215], v[100:103], v[64:79]
  v_cvt_pk_bf16_f32 v110, v44, v45
  v_cvt_pk_bf16_f32 v111, v46, v47
  v_mfma_f32_32x32x16_bf16 v[32:47], a[28:31], v[116:119], 0
  v_exp_f32 v16, v16
  v_exp_f32 v17, v17
  v_exp_f32 v18, v18
  v_exp_f32 v19, v19
  s_add_u32 s48, s52, 163840
  buffer_load_dwordx4 v[240:243], v2, s[12:15], s48 offen
  v_mfma_f32_32x32x16_bf16 v[64:79], a[92:95], v[104:107], v[64:79]
  s_add_u32 s48, s52, 172032
  v_exp_f32 v20, v20
  v_exp_f32 v21, v21
  v_exp_f32 v22, v22
  v_exp_f32 v23, v23
  v_cvt_pk_bf16_f32 v96, v16, v17
  v_cvt_pk_bf16_f32 v97, v18, v19
  buffer_load_dwordx4 v[244:247], v2, s[12:15], s48 offen
  v_mfma_f32_32x32x16_bf16 v[64:79], a[100:103], v[108:111], v[64:79]
  s_add_u32 s48, s52, 180224
  v_exp_f32 v24, v24
  v_exp_f32 v25, v25
  v_exp_f32 v26, v26
  v_exp_f32 v27, v27
  v_cvt_pk_bf16_f32 v98, v20, v21
  v_cvt_pk_bf16_f32 v99, v22, v23
  buffer_load_dwordx4 v[248:251], v2, s[12:15], s48 offen
  v_exp_f32 v28, v28
  v_exp_f32 v29, v29
  v_exp_f32 v30, v30
  v_exp_f32 v31, v31
  v_cvt_pk_bf16_f32 v100, v24, v25
  v_cvt_pk_bf16_f32 v101, v26, v27
  v_cvt_pk_bf16_f32 v102, v28, v29
  v_cvt_pk_bf16_f32 v103, v30, v31
  v_mfma_f32_32x32x16_bf16 v[16:31], a[36:39], v[116:119], 0
  v_exp_f32 v32, v32
  v_exp_f32 v33, v33
  v_exp_f32 v34, v34
  v_exp_f32 v35, v35
  s_add_u32 s48, s52, 188416
  buffer_load_dwordx4 v[252:255], v2, s[12:15], s48 offen
  v_mfma_f32_32x32x16_bf16 v[64:79], a[108:111], v[96:99], v[64:79]
  s_add_u32 s50, s55, 8192
  v_exp_f32 v36, v36
  s_add_u32 s11, s10, 3
  v_exp_f32 v37, v37
  s_cmp_ge_u32 s11, 7
  v_exp_f32 v38, v38
  s_cselect_b32 s51, 7, 0
  v_exp_f32 v39, v39
  s_sub_u32 s11, s11, s51
  v_cvt_pk_bf16_f32 v104, v32, v33
  v_cvt_pk_bf16_f32 v105, v34, v35
  buffer_load_dword v14, v12, s[28:31], s50 offen sc1
  v_mfma_f32_32x32x16_bf16 v[64:79], a[116:119], v[100:103], v[64:79]
  s_lshl_b32 s11, s11, 17
  v_exp_f32 v40, v40
  s_add_u32 s11, s11, s59
  v_exp_f32 v41, v41
  s_add_u32 m0, s56, 32768
  v_exp_f32 v42, v42
  s_add_u32 s48, s11, 0
  v_exp_f32 v43, v43
  v_cvt_pk_bf16_f32 v106, v36, v37
  v_cvt_pk_bf16_f32 v107, v38, v39
  buffer_load_dwordx4 v2, s[20:23], s48 offen lds
  v_exp_f32 v44, v44
  s_add_u32 m0, s56, 33792
  v_exp_f32 v45, v45
  s_add_u32 s48, s11, 8192
  v_exp_f32 v46, v46
  v_exp_f32 v47, v47
  v_cvt_pk_bf16_f32 v108, v40, v41
  v_cvt_pk_bf16_f32 v109, v42, v43
  buffer_load_dwordx4 v2, s[20:23], s48 offen lds
  s_add_u32 m0, s56, 34816
  s_add_u32 s48, s11, 16384
  buffer_load_dwordx4 v2, s[20:23], s48 offen lds
  v_cvt_pk_bf16_f32 v110, v44, v45
  v_cvt_pk_bf16_f32 v111, v46, v47
  v_mfma_f32_32x32x16_bf16 v[32:47], a[44:47], v[116:119], 0
  v_exp_f32 v16, v16
  v_exp_f32 v17, v17
  v_exp_f32 v18, v18
  v_exp_f32 v19, v19
  s_add_u32 m0, s56, 35840
  s_add_u32 s48, s11, 24576
  buffer_load_dwordx4 v2, s[20:23], s48 offen lds
  v_mfma_f32_32x32x16_bf16 v[64:79], a[124:127], v[104:107], v[64:79]
  s_add_u32 m0, s56, 36864
  v_exp_f32 v20, v20
  s_add_u32 s48, s11, 32768
  v_exp_f32 v21, v21
  v_exp_f32 v22, v22
  v_exp_f32 v23, v23
  v_cvt_pk_bf16_f32 v96, v16, v17
  v_cvt_pk_bf16_f32 v97, v18, v19
  buffer_load_dwordx4 v2, s[20:23], s48 offen lds
  v_mfma_f32_32x32x16_bf16 v[64:79], a[132:135], v[108:111], v[64:79]
  s_add_u32 m0, s56, 37888
  v_exp_f32 v24, v24
  s_add_u32 s48, s11, 40960
  v_exp_f32 v25, v25
  v_exp_f32 v26, v26
  v_exp_f32 v27, v27
  v_cvt_pk_bf16_f32 v98, v20, v21
  v_cvt_pk_bf16_f32 v99, v22, v23
  buffer_load_dwordx4 v2, s[20:23], s48 offen lds
  v_exp_f32 v28, v28
  v_exp_f32 v29, v29
  v_exp_f32 v30, v30
  v_exp_f32 v31, v31
  v_cvt_pk_bf16_f32 v100, v24, v25
  v_cvt_pk_bf16_f32 v101, v26, v27
  v_cvt_pk_bf16_f32 v102, v28, v29
  v_cvt_pk_bf16_f32 v103, v30, v31
  v_mfma_f32_32x32x16_bf16 v[16:31], a[52:55], v[116:119], 0
  v_exp_f32 v32, v32
  v_exp_f32 v33, v33
  v_exp_f32 v34, v34
  v_exp_f32 v35, v35
  s_add_u32 m0, s56, 38912
  s_add_u32 s48, s11, 49152
  buffer_load_dwordx4 v2, s[20:23], s48 offen lds
  v_mfma_f32_32x32x16_bf16 v[64:79], a[140:143], v[96:99], v[64:79]
  s_add_u32 m0, s56, 39936
  v_exp_f32 v36, v36
  s_add_u32 s48, s11, 57344
  v_exp_f32 v37, v37
  s_add_u32 s11, s10, 4
  v_exp_f32 v38, v38
  s_cmp_ge_u32 s11, 7
  v_exp_f32 v39, v39
  s_cselect_b32 s51, 7, 0
  v_cvt_pk_bf16_f32 v104, v32, v33
  v_cvt_pk_bf16_f32 v105, v34, v35
  buffer_load_dwordx4 v2, s[20:23], s48 offen lds
  v_mfma_f32_32x32x16_bf16 v[64:79], a[148:151], v[100:103], v[64:79]
  s_sub_u32 s11, s11, s51
  v_exp_f32 v40, v40
  s_lshl_b32 s11, s11, 17
  v_exp_f32 v41, v41
  s_add_u32 s11, s11, s59
  v_exp_f32 v42, v42
  s_add_u32 m0, s56, 65536
  v_exp_f32 v43, v43
  s_add_u32 s48, s11, 0
  v_cvt_pk_bf16_f32 v106, v36, v37
  v_cvt_pk_bf16_f32 v107, v38, v39
  buffer_load_dwordx4 v2, s[20:23], s48 offen lds
  v_exp_f32 v44, v44
  s_add_u32 m0, s56, 66560
  v_exp_f32 v45, v45
  s_add_u32 s48, s11, 8192
  v_exp_f32 v46, v46
  v_exp_f32 v47, v47
  v_cvt_pk_bf16_f32 v108, v40, v41
  v_cvt_pk_bf16_f32 v109, v42, v43
  buffer_load_dwordx4 v2, s[20:23], s48 offen lds
  v_cvt_pk_bf16_f32 v110, v44, v45
  v_cvt_pk_bf16_f32 v111, v46, v47
  v_mfma_f32_32x32x16_bf16 v[32:47], a[60:63], v[116:119], 0
  v_exp_f32 v16, v16
  v_exp_f32 v17, v17
  v_exp_f32 v18, v18
  v_exp_f32 v19, v19
  s_add_u32 m0, s56, 67584
  s_add_u32 s48, s11, 16384
  buffer_load_dwordx4 v2, s[20:23], s48 offen lds
  s_waitcnt vmcnt(11)
  v_cmp_ne_u32 vcc, s43, v14
  s_nop 0
  s_cbranch_vccnz L_spin_ha
L_back_ha:
  v_mfma_f32_32x32x16_bf16 v[64:79], a[156:159], v[104:107], v[64:79]
  s_add_u32 m0, s56, 68608
  v_exp_f32 v20, v20
  s_add_u32 s48, s11, 24576
  v_exp_f32 v21, v21
  v_exp_f32 v22, v22
  v_exp_f32 v23, v23
  v_cvt_pk_bf16_f32 v96, v16, v17
  v_cvt_pk_bf16_f32 v97, v18, v19
  buffer_load_dwordx4 v2, s[20:23], s48 offen lds
  v_mfma_f32_32x32x16_bf16 v[64:79], a[164:167], v[108:111], v[64:79]
  s_add_u32 m0, s56, 69632
  v_exp_f32 v24, v24
  s_add_u32 s48, s11, 32768
  v_exp_f32 v25, v25
  v_exp_f32 v26, v26
  v_exp_f32 v27, v27
  v_cvt_pk_bf16_f32 v98, v20, v21
  v_cvt_pk_bf16_f32 v99, v22, v23
  buffer_load_dwordx4 v2, s[20:23], s48 offen lds
  v_exp_f32 v28, v28
  v_exp_f32 v29, v29
  v_exp_f32 v30, v30
  v_exp_f32 v31, v31
  v_cvt_pk_bf16_f32 v100, v24, v25
  v_cvt_pk_bf16_f32 v101, v26, v27
  v_cvt_pk_bf16_f32 v102, v28, v29
  v_cvt_pk_bf16_f32 v103, v30, v31
  v_mfma_f32_32x32x16_bf16 v[64:79], a[172:175], v[96:99], v[64:79]
  v_exp_f32 v32, v32
  v_exp_f32 v33, v33
  v_exp_f32 v34, v34
  v_exp_f32 v35, v35
  s_add_u32 m0, s56, 70656
  s_add_u32 s48, s11, 40960
  buffer_load_dwordx4 v2, s[20:23], s48 offen lds
  v_mfma_f32_32x32x16_bf16 v[64:79], a[180:183], v[100:103], v[64:79]
  s_lshl_b32 s9, s8, 13
  v_exp_f32 v36, v36
  s_add_u32 s9, s9, s53
  v_exp_f32 v37, v37
  s_add_u32 s8, s8, 1
  v_exp_f32 v38, v38
  s_cmp_eq_u32 s8, 7
  v_exp_f32 v39, v39
  s_cselect_b32 s8, 0, s8
  v_cvt_pk_bf16_f32 v104, v32, v33
  v_cvt_pk_bf16_f32 v105, v34, v35
  buffer_load_dwordx4 a[216:219], v1, s[28:31], s9 offen offset:0 sc1
  v_exp_f32 v40, v40
  s_add_u32 m0, s56, 71680
  v_exp_f32 v41, v41
  s_add_u32 s48, s11, 49152
  v_exp_f32 v42, v42
  v_exp_f32 v43, v43
  v_cvt_pk_bf16_f32 v106, v36, v37
  v_cvt_pk_bf16_f32 v107, v38, v39
  buffer_load_dwordx4 v2, s[20:23], s48 offen lds
  v_exp_f32 v44, v44
  s_add_u32 m0, s56, 72704
  v_exp_f32 v45, v45
  s_add_u32 s48, s11, 57344
  v_exp_f32 v46, v46
  v_exp_f32 v47, v47
  v_cvt_pk_bf16_f32 v108, v40, v41
  v_cvt_pk_bf16_f32 v109, v42, v43
  buffer_load_dwordx4 a[220:223], v1, s[28:31], s9 offen offset:1024 sc1
  buffer_load_dwordx4 v2, s[20:23], s48 offen lds
  buffer_load_dwordx4 a[224:227], v1, s[28:31], s9 offen offset:2048 sc1
  buffer_load_dwordx4 a[228:231], v1, s[28:31], s9 offen offset:3072 sc1
  s_add_u32 s9, s9, 4096
  buffer_load_dwordx4 a[232:235], v1, s[28:31], s9 offen offset:0 sc1
  buffer_load_dwordx4 a[236:239], v1, s[28:31], s9 offen offset:1024 sc1
  buffer_load_dwordx4 a[240:243], v1, s[28:31], s9 offen offset:2048 sc1
  buffer_load_dwordx4 a[244:247], v1, s[28:31], s9 offen offset:3072 sc1
  s_lshl_b32 s9, s8, 13
  s_add_u32 s9, s9, s53
  s_add_u32 s8, s8, 1
  s_cmp_eq_u32 s8, 7
  buffer_load_dwordx4 a[248:251], v1, s[28:31], s9 offen offset:0 sc1
  buffer_load_dwordx4 a[252:255], v1, s[28:31], s9 offen offset:1024 sc1
  v_cvt_pk_bf16_f32 v110, v44, v45
  v_cvt_pk_bf16_f32 v111, v46, v47
  v_mfma_f32_32x32x16_bf16 v[64:79], a[188:191], v[104:107], v[64:79]
  s_cselect_b32 s8, 0, s8
  v_mfma_f32_32x32x16_bf16 v[64:79], a[196:199], v[108:111], v[64:79]
L_att_join:
  v_subrev_u32 v15, 0x2b800000, v56
  v_cmp_lt_u32 vcc, 0x28000000, v15
  s_nop 0
  s_cbranch_vccnz L_fb0
L_fb0_back:
  v_rcp_f32 v15, v56
  s_lshl_b32 s49, s44, 5
  v_mul_f32 v48, v48, v15
  v_mul_f32 v49, v49, v15
  v_mul_f32 v50, v50, v15
  v_mul_f32 v51, v51, v15
  v_mul_f32 v52, v52, v15
  v_mul_f32 v53, v53, v15
  v_mul_f32 v54, v54, v15
  v_mul_f32 v55, v55, v15
  v_cvt_pk_bf16_f32 v16, v48, v49
  v_cvt_pk_bf16_f32 v17, v50, v51
  v_cvt_pk_bf16_f32 v18, v52, v53
  v_cvt_pk_bf16_f32 v19, v54, v55
  s_lshl_b32 s50, s41, 1
  s_add_u32 s49, s49, s50
  s_lshl_b32 s49, s49, 10
  s_add_u32 s49, s49, 5242880
  buffer_store_dwordx4 v[16:19], v1, s[28:31], s49 offen offset:0 sc1
  v_subrev_u32 v15, 0x2b800000, v64
  v_cmp_lt_u32 vcc, 0x28000000, v15
  s_nop 0
  s_cbranch_vccnz L_fb1
L_fb1_back:
  v_rcp_f32 v15, v64
  s_lshl_b32 s49, s44, 5
  v_mul_f32 v72, v72, v15
  v_mul_f32 v73, v73, v15
  v_mul_f32 v74, v74, v15
  v_mul_f32 v75, v75, v15
  v_mul_f32 v76, v76, v15
  v_mul_f32 v77, v77, v15
  v_mul_f32 v78, v78, v15
  v_mul_f32 v79, v79, v15
  v_cvt_pk_bf16_f32 v20, v72, v73
  v_cvt_pk_bf16_f32 v21, v74, v75
  v_cvt_pk_bf16_f32 v22, v76, v77
  v_cvt_pk_bf16_f32 v23, v78, v79
  s_lshl_b32 s50, s41, 1
  s_add_u32 s49, s49, s50
  s_lshl_b32 s49, s49, 10
  s_add_u32 s49, s49, 5242880
  buffer_store_dwordx4 v[20:23], v1, s[28:31], s49 offen offset:1024 sc1
  v_mov_b32 v88, 0x3e803e80
  v_mov_b32 v89, 0
  v_mov_b32 v90, 0
  v_mov_b32 v91, 0
  v_lshl_or_b32 v120, v10, 16, v10
  v_add_u32 v5, 0, v8
  v_add_u32 v6, 0, v9
  s_barrier
  v_mfma_f32_32x32x16_bf16 v[16:31], v[120:123], v[88:91], 0
  ds_read_b64_tr_b16 v[48:49], v5 offset:0
  ds_read_b64_tr_b16 v[50:51], v5 offset:1024
  ds_read_b64_tr_b16 v[52:53], v6 offset:0
  ds_read_b64_tr_b16 v[54:55], v6 offset:1024
  ds_read_b64_tr_b16 v[56:57], v5 offset:2048
  ds_read_b64_tr_b16 v[58:59], v5 offset:3072
  ds_read_b64_tr_b16 v[60:61], v6 offset:2048
  ds_read_b64_tr_b16 v[62:63], v6 offset:3072
  ds_read_b64_tr_b16 v[96:97], v5 offset:4096
  ds_read_b64_tr_b16 v[98:99], v5 offset:5120
  ds_read_b64_tr_b16 v[100:101], v6 offset:4096
  ds_read_b64_tr_b16 v[102:103], v6 offset:5120
  ds_read_b64_tr_b16 v[104:105], v5 offset:6144
  ds_read_b64_tr_b16 v[106:107], v5 offset:7168
  ds_read_b64_tr_b16 v[108:109], v6 offset:6144
  ds_read_b64_tr_b16 v[110:111], v6 offset:7168
  s_waitcnt vmcnt(11)
  s_waitcnt lgkmcnt(8)
  v_mfma_f32_32x32x16_bf16 v[16:31], v[48:51], a[216:219], v[16:31]
  ds_read_b64_tr_b16 v[112:113], v5 offset:8192
  ds_read_b64_tr_b16 v[114:115], v5 offset:9216
  v_mfma_f32_32x32x16_bf16 v[32:47], v[52:55], a[216:219], 0
  ds_read_b64_tr_b16 v[116:117], v6 offset:8192
  ds_read_b64_tr_b16 v[118:119], v6 offset:9216
  buffer_load_dwordx4 a[0:3], v1, s[28:31], s9 offen offset:2048 sc1
  v_mfma_f32_32x32x16_bf16 v[16:31], v[56:59], a[220:223], v[16:31]
  s_waitcnt lgkmcnt(4)
  ds_read_b64_tr_b16 v[80:81], v5 offset:10240
  ds_read_b64_tr_b16 v[82:83], v5 offset:11264
  v_mfma_f32_32x32x16_bf16 v[32:47], v[60:63], a[220:223], v[32:47]
  s_waitcnt vmcnt(9)
  ds_read_b64_tr_b16 v[84:85], v6 offset:10240
  ds_read_b64_tr_b16 v[86:87], v6 offset:11264
  v_add_u32 v11, 98304, v8
  v_add_u32 v7, 98304, v9
  buffer_load_dwordx4 a[4:7], v1, s[28:31], s9 offen offset:3072 sc1
  v_mfma_f32_32x32x16_bf16 v[16:31], v[96:99], a[224:227], v[16:31]
  s_add_u32 s9, s9, 4096
  ds_read_b64_tr_b16 v[48:49], v5 offset:12288
  ds_read_b64_tr_b16 v[50:51], v5 offset:13312
  v_mfma_f32_32x32x16_bf16 v[32:47], v[100:103], a[224:227], v[32:47]
  ds_read_b64_tr_b16 v[52:53], v6 offset:12288
  ds_read_b64_tr_b16 v[54:55], v6 offset:13312
  buffer_load_dwordx4 a[8:11], v1, s[28:31], s9 offen offset:0 sc1
  v_mfma_f32_32x32x16_bf16 v[16:31], v[104:107], a[228:231], v[16:31]
  s_waitcnt lgkmcnt(4)
  ds_read_b64_tr_b16 v[56:57], v5 offset:14336
  ds_read_b64_tr_b16 v[58:59], v5 offset:15360
  v_mfma_f32_32x32x16_bf16 v[32:47], v[108:111], a[228:231], v[32:47]
  s_waitcnt vmcnt(9)
  ds_read_b64_tr_b16 v[60:61], v6 offset:14336
  ds_read_b64_tr_b16 v[62:63], v6 offset:15360
  buffer_load_dwordx4 a[12:15], v1, s[28:31], s9 offen offset:1024 sc1
  v_mfma_f32_32x32x16_bf16 v[16:31], v[112:115], a[232:235], v[16:31]
  ds_read_b64_tr_b16 v[96:97], v11 offset:0
  ds_read_b64_tr_b16 v[98:99], v11 offset:1024
  v_mfma_f32_32x32x16_bf16 v[32:47], v[116:119], a[232:235], v[32:47]
  ds_read_b64_tr_b16 v[100:101], v7 offset:0
  ds_read_b64_tr_b16 v[102:103], v7 offset:1024
  buffer_load_dwordx4 a[16:19], v1, s[28:31], s9 offen offset:2048 sc1
  v_mfma_f32_32x32x16_bf16 v[16:31], v[80:83], a[236:239], v[16:31]
  s_waitcnt lgkmcnt(4)
  ds_read_b64_tr_b16 v[104:105], v11 offset:2048
  ds_read_b64_tr_b16 v[106:107], v11 offset:3072
  v_mfma_f32_32x32x16_bf16 v[32:47], v[84:87], a[236:239], v[32:47]
  s_waitcnt vmcnt(9)
  ds_read_b64_tr_b16 v[108:109], v7 offset:2048
  ds_read_b64_tr_b16 v[110:111], v7 offset:3072
  buffer_load_dwordx4 a[20:23], v1, s[28:31], s9 offen offset:3072 sc1
  v_mfma_f32_32x32x16_bf16 v[16:31], v[48:51], a[240:243], v[16:31]
  s_lshl_b32 s9, s8, 13
  ds_read_b64_tr_b16 v[112:113], v11 offset:4096
  ds_read_b64_tr_b16 v[114:115], v11 offset:5120
  v_mfma_f32_32x32x16_bf16 v[32:47], v[52:55], a[240:243], v[32:47]
  s_add_u32 s9, s9, s53
  ds_read_b64_tr_b16 v[116:117], v7 offset:4096
  ds_read_b64_tr_b16 v[118:119], v7 offset:5120
  s_add_u32 s8, s8, 1
  s_cmp_eq_u32 s8, 7
  s_cselect_b32 s8, 0, s8
  buffer_load_dwordx4 a[24:27], v1, s[28:31], s9 offen offset:0 sc1
  v_mfma_f32_32x32x16_bf16 v[16:31], v[56:59], a[244:247], v[16:31]
  s_waitcnt lgkmcnt(4)
  ds_read_b64_tr_b16 v[80:81], v11 offset:6144
  ds_read_b64_tr_b16 v[82:83], v11 offset:7168
  v_mfma_f32_32x32x16_bf16 v[32:47], v[60:63], a[244:247], v[32:47]
  s_waitcnt vmcnt(9)
  ds_read_b64_tr_b16 v[84:85], v7 offset:6144
  ds_read_b64_tr_b16 v[86:87], v7 offset:7168
  buffer_load_dwordx4 a[28:31], v1, s[28:31], s9 offen offset:1024 sc1
  v_mfma_f32_32x32x16_bf16 v[16:31], v[96:99], a[248:251], v[16:31]
  s_lshl_b32 s49, s44, 6
  ds_read_b64_tr_b16 v[48:49], v11 offset:8192
  ds_read_b64_tr_b16 v[50:51], v11 offset:9216
  v_mfma_f32_32x32x16_bf16 v[32:47], v[100:103], a[248:251], v[32:47]
  s_lshl_b32 s50, s41, 2
  ds_read_b64_tr_b16 v[52:53], v7 offset:8192
  ds_read_b64_tr_b16 v[54:55], v7 offset:9216
  s_waitcnt vmcnt(8)
  s_add_u32 s49, s49, s50
  s_add_u32 s49, s49, 12288
  s_mov_b64 exec, 1
  buffer_store_dword v13, off, s[28:31], s49 sc0 sc1
  s_mov_b64 exec, -1
  buffer_load_dwordx4 a[32:35], v1, s[28:31], s9 offen offset:2048 sc1
  v_mfma_f32_32x32x16_bf16 v[16:31], v[104:107], a[252:255], v[16:31]
  s_waitcnt lgkmcnt(4)
  ds_read_b64_tr_b16 v[56:57], v11 offset:10240
  ds_read_b64_tr_b16 v[58:59], v11 offset:11264
  v_mfma_f32_32x32x16_bf16 v[32:47], v[108:111], a[252:255], v[32:47]
  s_waitcnt vmcnt(8)
  ds_read_b64_tr_b16 v[60:61], v7 offset:10240
  ds_read_b64_tr_b16 v[62:63], v7 offset:11264
  v_add_u32 v5, 131072, v8
  v_add_u32 v6, 131072, v9
  buffer_load_dwordx4 a[36:39], v1, s[28:31], s9 offen offset:3072 sc1
  v_mfma_f32_32x32x16_bf16 v[16:31], v[112:115], a[0:3], v[16:31]
  s_add_u32 s9, s9, 4096
  ds_read_b64_tr_b16 v[96:97], v11 offset:12288
  ds_read_b64_tr_b16 v[98:99], v11 offset:13312
  v_mfma_f32_32x32x16_bf16 v[32:47], v[116:119], a[0:3], v[32:47]
  s_add_u32 s11, s10, 5
  ds_read_b64_tr_b16 v[100:101], v7 offset:12288
  ds_read_b64_tr_b16 v[102:103], v7 offset:13312
  buffer_load_dwordx4 a[40:43], v1, s[28:31], s9 offen offset:0 sc1
  v_mfma_f32_32x32x16_bf16 v[16:31], v[80:83], a[4:7], v[16:31]
  s_waitcnt lgkmcnt(4)
  ds_read_b64_tr_b16 v[104:105], v11 offset:14336
  ds_read_b64_tr_b16 v[106:107], v11 offset:15360
  v_mfma_f32_32x32x16_bf16 v[32:47], v[84:87], a[4:7], v[32:47]
  s_waitcnt vmcnt(8)
  ds_read_b64_tr_b16 v[108:109], v7 offset:14336
  ds_read_b64_tr_b16 v[110:111], v7 offset:15360
  buffer_load_dwordx4 a[44:47], v1, s[28:31], s9 offen offset:1024 sc1
  v_mfma_f32_32x32x16_bf16 v[16:31], v[48:51], a[8:11], v[16:31]
  s_barrier
  ds_read_b64_tr_b16 v[112:113], v5 offset:0
  ds_read_b64_tr_b16 v[114:115], v5 offset:1024
  v_mfma_f32_32x32x16_bf16 v[32:47], v[52:55], a[8:11], v[32:47]
  s_cmp_ge_u32 s11, 7
  ds_read_b64_tr_b16 v[116:117], v6 offset:0
  ds_read_b64_tr_b16 v[118:119], v6 offset:1024
  buffer_load_dwordx4 a[48:51], v1, s[28:31], s9 offen offset:2048 sc1
  s_cselect_b32 s51, 7, 0
  s_sub_u32 s11, s11, s51
  s_lshl_b32 s11, s11, 17
  s_add_u32 s11, s11, s59
  s_add_u32 m0, s56, 0
  s_add_u32 s48, s11, 0
  buffer_load_dwordx4 v2, s[20:23], s48 offen lds
  v_mfma_f32_32x32x16_bf16 v[16:31], v[56:59], a[12:15], v[16:31]
  s_waitcnt lgkmcnt(4)
  ds_read_b64_tr_b16 v[80:81], v5 offset:2048
  ds_read_b64_tr_b16 v[82:83], v5 offset:3072
  v_mfma_f32_32x32x16_bf16 v[32:47], v[60:63], a[12:15], v[32:47]
  s_waitcnt vmcnt(9)
  ds_read_b64_tr_b16 v[84:85], v6 offset:2048
  ds_read_b64_tr_b16 v[86:87], v6 offset:3072
  buffer_load_dwordx4 a[52:55], v1, s[28:31], s9 offen offset:3072 sc1
  s_add_u32 m0, s56, 1024
  s_add_u32 s48, s11, 8192
  buffer_load_dwordx4 v2, s[20:23], s48 offen lds
  v_mfma_f32_32x32x16_bf16 v[16:31], v[96:99], a[16:19], v[16:31]
  s_lshl_b32 s9, s8, 13
  ds_read_b64_tr_b16 v[48:49], v5 offset:4096
  ds_read_b64_tr_b16 v[50:51], v5 offset:5120
  v_mfma_f32_32x32x16_bf16 v[32:47], v[100:103], a[16:19], v[32:47]
  s_add_u32 s9, s9, s53
  ds_read_b64_tr_b16 v[52:53], v6 offset:4096
  ds_read_b64_tr_b16 v[54:55], v6 offset:5120
  s_add_u32 s8, s8, 1
  s_cmp_eq_u32 s8, 7
  s_cselect_b32 s8, 0, s8
  buffer_load_dwordx4 a[56:59], v1, s[28:31], s9 offen offset:0 sc1
  s_add_u32 m0, s56, 2048
  s_add_u32 s48, s11, 16384
  buffer_load_dwordx4 v2, s[20:23], s48 offen lds
  v_mfma_f32_32x32x16_bf16 v[16:31], v[104:107], a[20:23], v[16:31]
  s_waitcnt lgkmcnt(4)
  ds_read_b64_tr_b16 v[56:57], v5 offset:6144
  ds_read_b64_tr_b16 v[58:59], v5 offset:7168
  v_mfma_f32_32x32x16_bf16 v[32:47], v[108:111], a[20:23], v[32:47]
  s_waitcnt vmcnt(11)
  ds_read_b64_tr_b16 v[60:61], v6 offset:6144
  ds_read_b64_tr_b16 v[62:63], v6 offset:7168
  buffer_load_dwordx4 a[60:63], v1, s[28:31], s9 offen offset:1024 sc1
  s_add_u32 m0, s56, 3072
  s_add_u32 s48, s11, 24576
  buffer_load_dwordx4 v2, s[20:23], s48 offen lds
  v_mfma_f32_32x32x16_bf16 v[16:31], v[112:115], a[24:27], v[16:31]
  s_add_u32 m0, s56, 4096
  ds_read_b64_tr_b16 v[96:97], v5 offset:8192
  ds_read_b64_tr_b16 v[98:99], v5 offset:9216
  v_mfma_f32_32x32x16_bf16 v[32:47], v[116:119], a[24:27], v[32:47]
  s_add_u32 s48, s11, 32768
  ds_read_b64_tr_b16 v[100:101], v6 offset:8192
  ds_read_b64_tr_b16 v[102:103], v6 offset:9216
  buffer_load_dwordx4 a[64:67], v1, s[28:31], s9 offen offset:2048 sc1
  buffer_load_dwordx4 v2, s[20:23], s48 offen lds
  v_mfma_f32_32x32x16_bf16 v[16:31], v[80:83], a[28:31], v[16:31]
  s_waitcnt lgkmcnt(4)
  ds_read_b64_tr_b16 v[104:105], v5 offset:10240
  ds_read_b64_tr_b16 v[106:107], v5 offset:11264
  v_mfma_f32_32x32x16_bf16 v[32:47], v[84:87], a[28:31], v[32:47]
  s_waitcnt vmcnt(12)
  ds_read_b64_tr_b16 v[108:109], v6 offset:10240
  ds_read_b64_tr_b16 v[110:111], v6 offset:11264
  v_add_u32 v11, 32768, v8
  v_add_u32 v7, 32768, v9
  buffer_load_dwordx4 a[68:71], v1, s[28:31], s9 offen offset:3072 sc1
  s_add_u32 m0, s56, 5120
  s_add_u32 s48, s11, 40960
  buffer_load_dwordx4 v2, s[20:23], s48 offen lds
  v_mfma_f32_32x32x16_bf16 v[16:31], v[48:51], a[32:35], v[16:31]
  s_add_u32 s9, s9, 4096
  ds_read_b64_tr_b16 v[112:113], v5 offset:12288
  ds_read_b64_tr_b16 v[114:115], v5 offset:13312
  v_mfma_f32_32x32x16_bf16 v[32:47], v[52:55], a[32:35], v[32:47]
  s_add_u32 m0, s56, 6144
  ds_read_b64_tr_b16 v[116:117], v6 offset:12288
  ds_read_b64_tr_b16 v[118:119], v6 offset:13312
  buffer_load_dwordx4 a[72:75], v1, s[28:31], s9 offen offset:0 sc1
  s_add_u32 s48, s11, 49152
  buffer_load_dwordx4 v2, s[20:23], s48 offen lds
  v_mfma_f32_32x32x16_bf16 v[16:31], v[56:59], a[36:39], v[16:31]
  s_waitcnt lgkmcnt(4)
  ds_read_b64_tr_b16 v[80:81], v5 offset:14336
  ds_read_b64_tr_b16 v[82:83], v5 offset:15360
  v_mfma_f32_32x32x16_bf16 v[32:47], v[60:63], a[36:39], v[32:47]
  s_waitcnt vmcnt(14)
  ds_read_b64_tr_b16 v[84:85], v6 offset:14336
  ds_read_b64_tr_b16 v[86:87], v6 offset:15360
  buffer_load_dwordx4 a[76:79], v1, s[28:31], s9 offen offset:1024 sc1
  s_add_u32 m0, s56, 7168
  s_add_u32 s48, s11, 57344
  buffer_load_dwordx4 v2, s[20:23], s48 offen lds
  v_mfma_f32_32x32x16_bf16 v[16:31], v[96:99], a[40:43], v[16:31]
  s_barrier
  ds_read_b64_tr_b16 v[48:49], v11 offset:0
  ds_read_b64_tr_b16 v[50:51], v11 offset:1024
  v_mfma_f32_32x32x16_bf16 v[32:47], v[100:103], a[40:43], v[32:47]
  s_add_u32 s11, s10, 6
  ds_read_b64_tr_b16 v[52:53], v7 offset:0
  ds_read_b64_tr_b16 v[54:55], v7 offset:1024
  buffer_load_dwordx4 a[80:83], v1, s[28:31], s9 offen offset:2048 sc1
  s_cmp_ge_u32 s11, 7
  s_cselect_b32 s51, 7, 0
  s_sub_u32 s11, s11, s51
  s_lshl_b32 s11, s11, 17
  s_add_u32 s11, s11, s59
  s_add_u32 m0, s56, 98304
  s_add_u32 s48, s11, 0
  buffer_load_dwordx4 v2, s[20:23], s48 offen lds
  v_mfma_f32_32x32x16_bf16 v[16:31], v[104:107], a[44:47], v[16:31]
  s_waitcnt lgkmcnt(4)
  ds_read_b64_tr_b16 v[56:57], v11 offset:2048
  ds_read_b64_tr_b16 v[58:59], v11 offset:3072
  v_mfma_f32_32x32x16_bf16 v[32:47], v[108:111], a[44:47], v[32:47]
  s_waitcnt vmcnt(15)
  ds_read_b64_tr_b16 v[60:61], v7 offset:2048
  ds_read_b64_tr_b16 v[62:63], v7 offset:3072
  buffer_load_dwordx4 a[84:87], v1, s[28:31], s9 offen offset:3072 sc1
  s_add_u32 m0, s56, 99328
  s_add_u32 s48, s11, 8192
  buffer_load_dwordx4 v2, s[20:23], s48 offen lds
  v_mfma_f32_32x32x16_bf16 v[16:31], v[112:115], a[48:51], v[16:31]
  s_lshl_b32 s9, s8, 13
  ds_read_b64_tr_b16 v[96:97], v11 offset:4096
  ds_read_b64_tr_b16 v[98:99], v11 offset:5120
  v_mfma_f32_32x32x16_bf16 v[32:47], v[116:119], a[48:51], v[32:47]
  s_add_u32 s9, s9, s53
  ds_read_b64_tr_b16 v[100:101], v7 offset:4096
  ds_read_b64_tr_b16 v[102:103], v7 offset:5120
  s_add_u32 s8, s8, 1
  s_cmp_eq_u32 s8, 7
  s_cselect_b32 s8, 0, s8
  buffer_load_dwordx4 a[88:91], v1, s[28:31], s9 offen offset:0 sc1
  s_add_u32 m0, s56, 100352
  s_add_u32 s48, s11, 16384
  buffer_load_dwordx4 v2, s[20:23], s48 offen lds
  v_mfma_f32_32x32x16_bf16 v[16:31], v[80:83], a[52:55], v[16:31]
  s_waitcnt lgkmcnt(4)
  ds_read_b64_tr_b16 v[104:105], v11 offset:6144
  ds_read_b64_tr_b16 v[106:107], v11 offset:7168
  v_mfma_f32_32x32x16_bf16 v[32:47], v[84:87], a[52:55], v[32:47]
  s_waitcnt vmcnt(15)
  ds_read_b64_tr_b16 v[108:109], v7 offset:6144
  ds_read_b64_tr_b16 v[110:111], v7 offset:7168
  buffer_load_dwordx4 a[92:95], v1, s[28:31], s9 offen offset:1024 sc1
  s_add_u32 m0, s56, 101376
  s_add_u32 s48, s11, 24576
  buffer_load_dwordx4 v2, s[20:23], s48 offen lds
  v_mfma_f32_32x32x16_bf16 v[16:31], v[48:51], a[56:59], v[16:31]
  s_add_u32 m0, s56, 102400
  ds_read_b64_tr_b16 v[112:113], v11 offset:8192
  ds_read_b64_tr_b16 v[114:115], v11 offset:9216
  v_mfma_f32_32x32x16_bf16 v[32:47], v[52:55], a[56:59], v[32:47]
  s_add_u32 s48, s11, 32768
  ds_read_b64_tr_b16 v[116:117], v7 offset:8192
  ds_read_b64_tr_b16 v[118:119], v7 offset:9216
  buffer_load_dwordx4 a[96:99], v1, s[28:31], s9 offen offset:2048 sc1
  buffer_load_dwordx4 v2, s[20:23], s48 offen lds
  v_mfma_f32_32x32x16_bf16 v[16:31], v[56:59], a[60:63], v[16:31]
  s_waitcnt lgkmcnt(4)
  ds_read_b64_tr_b16 v[80:81], v11 offset:10240
  ds_read_b64_tr_b16 v[82:83], v11 offset:11264
  v_mfma_f32_32x32x16_bf16 v[32:47], v[60:63], a[60:63], v[32:47]
  s_waitcnt vmcnt(15)
  ds_read_b64_tr_b16 v[84:85], v7 offset:10240
  ds_read_b64_tr_b16 v[86:87], v7 offset:11264
  v_add_u32 v5, 65536, v8
  v_add_u32 v6, 65536, v9
  buffer_load_dwordx4 a[100:103], v1, s[28:31], s9 offen offset:3072 sc1
  s_add_u32 m0, s56, 103424
  s_add_u32 s48, s11, 40960
  buffer_load_dwordx4 v2, s[20:23], s48 offen lds
  v_mfma_f32_32x32x16_bf16 v[16:31], v[96:99], a[64:67], v[16:31]
  s_add_u32 s9, s9, 4096
  ds_read_b64_tr_b16 v[48:49], v11 offset:12288
  ds_read_b64_tr_b16 v[50:51], v11 offset:13312
  v_mfma_f32_32x32x16_bf16 v[32:47], v[100:103], a[64:67], v[32:47]
  s_add_u32 m0, s56, 104448
  ds_read_b64_tr_b16 v[52:53], v7 offset:12288
  ds_read_b64_tr_b16 v[54:55], v7 offset:13312
  buffer_load_dwordx4 a[104:107], v1, s[28:31], s9 offen offset:0 sc1
  s_add_u32 s48, s11, 49152
  buffer_load_dwordx4 v2, s[20:23], s48 offen lds
  v_mfma_f32_32x32x16_bf16 v[16:31], v[104:107], a[68:71], v[16:31]
  s_waitcnt lgkmcnt(4)
  ds_read_b64_tr_b16 v[56:57], v11 offset:14336
  ds_read_b64_tr_b16 v[58:59], v11 offset:15360
  v_mfma_f32_32x32x16_bf16 v[32:47], v[108:111], a[68:71], v[32:47]
  s_waitcnt vmcnt(15)
  ds_read_b64_tr_b16 v[60:61], v7 offset:14336
  ds_read_b64_tr_b16 v[62:63], v7 offset:15360
  buffer_load_dwordx4 a[108:111], v1, s[28:31], s9 offen offset:1024 sc1
  s_add_u32 m0, s56, 105472
  s_add_u32 s48, s11, 57344
  buffer_load_dwordx4 v2, s[20:23], s48 offen lds
  v_mfma_f32_32x32x16_bf16 v[16:31], v[112:115], a[72:75], v[16:31]
  s_barrier
  ds_read_b64_tr_b16 v[96:97], v5 offset:0
  ds_read_b64_tr_b16 v[98:99], v5 offset:1024
  v_mfma_f32_32x32x16_bf16 v[32:47], v[116:119], a[72:75], v[32:47]
  s_add_u32 s50, s56, 131072
  ds_read_b64_tr_b16 v[100:101], v6 offset:0
  ds_read_b64_tr_b16 v[102:103], v6 offset:1024
  buffer_load_dwordx4 a[112:115], v1, s[28:31], s9 offen offset:2048 sc1
  v_add_u32 v4, s50, v1
  v_mfma_f32_32x32x16_bf16 v[16:31], v[80:83], a[76:79], v[16:31]
  s_waitcnt lgkmcnt(4)
  ds_read_b64_tr_b16 v[104:105], v5 offset:2048
  ds_read_b64_tr_b16 v[106:107], v5 offset:3072
  v_mfma_f32_32x32x16_bf16 v[32:47], v[84:87], a[76:79], v[32:47]
  s_waitcnt vmcnt(14)
  ds_read_b64_tr_b16 v[108:109], v6 offset:2048
  ds_read_b64_tr_b16 v[110:111], v6 offset:3072
  buffer_load_dwordx4 a[116:119], v1, s[28:31], s9 offen offset:3072 sc1
  ds_write_b128 v4, v[192:195] offset:0
  v_mfma_f32_32x32x16_bf16 v[16:31], v[48:51], a[80:83], v[16:31]
  s_add_u32 s50, s55, 12288
  ds_read_b64_tr_b16 v[112:113], v5 offset:4096
  ds_read_b64_tr_b16 v[114:115], v5 offset:5120
  v_mfma_f32_32x32x16_bf16 v[32:47], v[52:55], a[80:83], v[32:47]
  s_lshl_b32 s9, s8, 13
  ds_read_b64_tr_b16 v[116:117], v6 offset:4096
  ds_read_b64_tr_b16 v[118:119], v6 offset:5120
  buffer_load_dword v14, v12, s[28:31], s50 offen sc1
  s_add_u32 s9, s9, s53
  s_add_u32 s8, s8, 1
  buffer_load_dwordx4 a[120:123], v1, s[28:31], s9 offen offset:0 sc1
  ds_write_b128 v4, v[196:199] offset:1024
  v_mfma_f32_32x32x16_bf16 v[16:31], v[56:59], a[84:87], v[16:31]
  s_waitcnt lgkmcnt(6)
  ds_read_b64_tr_b16 v[80:81], v5 offset:6144
  ds_read_b64_tr_b16 v[82:83], v5 offset:7168
  v_mfma_f32_32x32x16_bf16 v[32:47], v[60:63], a[84:87], v[32:47]
  s_waitcnt vmcnt(13)
  ds_read_b64_tr_b16 v[84:85], v6 offset:6144
  ds_read_b64_tr_b16 v[86:87], v6 offset:7168
  buffer_load_dwordx4 a[124:127], v1, s[28:31], s9 offen offset:1024 sc1
  ds_write_b128 v4, v[200:203] offset:2048
  v_mfma_f32_32x32x16_bf16 v[16:31], v[96:99], a[88:91], v[16:31]
  s_cmp_eq_u32 s8, 7
  ds_read_b64_tr_b16 v[48:49], v5 offset:8192
  ds_read_b64_tr_b16 v[50:51], v5 offset:9216
  v_mfma_f32_32x32x16_bf16 v[32:47], v[100:103], a[88:91], v[32:47]
  s_cselect_b32 s8, 0, s8
  ds_read_b64_tr_b16 v[52:53], v6 offset:8192
  ds_read_b64_tr_b16 v[54:55], v6 offset:9216
  buffer_load_dwordx4 a[128:131], v1, s[28:31], s9 offen offset:2048 sc1
  ds_write_b128 v4, v[204:207] offset:3072
  v_mfma_f32_32x32x16_bf16 v[16:31], v[104:107], a[92:95], v[16:31]
  s_waitcnt lgkmcnt(6)
  ds_read_b64_tr_b16 v[56:57], v5 offset:10240
  ds_read_b64_tr_b16 v[58:59], v5 offset:11264
  v_mfma_f32_32x32x16_bf16 v[32:47], v[108:111], a[92:95], v[32:47]
  s_waitcnt vmcnt(11)
  ds_read_b64_tr_b16 v[60:61], v6 offset:10240
  ds_read_b64_tr_b16 v[62:63], v6 offset:11264
  v_add_u32 v11, 0, v8
  v_add_u32 v7, 0, v9
  buffer_load_dwordx4 a[132:135], v1, s[28:31], s9 offen offset:3072 sc1
  ds_write_b128 v4, v[208:211] offset:4096
  v_mfma_f32_32x32x16_bf16 v[16:31], v[112:115], a[96:99], v[16:31]
  s_add_u32 s9, s9, 4096
  ds_read_b64_tr_b16 v[96:97], v5 offset:12288
  ds_read_b64_tr_b16 v[98:99], v5 offset:13312
  v_mfma_f32_32x32x16_bf16 v[32:47], v[116:119], a[96:99], v[32:47]
  s_add_u32 s50, s56, 32768
  ds_read_b64_tr_b16 v[100:101], v6 offset:12288
  ds_read_b64_tr_b16 v[102:103], v6 offset:13312
  buffer_load_dwordx4 a[136:139], v1, s[28:31], s9 offen offset:0 sc1
  ds_write_b128 v4, v[212:215] offset:5120
  v_mfma_f32_32x32x16_bf16 v[16:31], v[80:83], a[100:103], v[16:31]
  s_waitcnt lgkmcnt(6)
  ds_read_b64_tr_b16 v[104:105], v5 offset:14336
  ds_read_b64_tr_b16 v[106:107], v5 offset:15360
  v_mfma_f32_32x32x16_bf16 v[32:47], v[84:87], a[100:103], v[32:47]
  s_waitcnt vmcnt(9)
  ds_read_b64_tr_b16 v[108:109], v6 offset:14336
  ds_read_b64_tr_b16 v[110:111], v6 offset:15360
  buffer_load_dwordx4 a[140:143], v1, s[28:31], s9 offen offset:1024 sc1
  ds_write_b128 v4, v[216:219] offset:6144
  v_mfma_f32_32x32x16_bf16 v[16:31], v[48:51], a[104:107], v[16:31]
  s_barrier
  ds_read_b64_tr_b16 v[112:113], v11 offset:0
  ds_read_b64_tr_b16 v[114:115], v11 offset:1024
  v_mfma_f32_32x32x16_bf16 v[32:47], v[52:55], a[104:107], v[32:47]
  ds_read_b64_tr_b16 v[116:117], v7 offset:0
  ds_read_b64_tr_b16 v[118:119], v7 offset:1024
  buffer_load_dwordx4 a[144:147], v1, s[28:31], s9 offen offset:2048 sc1
  ds_write_b128 v4, v[220:223] offset:7168
  v_add_u32 v4, s50, v1
  v_mfma_f32_32x32x16_bf16 v[16:31], v[56:59], a[108:111], v[16:31]
  s_waitcnt lgkmcnt(6)
  ds_read_b64_tr_b16 v[80:81], v11 offset:2048
  ds_read_b64_tr_b16 v[82:83], v11 offset:3072
  v_mfma_f32_32x32x16_bf16 v[32:47], v[60:63], a[108:111], v[32:47]
  s_waitcnt vmcnt(8)
  ds_read_b64_tr_b16 v[84:85], v7 offset:2048
  ds_read_b64_tr_b16 v[86:87], v7 offset:3072
  buffer_load_dwordx4 a[148:151], v1, s[28:31], s9 offen offset:3072 sc1
  ds_write_b128 v4, v[224:227] offset:0
  v_mfma_f32_32x32x16_bf16 v[16:31], v[96:99], a[112:115], v[16:31]
  s_lshl_b32 s9, s8, 13
  ds_read_b64_tr_b16 v[48:49], v11 offset:4096
  ds_read_b64_tr_b16 v[50:51], v11 offset:5120
  v_mfma_f32_32x32x16_bf16 v[32:47], v[100:103], a[112:115], v[32:47]
  s_add_u32 s9, s9, s53
  ds_read_b64_tr_b16 v[52:53], v7 offset:4096
  ds_read_b64_tr_b16 v[54:55], v7 offset:5120
  s_add_u32 s8, s8, 1
  buffer_load_dwordx4 a[152:155], v1, s[28:31], s9 offen offset:0 sc1
  ds_write_b128 v4, v[228:231] offset:1024
  v_mfma_f32_32x32x16_bf16 v[16:31], v[104:107], a[116:119], v[16:31]
  s_waitcnt lgkmcnt(6)
  ds_read_b64_tr_b16 v[56:57], v11 offset:6144
  ds_read_b64_tr_b16 v[58:59], v11 offset:7168
  v_mfma_f32_32x32x16_bf16 v[32:47], v[108:111], a[116:119], v[32:47]
  s_waitcnt vmcnt(7)
  ds_read_b64_tr_b16 v[60:61], v7 offset:6144
  ds_read_b64_tr_b16 v[62:63], v7 offset:7168
  buffer_load_dwordx4 a[156:159], v1, s[28:31], s9 offen offset:1024 sc1
  ds_write_b128 v4, v[232:235] offset:2048
  v_mfma_f32_32x32x16_bf16 v[16:31], v[112:115], a[120:123], v[16:31]
  s_cmp_eq_u32 s8, 7
  ds_read_b64_tr_b16 v[96:97], v11 offset:8192
  ds_read_b64_tr_b16 v[98:99], v11 offset:9216
  v_mfma_f32_32x32x16_bf16 v[32:47], v[116:119], a[120:123], v[32:47]
  s_cselect_b32 s8, 0, s8
  ds_read_b64_tr_b16 v[100:101], v7 offset:8192
  ds_read_b64_tr_b16 v[102:103], v7 offset:9216
  v_cmp_ne_u32 vcc, s43, v14
  s_nop 0
  s_cbranch_vccnz L_spin_o
L_back_o:
  buffer_load_dwordx4 a[160:163], v1, s[28:31], s9 offen offset:2048 sc1
  s_add_u32 s17, s54, 0
  buffer_load_dwordx4 a[184:187], v1, s[28:31], s17 offen offset:0 sc1
  ds_write_b128 v4, v[236:239] offset:3072
  v_mfma_f32_32x32x16_bf16 v[16:31], v[80:83], a[124:127], v[16:31]
  s_waitcnt lgkmcnt(6)
  ds_read_b64_tr_b16 v[104:105], v11 offset:10240
  ds_read_b64_tr_b16 v[106:107], v11 offset:11264
  v_mfma_f32_32x32x16_bf16 v[32:47], v[84:87], a[124:127], v[32:47]
  s_waitcnt vmcnt(8)
  ds_read_b64_tr_b16 v[108:109], v7 offset:10240
  ds_read_b64_tr_b16 v[110:111], v7 offset:11264
  v_add_u32 v5, 98304, v8
  v_add_u32 v6, 98304, v9
  buffer_load_dwordx4 a[164:167], v1, s[28:31], s9 offen offset:3072 sc1
  buffer_load_dwordx4 a[188:191], v1, s[28:31], s17 offen offset:1024 sc1
  ds_write_b128 v4, v[240:243] offset:4096
  v_mfma_f32_32x32x16_bf16 v[16:31], v[48:51], a[128:131], v[16:31]
  s_add_u32 s9, s9, 4096
  ds_read_b64_tr_b16 v[112:113], v11 offset:12288
  ds_read_b64_tr_b16 v[114:115], v11 offset:13312
  v_mfma_f32_32x32x16_bf16 v[32:47], v[52:55], a[128:131], v[32:47]
  ds_read_b64_tr_b16 v[116:117], v7 offset:12288
  ds_read_b64_tr_b16 v[118:119], v7 offset:13312
  buffer_load_dwordx4 a[168:171], v1, s[28:31], s9 offen offset:0 sc1
  buffer_load_dwordx4 a[192:195], v1, s[28:31], s17 offen offset:2048 sc1
  ds_write_b128 v4, v[244:247] offset:5120
  v_mfma_f32_32x32x16_bf16 v[16:31], v[56:59], a[132:135], v[16:31]
  s_waitcnt lgkmcnt(6)
  ds_read_b64_tr_b16 v[80:81], v11 offset:14336
  ds_read_b64_tr_b16 v[82:83], v11 offset:15360
  v_mfma_f32_32x32x16_bf16 v[32:47], v[60:63], a[132:135], v[32:47]
  s_waitcnt vmcnt(10)
  ds_read_b64_tr_b16 v[84:85], v7 offset:14336
  ds_read_b64_tr_b16 v[86:87], v7 offset:15360
  buffer_load_dwordx4 a[172:175], v1, s[28:31], s9 offen offset:1024 sc1
  buffer_load_dwordx4 a[196:199], v1, s[28:31], s17 offen offset:3072 sc1
  ds_write_b128 v4, v[248:251] offset:6144
  v_mfma_f32_32x32x16_bf16 v[16:31], v[96:99], a[136:139], v[16:31]
  s_barrier
  ds_read_b64_tr_b16 v[48:49], v5 offset:0
  ds_read_b64_tr_b16 v[50:51], v5 offset:1024
  v_mfma_f32_32x32x16_bf16 v[32:47], v[100:103], a[136:139], v[32:47]
  s_add_u32 s17, s54, 4096
  ds_read_b64_tr_b16 v[52:53], v6 offset:0
  ds_read_b64_tr_b16 v[54:55], v6 offset:1024
  buffer_load_dwordx4 a[176:179], v1, s[28:31], s9 offen offset:2048 sc1
  buffer_load_dwordx4 a[200:203], v1, s[28:31], s17 offen offset:0 sc1
  ds_write_b128 v4, v[252:255] offset:7168
  v_mfma_f32_32x32x16_bf16 v[16:31], v[104:107], a[140:143], v[16:31]
  s_waitcnt lgkmcnt(6)
  ds_read_b64_tr_b16 v[56:57], v5 offset:2048
  ds_read_b64_tr_b16 v[58:59], v5 offset:3072
  v_mfma_f32_32x32x16_bf16 v[32:47], v[108:111], a[140:143], v[32:47]
  s_waitcnt vmcnt(12)
  ds_read_b64_tr_b16 v[60:61], v6 offset:2048
  ds_read_b64_tr_b16 v[62:63], v6 offset:3072
  buffer_load_dwordx4 a[180:183], v1, s[28:31], s9 offen offset:3072 sc1
  buffer_load_dwordx4 a[204:207], v1, s[28:31], s17 offen offset:1024 sc1
  v_mfma_f32_32x32x16_bf16 v[16:31], v[112:115], a[144:147], v[16:31]
  s_or_b32 s50, s2, s42
  ds_read_b64_tr_b16 v[96:97], v5 offset:4096
  ds_read_b64_tr_b16 v[98:99], v5 offset:5120
  v_mfma_f32_32x32x16_bf16 v[32:47], v[116:119], a[144:147], v[32:47]
  s_cmp_eq_u32 s50, 0
  ds_read_b64_tr_b16 v[100:101], v6 offset:4096
  ds_read_b64_tr_b16 v[102:103], v6 offset:5120
  buffer_load_dwordx4 a[208:211], v1, s[28:31], s17 offen offset:2048 sc1
  s_cbranch_scc1 L_epre
L_epre_back:
  v_mfma_f32_32x32x16_bf16 v[16:31], v[80:83], a[148:151], v[16:31]
  s_waitcnt lgkmcnt(4)
  ds_read_b64_tr_b16 v[104:105], v5 offset:6144
  ds_read_b64_tr_b16 v[106:107], v5 offset:7168
  v_mfma_f32_32x32x16_bf16 v[32:47], v[84:87], a[148:151], v[32:47]
  s_waitcnt vmcnt(13)
  ds_read_b64_tr_b16 v[108:109], v6 offset:6144
  ds_read_b64_tr_b16 v[110:111], v6 offset:7168
  buffer_load_dwordx4 a[212:215], v1, s[28:31], s17 offen offset:3072 sc1
  v_mfma_f32_32x32x16_bf16 v[16:31], v[48:51], a[152:155], v[16:31]
  s_add_u32 s17, s54, 8192
  ds_read_b64_tr_b16 v[112:113], v5 offset:8192
  ds_read_b64_tr_b16 v[114:115], v5 offset:9216
  v_mfma_f32_32x32x16_bf16 v[32:47], v[52:55], a[152:155], v[32:47]
  ds_read_b64_tr_b16 v[116:117], v6 offset:8192
  ds_read_b64_tr_b16 v[118:119], v6 offset:9216
  buffer_load_dwordx4 a[216:219], v1, s[28:31], s17 offen offset:0 sc1
  v_mfma_f32_32x32x16_bf16 v[16:31], v[56:59], a[156:159], v[16:31]
  s_waitcnt lgkmcnt(4)
  ds_read_b64_tr_b16 v[80:81], v5 offset:10240
  ds_read_b64_tr_b16 v[82:83], v5 offset:11264
  v_mfma_f32_32x32x16_bf16 v[32:47], v[60:63], a[156:159], v[32:47]
  s_waitcnt vmcnt(12)
  ds_read_b64_tr_b16 v[84:85], v6 offset:10240
  ds_read_b64_tr_b16 v[86:87], v6 offset:11264
  v_add_u32 v11, 131072, v8
  v_add_u32 v7, 131072, v9
  buffer_load_dwordx4 a[220:223], v1, s[28:31], s17 offen offset:1024 sc1
  v_mfma_f32_32x32x16_bf16 v[16:31], v[96:99], a[160:163], v[16:31]
  ds_read_b64_tr_b16 v[48:49], v5 offset:12288
  ds_read_b64_tr_b16 v[50:51], v5 offset:13312
  v_mfma_f32_32x32x16_bf16 v[32:47], v[100:103], a[160:163], v[32:47]
  ds_read_b64_tr_b16 v[52:53], v6 offset:12288
  ds_read_b64_tr_b16 v[54:55], v6 offset:13312
  buffer_load_dwordx4 a[224:227], v1, s[28:31], s17 offen offset:2048 sc1
  v_and_b32 v3, 31, v0
  v_lshlrev_b32 v3, 10, v3
  v_lshrrev_b32 v15, 5, v0
  v_lshl_add_u32 v3, v15, 3, v3
  v_mfma_f32_32x32x16_bf16 v[16:31], v[104:107], a[164:167], v[16:31]
  s_waitcnt lgkmcnt(4)
  ds_read_b64_tr_b16 v[56:57], v5 offset:14336
  ds_read_b64_tr_b16 v[58:59], v5 offset:15360
  v_mfma_f32_32x32x16_bf16 v[32:47], v[108:111], a[164:167], v[32:47]
  s_waitcnt vmcnt(10)
  ds_read_b64_tr_b16 v[60:61], v6 offset:14336
  ds_read_b64_tr_b16 v[62:63], v6 offset:15360
  buffer_load_dwordx4 a[228:231], v1, s[28:31], s17 offen offset:3072 sc1
  buffer_load_dwordx2 v[168:169], v3, s[4:7], s45 offen offset:0
  v_mfma_f32_32x32x16_bf16 v[16:31], v[112:115], a[168:171], v[16:31]
  s_barrier
  ds_read_b64_tr_b16 v[96:97], v11 offset:0
  ds_read_b64_tr_b16 v[98:99], v11 offset:1024
  v_mfma_f32_32x32x16_bf16 v[32:47], v[116:119], a[168:171], v[32:47]
  s_add_u32 s17, s54, 12288
  ds_read_b64_tr_b16 v[100:101], v7 offset:0
  ds_read_b64_tr_b16 v[102:103], v7 offset:1024
  buffer_load_dwordx4 a[232:235], v1, s[28:31], s17 offen offset:0 sc1
  buffer_load_dwordx2 v[170:171], v3, s[4:7], s45 offen offset:16
  s_add_u32 s50, s56, 65536
  v_add_u32 v12, s50, v1
  s_xor_b32 s50, s50, 16384
  v_add_u32 v14, s50, v1
  v_mfma_f32_32x32x16_bf16 v[16:31], v[80:83], a[172:175], v[16:31]
  s_waitcnt lgkmcnt(4)
  ds_read_b64_tr_b16 v[104:105], v11 offset:2048
  ds_read_b64_tr_b16 v[106:107], v11 offset:3072
  v_mfma_f32_32x32x16_bf16 v[32:47], v[84:87], a[172:175], v[32:47]
  s_waitcnt vmcnt(10)
  ds_read_b64_tr_b16 v[108:109], v7 offset:2048
  ds_read_b64_tr_b16 v[110:111], v7 offset:3072
  buffer_load_dwordx4 a[236:239], v1, s[28:31], s17 offen offset:1024 sc1
  buffer_load_dwordx2 v[172:173], v3, s[4:7], s45 offen offset:32
  v_mfma_f32_32x32x16_bf16 v[16:31], v[48:51], a[176:179], v[16:31]
  ds_read_b64_tr_b16 v[112:113], v11 offset:4096
  ds_read_b64_tr_b16 v[114:115], v11 offset:5120
  v_mfma_f32_32x32x16_bf16 v[32:47], v[52:55], a[176:179], v[32:47]
  ds_read_b64_tr_b16 v[116:117], v7 offset:4096
  ds_read_b64_tr_b16 v[118:119], v7 offset:5120
  buffer_load_dwordx4 a[240:243], v1, s[28:31], s17 offen offset:2048 sc1
  buffer_load_dwordx2 v[174:175], v3, s[4:7], s45 offen offset:48
  v_mfma_f32_32x32x16_bf16 v[16:31], v[56:59], a[180:183], v[16:31]
  s_waitcnt lgkmcnt(4)
  ds_read_b64_tr_b16 v[80:81], v11 offset:6144
  ds_read_b64_tr_b16 v[82:83], v11 offset:7168
  v_mfma_f32_32x32x16_bf16 v[32:47], v[60:63], a[180:183], v[32:47]
  ds_read_b64_tr_b16 v[84:85], v7 offset:6144
  ds_read_b64_tr_b16 v[86:87], v7 offset:7168
  buffer_load_dwordx4 a[244:247], v1, s[28:31], s17 offen offset:3072 sc1
  v_mfma_f32_32x32x16_bf16 v[64:79], v[96:99], a[184:187], 0
  ds_read_b64_tr_b16 v[48:49], v11 offset:8192
  ds_read_b64_tr_b16 v[50:51], v11 offset:9216
  v_mfma_f32_32x32x16_bf16 v[128:143], v[100:103], a[184:187], 0
  ds_read_b64_tr_b16 v[52:53], v7 offset:8192
  ds_read_b64_tr_b16 v[54:55], v7 offset:9216
  v_mfma_f32_32x32x16_bf16 v[64:79], v[104:107], a[188:191], v[64:79]
  s_waitcnt lgkmcnt(4)
  ds_read_b64_tr_b16 v[56:57], v11 offset:10240
  ds_read_b64_tr_b16 v[58:59], v11 offset:11264
  v_mfma_f32_32x32x16_bf16 v[128:143], v[108:111], a[188:191], v[128:143]
  ds_read_b64_tr_b16 v[60:61], v7 offset:10240
  ds_read_b64_tr_b16 v[62:63], v7 offset:11264
  v_add_u32 v5, 32768, v8
  v_add_u32 v6, 32768, v9
  ds_write_b128 v12, v[32:35] offset:0
  ds_write_b128 v12, v[36:39] offset:1024
  v_mfma_f32_32x32x16_bf16 v[64:79], v[112:115], a[192:195], v[64:79]
  s_mov_b32 s51, 0xffff0000
  ds_read_b64_tr_b16 v[96:97], v11 offset:12288
  ds_read_b64_tr_b16 v[98:99], v11 offset:13312
  v_mfma_f32_32x32x16_bf16 v[128:143], v[116:119], a[192:195], v[128:143]
  ds_read_b64_tr_b16 v[100:101], v7 offset:12288
  ds_read_b64_tr_b16 v[102:103], v7 offset:13312
  ds_write_b128 v12, v[40:43] offset:2048
  ds_write_b128 v12, v[44:47] offset:3072
  v_mfma_f32_32x32x16_bf16 v[64:79], v[80:83], a[196:199], v[64:79]
  s_waitcnt lgkmcnt(8)
  ds_read_b64_tr_b16 v[104:105], v11 offset:14336
  ds_read_b64_tr_b16 v[106:107], v11 offset:15360
  v_mfma_f32_32x32x16_bf16 v[128:143], v[84:87], a[196:199], v[128:143]
  s_waitcnt vmcnt(14)
  ds_read_b64_tr_b16 v[108:109], v7 offset:14336
  ds_read_b64_tr_b16 v[110:111], v7 offset:15360
  v_mfma_f32_32x32x16_bf16 v[64:79], v[48:51], a[200:203], v[64:79]
  s_waitcnt lgkmcnt(4)
  s_barrier
  ds_read_b64_tr_b16 v[112:113], v5 offset:0
  ds_read_b64_tr_b16 v[114:115], v5 offset:1024
  v_mfma_f32_32x32x16_bf16 v[128:143], v[52:55], a[200:203], v[128:143]
  ds_read_b64_tr_b16 v[116:117], v6 offset:0
  ds_read_b64_tr_b16 v[118:119], v6 offset:1024
  ds_read_b128 v[176:179], v14 offset:0
  ds_read_b128 v[180:183], v14 offset:1024
  v_mfma_f32_32x32x16_bf16 v[64:79], v[56:59], a[204:207], v[64:79]
  s_waitcnt lgkmcnt(6)
  ds_read_b64_tr_b16 v[80:81], v5 offset:2048
  ds_read_b64_tr_b16 v[82:83], v5 offset:3072
  v_mfma_f32_32x32x16_bf16 v[128:143], v[60:63], a[204:207], v[128:143]
  s_waitcnt vmcnt(12)
  ds_read_b64_tr_b16 v[84:85], v6 offset:2048
  ds_read_b64_tr_b16 v[86:87], v6 offset:3072
  ds_read_b128 v[184:187], v14 offset:2048
  ds_read_b128 v[188:191], v14 offset:3072
  v_mfma_f32_32x32x16_bf16 v[64:79], v[96:99], a[208:211], v[64:79]
  ds_read_b64_tr_b16 v[48:49], v5 offset:4096
  ds_read_b64_tr_b16 v[50:51], v5 offset:5120
  v_mfma_f32_32x32x16_bf16 v[128:143], v[100:103], a[208:211], v[128:143]
  ds_read_b64_tr_b16 v[52:53], v6 offset:4096
  ds_read_b64_tr_b16 v[54:55], v6 offset:5120
  v_mov_b32 v10, 0xbfb8aa3b
  s_waitcnt lgkmcnt(11)
  v_add_f32 v16, v16, v176
  v_add_f32 v17, v17, v177
  v_add_f32 v18, v18, v178
  v_add_f32 v19, v19, v179
  v_mul_f32 v208, v10, v16
  v_mul_f32 v209, v10, v17
  v_mul_f32 v210, v10, v18
  v_mul_f32 v211, v10, v19
  v_exp_f32 v208, v208
  v_mfma_f32_32x32x16_bf16 v[64:79], v[104:107], a[212:215], v[64:79]
  s_waitcnt lgkmcnt(6)
  ds_read_b64_tr_b16 v[56:57], v5 offset:6144
  ds_read_b64_tr_b16 v[58:59], v5 offset:7168
  v_mfma_f32_32x32x16_bf16 v[128:143], v[108:111], a[212:215], v[128:143]
  s_waitcnt vmcnt(10)
  ds_read_b64_tr_b16 v[60:61], v6 offset:6144
  ds_read_b64_tr_b16 v[62:63], v6 offset:7168
  v_exp_f32 v209, v209
  v_exp_f32 v210, v210
  v_exp_f32 v211, v211
  v_add_f32 v208, 1.0, v208
  v_add_f32 v209, 1.0, v209
  v_add_f32 v210, 1.0, v210
  v_add_f32 v211, 1.0, v211
  v_rcp_f32 v208, v208
  v_rcp_f32 v209, v209
  v_rcp_f32 v210, v210
  v_rcp_f32 v211, v211
  v_mul_f32 v16, v16, v208
  v_mfma_f32_32x32x16_bf16 v[64:79], v[112:115], a[216:219], v[64:79]
  ds_read_b64_tr_b16 v[96:97], v5 offset:8192
  ds_read_b64_tr_b16 v[98:99], v5 offset:9216
  v_mfma_f32_32x32x16_bf16 v[128:143], v[116:119], a[216:219], v[128:143]
  ds_read_b64_tr_b16 v[100:101], v6 offset:8192
  ds_read_b64_tr_b16 v[102:103], v6 offset:9216
  v_mul_f32 v17, v17, v209
  v_mul_f32 v18, v18, v210
  v_mul_f32 v19, v19, v211
  v_add_f32 v20, v20, v180
  v_add_f32 v21, v21, v181
  v_add_f32 v22, v22, v182
  v_add_f32 v23, v23, v183
  v_mul_f32 v208, v10, v20
  v_mul_f32 v209, v10, v21
  v_mul_f32 v210, v10, v22
  v_mul_f32 v211, v10, v23
  v_mfma_f32_32x32x16_bf16 v[64:79], v[80:83], a[220:223], v[64:79]
  s_waitcnt lgkmcnt(4)
  ds_read_b64_tr_b16 v[104:105], v5 offset:10240
  ds_read_b64_tr_b16 v[106:107], v5 offset:11264
  v_mfma_f32_32x32x16_bf16 v[128:143], v[84:87], a[220:223], v[128:143]
  s_waitcnt vmcnt(8)
  ds_read_b64_tr_b16 v[108:109], v6 offset:10240
  ds_read_b64_tr_b16 v[110:111], v6 offset:11264
  v_exp_f32 v208, v208
  v_exp_f32 v209, v209
  v_exp_f32 v210, v210
  v_exp_f32 v211, v211
  v_add_f32 v208, 1.0, v208
  v_add_f32 v209, 1.0, v209
  v_add_f32 v210, 1.0, v210
  v_add_f32 v211, 1.0, v211
  v_rcp_f32 v208, v208
  v_rcp_f32 v209, v209
  v_rcp_f32 v210, v210
  v_rcp_f32 v211, v211
  v_mfma_f32_32x32x16_bf16 v[64:79], v[48:51], a[224:227], v[64:79]
  ds_read_b64_tr_b16 v[112:113], v5 offset:12288
  ds_read_b64_tr_b16 v[114:115], v5 offset:13312
  v_mfma_f32_32x32x16_bf16 v[128:143], v[52:55], a[224:227], v[128:143]
  ds_read_b64_tr_b16 v[116:117], v6 offset:12288
  ds_read_b64_tr_b16 v[118:119], v6 offset:13312
  v_mul_f32 v20, v20, v208
  v_mul_f32 v21, v21, v209
  v_mul_f32 v22, v22, v210
  v_mul_f32 v23, v23, v211
  v_add_f32 v24, v24, v184
  v_add_f32 v25, v25, v185
  v_add_f32 v26, v26, v186
  v_add_f32 v27, v27, v187
  v_mul_f32 v208, v10, v24
  v_mul_f32 v209, v10, v25
  v_mul_f32 v210, v10, v26
  v_mfma_f32_32x32x16_bf16 v[64:79], v[56:59], a[228:231], v[64:79]
  s_waitcnt lgkmcnt(4)
  ds_read_b64_tr_b16 v[80:81], v5 offset:14336
  ds_read_b64_tr_b16 v[82:83], v5 offset:15360
  v_mfma_f32_32x32x16_bf16 v[128:143], v[60:63], a[228:231], v[128:143]
  s_waitcnt vmcnt(4)
  ds_read_b64_tr_b16 v[84:85], v6 offset:14336
  ds_read_b64_tr_b16 v[86:87], v6 offset:15360
  v_mul_f32 v211, v10, v27
  v_exp_f32 v208, v208
  v_exp_f32 v209, v209
  v_exp_f32 v210, v210
  v_exp_f32 v211, v211
  v_add_f32 v208, 1.0, v208
  v_add_f32 v209, 1.0, v209
  v_add_f32 v210, 1.0, v210
  v_add_f32 v211, 1.0, v211
  v_rcp_f32 v208, v208
  v_rcp_f32 v209, v209
  v_rcp_f32 v210, v210
  v_mfma_f32_32x32x16_bf16 v[64:79], v[96:99], a[232:235], v[64:79]
  v_mfma_f32_32x32x16_bf16 v[128:143], v[100:103], a[232:235], v[128:143]
  v_rcp_f32 v211, v211
  v_mul_f32 v24, v24, v208
  v_mul_f32 v25, v25, v209
  v_mul_f32 v26, v26, v210
  v_mul_f32 v27, v27, v211
  v_add_f32 v28, v28, v188
  v_add_f32 v29, v29, v189
  v_add_f32 v30, v30, v190
  v_add_f32 v31, v31, v191
  v_mul_f32 v208, v10, v28
  v_mul_f32 v209, v10, v29
  v_mfma_f32_32x32x16_bf16 v[64:79], v[104:107], a[236:239], v[64:79]
  s_waitcnt lgkmcnt(0)
  v_mfma_f32_32x32x16_bf16 v[128:143], v[108:111], a[236:239], v[128:143]
  s_waitcnt vmcnt(0)
  v_mul_f32 v210, v10, v30
  v_mul_f32 v211, v10, v31
  v_exp_f32 v208, v208
  v_exp_f32 v209, v209
  v_exp_f32 v210, v210
  v_exp_f32 v211, v211
  v_add_f32 v208, 1.0, v208
  v_add_f32 v209, 1.0, v209
  v_add_f32 v210, 1.0, v210
  v_add_f32 v211, 1.0, v211
  v_rcp_f32 v208, v208
  v_rcp_f32 v209, v209
  v_mfma_f32_32x32x16_bf16 v[64:79], v[112:115], a[240:243], v[64:79]
  v_mfma_f32_32x32x16_bf16 v[128:143], v[116:119], a[240:243], v[128:143]
  v_rcp_f32 v210, v210
  v_rcp_f32 v211, v211
  v_mul_f32 v28, v28, v208
  v_mul_f32 v29, v29, v209
  v_mul_f32 v30, v30, v210
  v_mul_f32 v31, v31, v211
  v_lshlrev_b32 v176, 16, v168
  v_and_b32 v177, s51, v168
  v_lshlrev_b32 v178, 16, v169
  v_and_b32 v179, s51, v169
  v_lshlrev_b32 v180, 16, v170
  v_mfma_f32_32x32x16_bf16 v[64:79], v[80:83], a[244:247], v[64:79]
  v_mfma_f32_32x32x16_bf16 v[128:143], v[84:87], a[244:247], v[128:143]
  v_and_b32 v181, s51, v170
  v_lshlrev_b32 v182, 16, v171
  v_and_b32 v183, s51, v171
  v_lshlrev_b32 v184, 16, v172
  v_and_b32 v185, s51, v172
  v_lshlrev_b32 v186, 16, v173
  v_and_b32 v187, s51, v173
  v_lshlrev_b32 v188, 16, v174
  v_and_b32 v189, s51, v174
  v_lshlrev_b32 v190, 16, v175
  v_and_b32 v191, s51, v175
  s_nop 0
  ds_write_b128 v12, v[128:131] offset:4096
  ds_write_b128 v12, v[132:135] offset:5120
  ds_write_b128 v12, v[136:139] offset:6144
  ds_write_b128 v12, v[140:143] offset:7168
  s_waitcnt lgkmcnt(0)
  s_barrier
  ds_read_b128 v[192:195], v14 offset:4096
  ds_read_b128 v[196:199], v14 offset:5120
  ds_read_b128 v[200:203], v14 offset:6144
  ds_read_b128 v[204:207], v14 offset:7168
  v_lshrrev_b32 v15, 5, v0
  v_lshl_add_u32 v3, v15, 3, v3
  s_waitcnt lgkmcnt(3)
  v_add_f32 v64, v64, v192
  v_add_f32 v65, v65, v193
  v_add_f32 v66, v66, v194
  v_add_f32 v67, v67, v195
  v_fma_f32 v64, v64, v16, v176
  v_fma_f32 v65, v65, v17, v177
  v_fma_f32 v66, v66, v18, v178
  v_fma_f32 v67, v67, v19, v179
  v_cvt_pk_bf16_f32 v168, v64, v65
  v_cvt_pk_bf16_f32 v169, v66, v67
  s_waitcnt lgkmcnt(2)
  v_add_f32 v68, v68, v196
  v_add_f32 v69, v69, v197
  v_add_f32 v70, v70, v198
  v_add_f32 v71, v71, v199
  v_fma_f32 v68, v68, v20, v180
  v_fma_f32 v69, v69, v21, v181
  v_fma_f32 v70, v70, v22, v182
  v_fma_f32 v71, v71, v23, v183
  v_cvt_pk_bf16_f32 v170, v68, v69
  v_cvt_pk_bf16_f32 v171, v70, v71
  s_nop 0
  v_permlane32_swap_b32 v168, v170
  v_permlane32_swap_b32 v169, v171
  buffer_store_dwordx4 v[168:171], v3, s[24:27], s45 offen offset:0
  s_waitcnt lgkmcnt(1)
  v_add_f32 v72, v72, v200
  v_add_f32 v73, v73, v201
  v_add_f32 v74, v74, v202
  v_add_f32 v75, v75, v203
  v_fma_f32 v72, v72, v24, v184
  v_fma_f32 v73, v73, v25, v185
  v_fma_f32 v74, v74, v26, v186
  v_fma_f32 v75, v75, v27, v187
  v_cvt_pk_bf16_f32 v172, v72, v73
  v_cvt_pk_bf16_f32 v173, v74, v75
  s_waitcnt lgkmcnt(0)
  v_add_f32 v76, v76, v204
  v_add_f32 v77, v77, v205
  v_add_f32 v78, v78, v206
  v_add_f32 v79, v79, v207
  v_fma_f32 v76, v76, v28, v188
  v_fma_f32 v77, v77, v29, v189
  v_fma_f32 v78, v78, v30, v190
  v_fma_f32 v79, v79, v31, v191
  v_cvt_pk_bf16_f32 v174, v76, v77
  v_cvt_pk_bf16_f32 v175, v78, v79
  s_nop 0
  v_permlane32_swap_b32 v172, v174
  v_permlane32_swap_b32 v173, v175
  buffer_store_dwordx4 v[172:175], v3, s[24:27], s45 offen offset:32
  s_or_b32 s50, s2, s42
  s_cmp_eq_u32 s50, 0
  s_cbranch_scc1 L_epoch
  s_waitcnt vmcnt(0)
L_end:
  s_endpgm
L_spin_kv0:
  s_mov_b32 s51, 0x20000
L_spin2_kv0:
  s_lshl_b32 s50, s41, 8
  s_add_u32 s50, s50, 4096
  buffer_load_dword v14, v12, s[28:31], s50 offen sc1
  s_waitcnt vmcnt(0)
  v_cmp_ne_u32 vcc, s43, v14
  s_nop 0
  s_cbranch_vccz L_back_kv0
  s_sub_u32 s51, s51, 1
  s_cmp_lg_u32 s51, 0
  s_cbranch_scc1 L_spin2_kv0
  s_branch L_back_kv0
L_spin_kv1:
  s_mov_b32 s51, 0x20000
L_spin2_kv1:
  s_lshl_b32 s50, s41, 8
  s_add_u32 s50, s50, 4096
  buffer_load_dword v14, v12, s[28:31], s50 offen sc1
  s_waitcnt vmcnt(0)
  v_cmp_ne_u32 vcc, s43, v14
  s_nop 0
  s_cbranch_vccz L_back_kv1
  s_sub_u32 s51, s51, 1
  s_cmp_lg_u32 s51, 0
  s_cbranch_scc1 L_spin2_kv1
  s_branch L_back_kv1
L_spin_ha:
  s_mov_b32 s51, 0x20000
L_spin2_ha:
  s_add_u32 s50, s55, 8192
  buffer_load_dword v14, v12, s[28:31], s50 offen sc1
  s_waitcnt vmcnt(0)
  v_cmp_ne_u32 vcc, s43, v14
  s_nop 0
  s_cbranch_vccz L_back_ha
  s_sub_u32 s51, s51, 1
  s_cmp_lg_u32 s51, 0
  s_cbranch_scc1 L_spin2_ha
  s_branch L_back_ha
L_epre:
  s_mov_b32 s50, 4096
  buffer_load_dwordx4 v[224:227], v1, s[28:31], s50 offen offset:0 sc1
  buffer_load_dwordx4 v[228:231], v1, s[28:31], s50 offen offset:1024 sc1
  buffer_load_dwordx4 v[232:235], v1, s[28:31], s50 offen offset:2048 sc1
  buffer_load_dwordx4 v[236:239], v1, s[28:31], s50 offen offset:3072 sc1
  s_branch L_epre_back
L_spin_o:
  s_mov_b32 s51, 0x20000
L_spin2_o:
  s_add_u32 s50, s55, 12288
  buffer_load_dword v14, v12, s[28:31], s50 offen sc1
  s_waitcnt vmcnt(0)
  v_cmp_ne_u32 vcc, s43, v14
  s_nop 0
  s_cbranch_vccz L_back_o
  s_sub_u32 s51, s51, 1
  s_cmp_lg_u32 s51, 0
  s_cbranch_scc1 L_spin2_o
  s_branch L_back_o
L_epoch:
  s_mov_b32 s51, 0x20000
  s_waitcnt vmcnt(2)
  s_branch L_epoch4
L_epoch2:
  s_mov_b32 s50, 4096
  buffer_load_dwordx4 v[224:227], v1, s[28:31], s50 offen offset:0 sc1
  buffer_load_dwordx4 v[228:231], v1, s[28:31], s50 offen offset:1024 sc1
  buffer_load_dwordx4 v[232:235], v1, s[28:31], s50 offen offset:2048 sc1
  buffer_load_dwordx4 v[236:239], v1, s[28:31], s50 offen offset:3072 sc1
  s_waitcnt vmcnt(0)
L_epoch4:
  v_xor_b32 v224, s43, v224
  v_xor_b32 v225, s43, v225
  v_xor_b32 v226, s43, v226
  v_xor_b32 v227, s43, v227
  v_xor_b32 v228, s43, v228
  v_xor_b32 v229, s43, v229
  v_xor_b32 v230, s43, v230
  v_xor_b32 v231, s43, v231
  v_xor_b32 v232, s43, v232
  v_xor_b32 v233, s43, v233
  v_xor_b32 v234, s43, v234
  v_xor_b32 v235, s43, v235
  v_xor_b32 v236, s43, v236
  v_xor_b32 v237, s43, v237
  v_xor_b32 v238, s43, v238
  v_xor_b32 v239, s43, v239
  v_or_b32 v224, v224, v225
  v_or_b32 v224, v224, v226
  v_or_b32 v224, v224, v227
  v_or_b32 v224, v224, v228
  v_or_b32 v224, v224, v229
  v_or_b32 v224, v224, v230
  v_or_b32 v224, v224, v231
  v_or_b32 v224, v224, v232
  v_or_b32 v224, v224, v233
  v_or_b32 v224, v224, v234
  v_or_b32 v224, v224, v235
  v_or_b32 v224, v224, v236
  v_or_b32 v224, v224, v237
  v_or_b32 v224, v224, v238
  v_or_b32 v224, v224, v239
  v_cmp_ne_u32 vcc, 0, v224
  s_nop 0
  s_cbranch_vccz L_epoch3
  s_sub_u32 s51, s51, 1
  s_cmp_lg_u32 s51, 0
  s_cbranch_scc1 L_epoch2
L_epoch3:
  s_mov_b64 exec, 1
  buffer_store_dword v13, off, s[28:31], 0 offset:0
  s_endpgm
L_hot_end:
L_fb0:
  s_nop 15
  v_mov_b32 v40, 0xff800000
  v_mov_b32 v42, 0xff800000
  s_add_u32 s50, s44, 0
  s_cmp_lt_u32 s50, 8
  s_cbranch_scc1 L_fb0_a0
  v_mfma_f32_32x32x16_bf16 v[24:39], a[0:3], v[112:115], 0
  s_nop 15
  v_cndmask_b32 v24, v24, v42, s[70:71]
  v_cndmask_b32 v25, v25, v42, s[72:73]
  v_cndmask_b32 v26, v26, v42, s[74:75]
  v_cndmask_b32 v27, v27, v42, s[76:77]
  v_cndmask_b32 v28, v28, v42, s[78:79]
  v_cndmask_b32 v29, v29, v42, s[80:81]
  v_cndmask_b32 v30, v30, v42, s[82:83]
  v_cndmask_b32 v31, v31, v42, s[84:85]
  v_cndmask_b32 v32, v32, v42, s[86:87]
  v_cndmask_b32 v33, v33, v42, s[88:89]
  v_cndmask_b32 v34, v34, v42, s[90:91]
  v_cndmask_b32 v35, v35, v42, s[92:93]
  v_cndmask_b32 v36, v36, v42, s[94:95]
  v_cndmask_b32 v37, v37, v42, s[96:97]
  v_cndmask_b32 v38, v38, v42, s[98:99]
  v_cndmask_b32 v39, v39, v42, s[100:101]
  v_max3_f32 v40, v40, v24, v25
  v_max3_f32 v40, v40, v26, v27
  v_max3_f32 v40, v40, v28, v29
  v_max3_f32 v40, v40, v30, v31
  v_max3_f32 v40, v40, v32, v33
  v_max3_f32 v40, v40, v34, v35
  v_max3_f32 v40, v40, v36, v37
  v_max3_f32 v40, v40, v38, v39
L_fb0_a0:
  s_add_u32 s50, s44, 1
  s_cmp_lt_u32 s50, 8
  s_cbranch_scc1 L_fb0_a1
  v_mfma_f32_32x32x16_bf16 v[24:39], a[8:11], v[112:115], 0
  s_nop 15
  v_max3_f32 v40, v40, v24, v25
  v_max3_f32 v40, v40, v26, v27
  v_max3_f32 v40, v40, v28, v29
  v_max3_f32 v40, v40, v30, v31
  v_max3_f32 v40, v40, v32, v33
  v_max3_f32 v40, v40, v34, v35
  v_max3_f32 v40, v40, v36, v37
  v_max3_f32 v40, v40, v38, v39
L_fb0_a1:
  s_add_u32 s50, s44, 2
  s_cmp_lt_u32 s50, 8
  s_cbranch_scc1 L_fb0_a2
  v_mfma_f32_32x32x16_bf16 v[24:39], a[16:19], v[112:115], 0
  s_nop 15
  v_max3_f32 v40, v40, v24, v25
  v_max3_f32 v40, v40, v26, v27
  v_max3_f32 v40, v40, v28, v29
  v_max3_f32 v40, v40, v30, v31
  v_max3_f32 v40, v40, v32, v33
  v_max3_f32 v40, v40, v34, v35
  v_max3_f32 v40, v40, v36, v37
  v_max3_f32 v40, v40, v38, v39
L_fb0_a2:
  s_add_u32 s50, s44, 3
  s_cmp_lt_u32 s50, 8
  s_cbranch_scc1 L_fb0_a3
  v_mfma_f32_32x32x16_bf16 v[24:39], a[24:27], v[112:115], 0
  s_nop 15
  v_max3_f32 v40, v40, v24, v25
  v_max3_f32 v40, v40, v26, v27
  v_max3_f32 v40, v40, v28, v29
  v_max3_f32 v40, v40, v30, v31
  v_max3_f32 v40, v40, v32, v33
  v_max3_f32 v40, v40, v34, v35
  v_max3_f32 v40, v40, v36, v37
  v_max3_f32 v40, v40, v38, v39
L_fb0_a3:
  s_add_u32 s50, s44, 4
  s_cmp_lt_u32 s50, 8
  s_cbranch_scc1 L_fb0_a4
  v_mfma_f32_32x32x16_bf16 v[24:39], a[32:35], v[112:115], 0
  s_nop 15
  v_max3_f32 v40, v40, v24, v25
  v_max3_f32 v40, v40, v26, v27
  v_max3_f32 v40, v40, v28, v29
  v_max3_f32 v40, v40, v30, v31
  v_max3_f32 v40, v40, v32, v33
  v_max3_f32 v40, v40, v34, v35
  v_max3_f32 v40, v40, v36, v37
  v_max3_f32 v40, v40, v38, v39
L_fb0_a4:
  s_add_u32 s50, s44, 5
  s_cmp_lt_u32 s50, 8
  s_cbranch_scc1 L_fb0_a5
  v_mfma_f32_32x32x16_bf16 v[24:39], a[40:43], v[112:115], 0
  s_nop 15
  v_max3_f32 v40, v40, v24, v25
  v_max3_f32 v40, v40, v26, v27
  v_max3_f32 v40, v40, v28, v29
  v_max3_f32 v40, v40, v30, v31
  v_max3_f32 v40, v40, v32, v33
  v_max3_f32 v40, v40, v34, v35
  v_max3_f32 v40, v40, v36, v37
  v_max3_f32 v40, v40, v38, v39
L_fb0_a5:
  s_add_u32 s50, s44, 6
  s_cmp_lt_u32 s50, 8
  s_cbranch_scc1 L_fb0_a6
  v_mfma_f32_32x32x16_bf16 v[24:39], a[48:51], v[112:115], 0
  s_nop 15
  v_max3_f32 v40, v40, v24, v25
  v_max3_f32 v40, v40, v26, v27
  v_max3_f32 v40, v40, v28, v29
  v_max3_f32 v40, v40, v30, v31
  v_max3_f32 v40, v40, v32, v33
  v_max3_f32 v40, v40, v34, v35
  v_max3_f32 v40, v40, v36, v37
  v_max3_f32 v40, v40, v38, v39
L_fb0_a6:
  s_add_u32 s50, s44, 7
  s_cmp_lt_u32 s50, 8
  s_cbranch_scc1 L_fb0_a7
  v_mfma_f32_32x32x16_bf16 v[24:39], a[56:59], v[112:115], 0
  s_nop 15
  v_max3_f32 v40, v40, v24, v25
  v_max3_f32 v40, v40, v26, v27
  v_max3_f32 v40, v40, v28, v29
  v_max3_f32 v40, v40, v30, v31
  v_max3_f32 v40, v40, v32, v33
  v_max3_f32 v40, v40, v34, v35
  v_max3_f32 v40, v40, v36, v37
  v_max3_f32 v40, v40, v38, v39
L_fb0_a7:
  v_mfma_f32_32x32x16_bf16 v[24:39], a[64:67], v[112:115], 0
  s_nop 15
  v_cndmask_b32 v24, v42, v24, s[70:71]
  v_cndmask_b32 v25, v42, v25, s[72:73]
  v_cndmask_b32 v26, v42, v26, s[74:75]
  v_cndmask_b32 v27, v42, v27, s[76:77]
  v_cndmask_b32 v28, v42, v28, s[78:79]
  v_cndmask_b32 v29, v42, v29, s[80:81]
  v_cndmask_b32 v30, v42, v30, s[82:83]
  v_cndmask_b32 v31, v42, v31, s[84:85]
  v_cndmask_b32 v32, v42, v32, s[86:87]
  v_cndmask_b32 v33, v42, v33, s[88:89]
  v_cndmask_b32 v34, v42, v34, s[90:91]
  v_cndmask_b32 v35, v42, v35, s[92:93]
  v_cndmask_b32 v36, v42, v36, s[94:95]
  v_cndmask_b32 v37, v42, v37, s[96:97]
  v_cndmask_b32 v38, v42, v38, s[98:99]
  v_cndmask_b32 v39, v42, v39, s[100:101]
  v_max3_f32 v40, v40, v24, v25
  v_max3_f32 v40, v40, v26, v27
  v_max3_f32 v40, v40, v28, v29
  v_max3_f32 v40, v40, v30, v31
  v_max3_f32 v40, v40, v32, v33
  v_max3_f32 v40, v40, v34, v35
  v_max3_f32 v40, v40, v36, v37
  v_max3_f32 v40, v40, v38, v39
L_fb0_a8:
  v_mov_b32 v41, v40
  s_nop 1
  v_permlane32_swap_b32 v40, v41
  s_nop 1
  v_max_f32 v40, v40, v41
  v_mov_b32 v48, 0
  v_mov_b32 v49, 0
  v_mov_b32 v50, 0
  v_mov_b32 v51, 0
  v_mov_b32 v52, 0
  v_mov_b32 v53, 0
  v_mov_b32 v54, 0
  v_mov_b32 v55, 0
  v_mov_b32 v56, 0
  v_mov_b32 v57, 0
  v_mov_b32 v58, 0
  v_mov_b32 v59, 0
  v_mov_b32 v60, 0
  v_mov_b32 v61, 0
  v_mov_b32 v62, 0
  v_mov_b32 v63, 0
  s_add_u32 s50, s44, 0
  s_cmp_lt_u32 s50, 8
  s_cbranch_scc1 L_fb0_b0
  v_mfma_f32_32x32x16_bf16 v[24:39], a[0:3], v[112:115], 0
  s_nop 15
  v_cndmask_b32 v24, v24, v42, s[70:71]
  v_cndmask_b32 v25, v25, v42, s[72:73]
  v_cndmask_b32 v26, v26, v42, s[74:75]
  v_cndmask_b32 v27, v27, v42, s[76:77]
  v_cndmask_b32 v28, v28, v42, s[78:79]
  v_cndmask_b32 v29, v29, v42, s[80:81]
  v_cndmask_b32 v30, v30, v42, s[82:83]
  v_cndmask_b32 v31, v31, v42, s[84:85]
  v_cndmask_b32 v32, v32, v42, s[86:87]
  v_cndmask_b32 v33, v33, v42, s[88:89]
  v_cndmask_b32 v34, v34, v42, s[90:91]
  v_cndmask_b32 v35, v35, v42, s[92:93]
  v_cndmask_b32 v36, v36, v42, s[94:95]
  v_cndmask_b32 v37, v37, v42, s[96:97]
  v_cndmask_b32 v38, v38, v42, s[98:99]
  v_cndmask_b32 v39, v39, v42, s[100:101]
  v_sub_f32 v24, v24, v40
  v_sub_f32 v25, v25, v40
  v_sub_f32 v26, v26, v40
  v_sub_f32 v27, v27, v40
  v_sub_f32 v28, v28, v40
  v_sub_f32 v29, v29, v40
  v_sub_f32 v30, v30, v40
  v_sub_f32 v31, v31, v40
  v_sub_f32 v32, v32, v40
  v_sub_f32 v33, v33, v40
  v_sub_f32 v34, v34, v40
  v_sub_f32 v35, v35, v40
  v_sub_f32 v36, v36, v40
  v_sub_f32 v37, v37, v40
  v_sub_f32 v38, v38, v40
  v_sub_f32 v39, v39, v40
  v_exp_f32 v24, v24
  v_exp_f32 v25, v25
  v_exp_f32 v26, v26
  v_exp_f32 v27, v27
  v_exp_f32 v28, v28
  v_exp_f32 v29, v29
  v_exp_f32 v30, v30
  v_exp_f32 v31, v31
  v_exp_f32 v32, v32
  v_exp_f32 v33, v33
  v_exp_f32 v34, v34
  v_exp_f32 v35, v35
  v_exp_f32 v36, v36
  v_exp_f32 v37, v37
  v_exp_f32 v38, v38
  v_exp_f32 v39, v39
  s_nop 0
  v_cvt_pk_bf16_f32 v96, v24, v25
  v_cvt_pk_bf16_f32 v97, v26, v27
  v_cvt_pk_bf16_f32 v98, v28, v29
  v_cvt_pk_bf16_f32 v99, v30, v31
  v_cvt_pk_bf16_f32 v100, v32, v33
  v_cvt_pk_bf16_f32 v101, v34, v35
  v_cvt_pk_bf16_f32 v102, v36, v37
  v_cvt_pk_bf16_f32 v103, v38, v39
  s_nop 1
  v_mfma_f32_32x32x16_bf16 v[48:63], a[72:75], v[96:99], v[48:63]
  v_mfma_f32_32x32x16_bf16 v[48:63], a[80:83], v[100:103], v[48:63]
  s_nop 7
L_fb0_b0:
  s_add_u32 s50, s44, 1
  s_cmp_lt_u32 s50, 8
  s_cbranch_scc1 L_fb0_b1
  v_mfma_f32_32x32x16_bf16 v[24:39], a[8:11], v[112:115], 0
  s_nop 15
  v_sub_f32 v24, v24, v40
  v_sub_f32 v25, v25, v40
  v_sub_f32 v26, v26, v40
  v_sub_f32 v27, v27, v40
  v_sub_f32 v28, v28, v40
  v_sub_f32 v29, v29, v40
  v_sub_f32 v30, v30, v40
  v_sub_f32 v31, v31, v40
  v_sub_f32 v32, v32, v40
  v_sub_f32 v33, v33, v40
  v_sub_f32 v34, v34, v40
  v_sub_f32 v35, v35, v40
  v_sub_f32 v36, v36, v40
  v_sub_f32 v37, v37, v40
  v_sub_f32 v38, v38, v40
  v_sub_f32 v39, v39, v40
  v_exp_f32 v24, v24
  v_exp_f32 v25, v25
  v_exp_f32 v26, v26
  v_exp_f32 v27, v27
  v_exp_f32 v28, v28
  v_exp_f32 v29, v29
  v_exp_f32 v30, v30
  v_exp_f32 v31, v31
  v_exp_f32 v32, v32
  v_exp_f32 v33, v33
  v_exp_f32 v34, v34
  v_exp_f32 v35, v35
  v_exp_f32 v36, v36
  v_exp_f32 v37, v37
  v_exp_f32 v38, v38
  v_exp_f32 v39, v39
  s_nop 0
  v_cvt_pk_bf16_f32 v96, v24, v25
  v_cvt_pk_bf16_f32 v97, v26, v27
  v_cvt_pk_bf16_f32 v98, v28, v29
  v_cvt_pk_bf16_f32 v99, v30, v31
  v_cvt_pk_bf16_f32 v100, v32, v33
  v_cvt_pk_bf16_f32 v101, v34, v35
  v_cvt_pk_bf16_f32 v102, v36, v37
  v_cvt_pk_bf16_f32 v103, v38, v39
  s_nop 1
  v_mfma_f32_32x32x16_bf16 v[48:63], a[88:91], v[96:99], v[48:63]
  v_mfma_f32_32x32x16_bf16 v[48:63], a[96:99], v[100:103], v[48:63]
  s_nop 7
L_fb0_b1:
  s_add_u32 s50, s44, 2
  s_cmp_lt_u32 s50, 8
  s_cbranch_scc1 L_fb0_b2
  v_mfma_f32_32x32x16_bf16 v[24:39], a[16:19], v[112:115], 0
  s_nop 15
  v_sub_f32 v24, v24, v40
  v_sub_f32 v25, v25, v40
  v_sub_f32 v26, v26, v40
  v_sub_f32 v27, v27, v40
  v_sub_f32 v28, v28, v40
  v_sub_f32 v29, v29, v40
  v_sub_f32 v30, v30, v40
  v_sub_f32 v31, v31, v40
  v_sub_f32 v32, v32, v40
  v_sub_f32 v33, v33, v40
  v_sub_f32 v34, v34, v40
  v_sub_f32 v35, v35, v40
  v_sub_f32 v36, v36, v40
  v_sub_f32 v37, v37, v40
  v_sub_f32 v38, v38, v40
  v_sub_f32 v39, v39, v40
  v_exp_f32 v24, v24
  v_exp_f32 v25, v25
  v_exp_f32 v26, v26
  v_exp_f32 v27, v27
  v_exp_f32 v28, v28
  v_exp_f32 v29, v29
  v_exp_f32 v30, v30
  v_exp_f32 v31, v31
  v_exp_f32 v32, v32
  v_exp_f32 v33, v33
  v_exp_f32 v34, v34
  v_exp_f32 v35, v35
  v_exp_f32 v36, v36
  v_exp_f32 v37, v37
  v_exp_f32 v38, v38
  v_exp_f32 v39, v39
  s_nop 0
  v_cvt_pk_bf16_f32 v96, v24, v25
  v_cvt_pk_bf16_f32 v97, v26, v27
  v_cvt_pk_bf16_f32 v98, v28, v29
  v_cvt_pk_bf16_f32 v99, v30, v31
  v_cvt_pk_bf16_f32 v100, v32, v33
  v_cvt_pk_bf16_f32 v101, v34, v35
  v_cvt_pk_bf16_f32 v102, v36, v37
  v_cvt_pk_bf16_f32 v103, v38, v39
  s_nop 1
  v_mfma_f32_32x32x16_bf16 v[48:63], a[104:107], v[96:99], v[48:63]
  v_mfma_f32_32x32x16_bf16 v[48:63], a[112:115], v[100:103], v[48:63]
  s_nop 7
L_fb0_b2:
  s_add_u32 s50, s44, 3
  s_cmp_lt_u32 s50, 8
  s_cbranch_scc1 L_fb0_b3
  v_mfma_f32_32x32x16_bf16 v[24:39], a[24:27], v[112:115], 0
  s_nop 15
  v_sub_f32 v24, v24, v40
  v_sub_f32 v25, v25, v40
  v_sub_f32 v26, v26, v40
  v_sub_f32 v27, v27, v40
  v_sub_f32 v28, v28, v40
  v_sub_f32 v29, v29, v40
  v_sub_f32 v30, v30, v40
  v_sub_f32 v31, v31, v40
  v_sub_f32 v32, v32, v40
  v_sub_f32 v33, v33, v40
  v_sub_f32 v34, v34, v40
  v_sub_f32 v35, v35, v40
  v_sub_f32 v36, v36, v40
  v_sub_f32 v37, v37, v40
  v_sub_f32 v38, v38, v40
  v_sub_f32 v39, v39, v40
  v_exp_f32 v24, v24
  v_exp_f32 v25, v25
  v_exp_f32 v26, v26
  v_exp_f32 v27, v27
  v_exp_f32 v28, v28
  v_exp_f32 v29, v29
  v_exp_f32 v30, v30
  v_exp_f32 v31, v31
  v_exp_f32 v32, v32
  v_exp_f32 v33, v33
  v_exp_f32 v34, v34
  v_exp_f32 v35, v35
  v_exp_f32 v36, v36
  v_exp_f32 v37, v37
  v_exp_f32 v38, v38
  v_exp_f32 v39, v39
  s_nop 0
  v_cvt_pk_bf16_f32 v96, v24, v25
  v_cvt_pk_bf16_f32 v97, v26, v27
  v_cvt_pk_bf16_f32 v98, v28, v29
  v_cvt_pk_bf16_f32 v99, v30, v31
  v_cvt_pk_bf16_f32 v100, v32, v33
  v_cvt_pk_bf16_f32 v101, v34, v35
  v_cvt_pk_bf16_f32 v102, v36, v37
  v_cvt_pk_bf16_f32 v103, v38, v39
  s_nop 1
  v_mfma_f32_32x32x16_bf16 v[48:63], a[120:123], v[96:99], v[48:63]
  v_mfma_f32_32x32x16_bf16 v[48:63], a[128:131], v[100:103], v[48:63]
  s_nop 7
L_fb0_b3:
  s_add_u32 s50, s44, 4
  s_cmp_lt_u32 s50, 8
  s_cbranch_scc1 L_fb0_b4
  v_mfma_f32_32x32x16_bf16 v[24:39], a[32:35], v[112:115], 0
  s_nop 15
  v_sub_f32 v24, v24, v40
  v_sub_f32 v25, v25, v40
  v_sub_f32 v26, v26, v40
  v_sub_f32 v27, v27, v40
  v_sub_f32 v28, v28, v40
  v_sub_f32 v29, v29, v40
  v_sub_f32 v30, v30, v40
  v_sub_f32 v31, v31, v40
  v_sub_f32 v32, v32, v40
  v_sub_f32 v33, v33, v40
  v_sub_f32 v34, v34, v40
  v_sub_f32 v35, v35, v40
  v_sub_f32 v36, v36, v40
  v_sub_f32 v37, v37, v40
  v_sub_f32 v38, v38, v40
  v_sub_f32 v39, v39, v40
  v_exp_f32 v24, v24
  v_exp_f32 v25, v25
  v_exp_f32 v26, v26
  v_exp_f32 v27, v27
  v_exp_f32 v28, v28
  v_exp_f32 v29, v29
  v_exp_f32 v30, v30
  v_exp_f32 v31, v31
  v_exp_f32 v32, v32
  v_exp_f32 v33, v33
  v_exp_f32 v34, v34
  v_exp_f32 v35, v35
  v_exp_f32 v36, v36
  v_exp_f32 v37, v37
  v_exp_f32 v38, v38
  v_exp_f32 v39, v39
  s_nop 0
  v_cvt_pk_bf16_f32 v96, v24, v25
  v_cvt_pk_bf16_f32 v97, v26, v27
  v_cvt_pk_bf16_f32 v98, v28, v29
  v_cvt_pk_bf16_f32 v99, v30, v31
  v_cvt_pk_bf16_f32 v100, v32, v33
  v_cvt_pk_bf16_f32 v101, v34, v35
  v_cvt_pk_bf16_f32 v102, v36, v37
  v_cvt_pk_bf16_f32 v103, v38, v39
  s_nop 1
  v_mfma_f32_32x32x16_bf16 v[48:63], a[136:139], v[96:99], v[48:63]
  v_mfma_f32_32x32x16_bf16 v[48:63], a[144:147], v[100:103], v[48:63]
  s_nop 7
L_fb0_b4:
  s_add_u32 s50, s44, 5
  s_cmp_lt_u32 s50, 8
  s_cbranch_scc1 L_fb0_b5
  v_mfma_f32_32x32x16_bf16 v[24:39], a[40:43], v[112:115], 0
  s_nop 15
  v_sub_f32 v24, v24, v40
  v_sub_f32 v25, v25, v40
  v_sub_f32 v26, v26, v40
  v_sub_f32 v27, v27, v40
  v_sub_f32 v28, v28, v40
  v_sub_f32 v29, v29, v40
  v_sub_f32 v30, v30, v40
  v_sub_f32 v31, v31, v40
  v_sub_f32 v32, v32, v40
  v_sub_f32 v33, v33, v40
  v_sub_f32 v34, v34, v40
  v_sub_f32 v35, v35, v40
  v_sub_f32 v36, v36, v40
  v_sub_f32 v37, v37, v40
  v_sub_f32 v38, v38, v40
  v_sub_f32 v39, v39, v40
  v_exp_f32 v24, v24
  v_exp_f32 v25, v25
  v_exp_f32 v26, v26
  v_exp_f32 v27, v27
  v_exp_f32 v28, v28
  v_exp_f32 v29, v29
  v_exp_f32 v30, v30
  v_exp_f32 v31, v31
  v_exp_f32 v32, v32
  v_exp_f32 v33, v33
  v_exp_f32 v34, v34
  v_exp_f32 v35, v35
  v_exp_f32 v36, v36
  v_exp_f32 v37, v37
  v_exp_f32 v38, v38
  v_exp_f32 v39, v39
  s_nop 0
  v_cvt_pk_bf16_f32 v96, v24, v25
  v_cvt_pk_bf16_f32 v97, v26, v27
  v_cvt_pk_bf16_f32 v98, v28, v29
  v_cvt_pk_bf16_f32 v99, v30, v31
  v_cvt_pk_bf16_f32 v100, v32, v33
  v_cvt_pk_bf16_f32 v101, v34, v35
  v_cvt_pk_bf16_f32 v102, v36, v37
  v_cvt_pk_bf16_f32 v103, v38, v39
  s_nop 1
  v_mfma_f32_32x32x16_bf16 v[48:63], a[152:155], v[96:99], v[48:63]
  v_mfma_f32_32x32x16_bf16 v[48:63], a[160:163], v[100:103], v[48:63]
  s_nop 7
L_fb0_b5:
  s_add_u32 s50, s44, 6
  s_cmp_lt_u32 s50, 8
  s_cbranch_scc1 L_fb0_b6
  v_mfma_f32_32x32x16_bf16 v[24:39], a[48:51], v[112:115], 0
  s_nop 15
  v_sub_f32 v24, v24, v40
  v_sub_f32 v25, v25, v40
  v_sub_f32 v26, v26, v40
  v_sub_f32 v27, v27, v40
  v_sub_f32 v28, v28, v40
  v_sub_f32 v29, v29, v40
  v_sub_f32 v30, v30, v40
  v_sub_f32 v31, v31, v40
  v_sub_f32 v32, v32, v40
  v_sub_f32 v33, v33, v40
  v_sub_f32 v34, v34, v40
  v_sub_f32 v35, v35, v40
  v_sub_f32 v36, v36, v40
  v_sub_f32 v37, v37, v40
  v_sub_f32 v38, v38, v40
  v_sub_f32 v39, v39, v40
  v_exp_f32 v24, v24
  v_exp_f32 v25, v25
  v_exp_f32 v26, v26
  v_exp_f32 v27, v27
  v_exp_f32 v28, v28
  v_exp_f32 v29, v29
  v_exp_f32 v30, v30
  v_exp_f32 v31, v31
  v_exp_f32 v32, v32
  v_exp_f32 v33, v33
  v_exp_f32 v34, v34
  v_exp_f32 v35, v35
  v_exp_f32 v36, v36
  v_exp_f32 v37, v37
  v_exp_f32 v38, v38
  v_exp_f32 v39, v39
  s_nop 0
  v_cvt_pk_bf16_f32 v96, v24, v25
  v_cvt_pk_bf16_f32 v97, v26, v27
  v_cvt_pk_bf16_f32 v98, v28, v29
  v_cvt_pk_bf16_f32 v99, v30, v31
  v_cvt_pk_bf16_f32 v100, v32, v33
  v_cvt_pk_bf16_f32 v101, v34, v35
  v_cvt_pk_bf16_f32 v102, v36, v37
  v_cvt_pk_bf16_f32 v103, v38, v39
  s_nop 1
  v_mfma_f32_32x32x16_bf16 v[48:63], a[168:171], v[96:99], v[48:63]
  v_mfma_f32_32x32x16_bf16 v[48:63], a[176:179], v[100:103], v[48:63]
  s_nop 7
L_fb0_b6:
  s_add_u32 s50, s44, 7
  s_cmp_lt_u32 s50, 8
  s_cbranch_scc1 L_fb0_b7
  v_mfma_f32_32x32x16_bf16 v[24:39], a[56:59], v[112:115], 0
  s_nop 15
  v_sub_f32 v24, v24, v40
  v_sub_f32 v25, v25, v40
  v_sub_f32 v26, v26, v40
  v_sub_f32 v27, v27, v40
  v_sub_f32 v28, v28, v40
  v_sub_f32 v29, v29, v40
  v_sub_f32 v30, v30, v40
  v_sub_f32 v31, v31, v40
  v_sub_f32 v32, v32, v40
  v_sub_f32 v33, v33, v40
  v_sub_f32 v34, v34, v40
  v_sub_f32 v35, v35, v40
  v_sub_f32 v36, v36, v40
  v_sub_f32 v37, v37, v40
  v_sub_f32 v38, v38, v40
  v_sub_f32 v39, v39, v40
  v_exp_f32 v24, v24
  v_exp_f32 v25, v25
  v_exp_f32 v26, v26
  v_exp_f32 v27, v27
  v_exp_f32 v28, v28
  v_exp_f32 v29, v29
  v_exp_f32 v30, v30
  v_exp_f32 v31, v31
  v_exp_f32 v32, v32
  v_exp_f32 v33, v33
  v_exp_f32 v34, v34
  v_exp_f32 v35, v35
  v_exp_f32 v36, v36
  v_exp_f32 v37, v37
  v_exp_f32 v38, v38
  v_exp_f32 v39, v39
  s_nop 0
  v_cvt_pk_bf16_f32 v96, v24, v25
  v_cvt_pk_bf16_f32 v97, v26, v27
  v_cvt_pk_bf16_f32 v98, v28, v29
  v_cvt_pk_bf16_f32 v99, v30, v31
  v_cvt_pk_bf16_f32 v100, v32, v33
  v_cvt_pk_bf16_f32 v101, v34, v35
  v_cvt_pk_bf16_f32 v102, v36, v37
  v_cvt_pk_bf16_f32 v103, v38, v39
  s_nop 1
  v_mfma_f32_32x32x16_bf16 v[48:63], a[184:187], v[96:99], v[48:63]
  v_mfma_f32_32x32x16_bf16 v[48:63], a[192:195], v[100:103], v[48:63]
  s_nop 7
L_fb0_b7:
  v_mfma_f32_32x32x16_bf16 v[24:39], a[64:67], v[112:115], 0
  s_nop 15
  v_cndmask_b32 v24, v42, v24, s[70:71]
  v_cndmask_b32 v25, v42, v25, s[72:73]
  v_cndmask_b32 v26, v42, v26, s[74:75]
  v_cndmask_b32 v27, v42, v27, s[76:77]
  v_cndmask_b32 v28, v42, v28, s[78:79]
  v_cndmask_b32 v29, v42, v29, s[80:81]
  v_cndmask_b32 v30, v42, v30, s[82:83]
  v_cndmask_b32 v31, v42, v31, s[84:85]
  v_cndmask_b32 v32, v42, v32, s[86:87]
  v_cndmask_b32 v33, v42, v33, s[88:89]
  v_cndmask_b32 v34, v42, v34, s[90:91]
  v_cndmask_b32 v35, v42, v35, s[92:93]
  v_cndmask_b32 v36, v42, v36, s[94:95]
  v_cndmask_b32 v37, v42, v37, s[96:97]
  v_cndmask_b32 v38, v42, v38, s[98:99]
  v_cndmask_b32 v39, v42, v39, s[100:101]
  v_sub_f32 v24, v24, v40
  v_sub_f32 v25, v25, v40
  v_sub_f32 v26, v26, v40
  v_sub_f32 v27, v27, v40
  v_sub_f32 v28, v28, v40
  v_sub_f32 v29, v29, v40
  v_sub_f32 v30, v30, v40
  v_sub_f32 v31, v31, v40
  v_sub_f32 v32, v32, v40
  v_sub_f32 v33, v33, v40
  v_sub_f32 v34, v34, v40
  v_sub_f32 v35, v35, v40
  v_sub_f32 v36, v36, v40
  v_sub_f32 v37, v37, v40
  v_sub_f32 v38, v38, v40
  v_sub_f32 v39, v39, v40
  v_exp_f32 v24, v24
  v_exp_f32 v25, v25
  v_exp_f32 v26, v26
  v_exp_f32 v27, v27
  v_exp_f32 v28, v28
  v_exp_f32 v29, v29
  v_exp_f32 v30, v30
  v_exp_f32 v31, v31
  v_exp_f32 v32, v32
  v_exp_f32 v33, v33
  v_exp_f32 v34, v34
  v_exp_f32 v35, v35
  v_exp_f32 v36, v36
  v_exp_f32 v37, v37
  v_exp_f32 v38, v38
  v_exp_f32 v39, v39
  s_nop 0
  v_cvt_pk_bf16_f32 v96, v24, v25
  v_cvt_pk_bf16_f32 v97, v26, v27
  v_cvt_pk_bf16_f32 v98, v28, v29
  v_cvt_pk_bf16_f32 v99, v30, v31
  v_cvt_pk_bf16_f32 v100, v32, v33
  v_cvt_pk_bf16_f32 v101, v34, v35
  v_cvt_pk_bf16_f32 v102, v36, v37
  v_cvt_pk_bf16_f32 v103, v38, v39
  s_nop 1
  v_mfma_f32_32x32x16_bf16 v[48:63], a[200:203], v[96:99], v[48:63]
  v_mfma_f32_32x32x16_bf16 v[48:63], a[208:211], v[100:103], v[48:63]
  s_nop 7
L_fb0_b8:
  s_nop 15
  s_branch L_fb0_back
L_fb1:
  s_nop 15
  v_mov_b32 v40, 0xff800000
  v_mov_b32 v42, 0xff800000
  s_add_u32 s50, s44, 0
  s_cmp_lt_u32 s50, 8
  s_cbranch_scc1 L_fb1_a0
  v_mfma_f32_32x32x16_bf16 v[24:39], a[4:7], v[116:119], 0
  s_nop 15
  v_cndmask_b32 v24, v24, v42, s[70:71]
  v_cndmask_b32 v25, v25, v42, s[72:73]
  v_cndmask_b32 v26, v26, v42, s[74:75]
  v_cndmask_b32 v27, v27, v42, s[76:77]
  v_cndmask_b32 v28, v28, v42, s[78:79]
  v_cndmask_b32 v29, v29, v42, s[80:81]
  v_cndmask_b32 v30, v30, v42, s[82:83]
  v_cndmask_b32 v31, v31, v42, s[84:85]
  v_cndmask_b32 v32, v32, v42, s[86:87]
  v_cndmask_b32 v33, v33, v42, s[88:89]
  v_cndmask_b32 v34, v34, v42, s[90:91]
  v_cndmask_b32 v35, v35, v42, s[92:93]
  v_cndmask_b32 v36, v36, v42, s[94:95]
  v_cndmask_b32 v37, v37, v42, s[96:97]
  v_cndmask_b32 v38, v38, v42, s[98:99]
  v_cndmask_b32 v39, v39, v42, s[100:101]
  v_max3_f32 v40, v40, v24, v25
  v_max3_f32 v40, v40, v26, v27
  v_max3_f32 v40, v40, v28, v29
  v_max3_f32 v40, v40, v30, v31
  v_max3_f32 v40, v40, v32, v33
  v_max3_f32 v40, v40, v34, v35
  v_max3_f32 v40, v40, v36, v37
  v_max3_f32 v40, v40, v38, v39
L_fb1_a0:
  s_add_u32 s50, s44, 1
  s_cmp_lt_u32 s50, 8
  s_cbranch_scc1 L_fb1_a1
  v_mfma_f32_32x32x16_bf16 v[24:39], a[12:15], v[116:119], 0
  s_nop 15
  v_max3_f32 v40, v40, v24, v25
  v_max3_f32 v40, v40, v26, v27
  v_max3_f32 v40, v40, v28, v29
  v_max3_f32 v40, v40, v30, v31
  v_max3_f32 v40, v40, v32, v33
  v_max3_f32 v40, v40, v34, v35
  v_max3_f32 v40, v40, v36, v37
  v_max3_f32 v40, v40, v38, v39
L_fb1_a1:
  s_add_u32 s50, s44, 2
  s_cmp_lt_u32 s50, 8
  s_cbranch_scc1 L_fb1_a2
  v_mfma_f32_32x32x16_bf16 v[24:39], a[20:23], v[116:119], 0
  s_nop 15
  v_max3_f32 v40, v40, v24, v25
  v_max3_f32 v40, v40, v26, v27
  v_max3_f32 v40, v40, v28, v29
  v_max3_f32 v40, v40, v30, v31
  v_max3_f32 v40, v40, v32, v33
  v_max3_f32 v40, v40, v34, v35
  v_max3_f32 v40, v40, v36, v37
  v_max3_f32 v40, v40, v38, v39
L_fb1_a2:
  s_add_u32 s50, s44, 3
  s_cmp_lt_u32 s50, 8
  s_cbranch_scc1 L_fb1_a3
  v_mfma_f32_32x32x16_bf16 v[24:39], a[28:31], v[116:119], 0
  s_nop 15
  v_max3_f32 v40, v40, v24, v25
  v_max3_f32 v40, v40, v26, v27
  v_max3_f32 v40, v40, v28, v29
  v_max3_f32 v40, v40, v30, v31
  v_max3_f32 v40, v40, v32, v33
  v_max3_f32 v40, v40, v34, v35
  v_max3_f32 v40, v40, v36, v37
  v_max3_f32 v40, v40, v38, v39
L_fb1_a3:
  s_add_u32 s50, s44, 4
  s_cmp_lt_u32 s50, 8
  s_cbranch_scc1 L_fb1_a4
  v_mfma_f32_32x32x16_bf16 v[24:39], a[36:39], v[116:119], 0
  s_nop 15
  v_max3_f32 v40, v40, v24, v25
  v_max3_f32 v40, v40, v26, v27
  v_max3_f32 v40, v40, v28, v29
  v_max3_f32 v40, v40, v30, v31
  v_max3_f32 v40, v40, v32, v33
  v_max3_f32 v40, v40, v34, v35
  v_max3_f32 v40, v40, v36, v37
  v_max3_f32 v40, v40, v38, v39
L_fb1_a4:
  s_add_u32 s50, s44, 5
  s_cmp_lt_u32 s50, 8
  s_cbranch_scc1 L_fb1_a5
  v_mfma_f32_32x32x16_bf16 v[24:39], a[44:47], v[116:119], 0
  s_nop 15
  v_max3_f32 v40, v40, v24, v25
  v_max3_f32 v40, v40, v26, v27
  v_max3_f32 v40, v40, v28, v29
  v_max3_f32 v40, v40, v30, v31
  v_max3_f32 v40, v40, v32, v33
  v_max3_f32 v40, v40, v34, v35
  v_max3_f32 v40, v40, v36, v37
  v_max3_f32 v40, v40, v38, v39
L_fb1_a5:
  s_add_u32 s50, s44, 6
  s_cmp_lt_u32 s50, 8
  s_cbranch_scc1 L_fb1_a6
  v_mfma_f32_32x32x16_bf16 v[24:39], a[52:55], v[116:119], 0
  s_nop 15
  v_max3_f32 v40, v40, v24, v25
  v_max3_f32 v40, v40, v26, v27
  v_max3_f32 v40, v40, v28, v29
  v_max3_f32 v40, v40, v30, v31
  v_max3_f32 v40, v40, v32, v33
  v_max3_f32 v40, v40, v34, v35
  v_max3_f32 v40, v40, v36, v37
  v_max3_f32 v40, v40, v38, v39
L_fb1_a6:
  s_add_u32 s50, s44, 7
  s_cmp_lt_u32 s50, 8
  s_cbranch_scc1 L_fb1_a7
  v_mfma_f32_32x32x16_bf16 v[24:39], a[60:63], v[116:119], 0
  s_nop 15
  v_max3_f32 v40, v40, v24, v25
  v_max3_f32 v40, v40, v26, v27
  v_max3_f32 v40, v40, v28, v29
  v_max3_f32 v40, v40, v30, v31
  v_max3_f32 v40, v40, v32, v33
  v_max3_f32 v40, v40, v34, v35
  v_max3_f32 v40, v40, v36, v37
  v_max3_f32 v40, v40, v38, v39
L_fb1_a7:
  v_mfma_f32_32x32x16_bf16 v[24:39], a[68:71], v[116:119], 0
  s_nop 15
  v_cndmask_b32 v24, v42, v24, s[70:71]
  v_cndmask_b32 v25, v42, v25, s[72:73]
  v_cndmask_b32 v26, v42, v26, s[74:75]
  v_cndmask_b32 v27, v42, v27, s[76:77]
  v_cndmask_b32 v28, v42, v28, s[78:79]
  v_cndmask_b32 v29, v42, v29, s[80:81]
  v_cndmask_b32 v30, v42, v30, s[82:83]
  v_cndmask_b32 v31, v42, v31, s[84:85]
  v_cndmask_b32 v32, v42, v32, s[86:87]
  v_cndmask_b32 v33, v42, v33, s[88:89]
  v_cndmask_b32 v34, v42, v34, s[90:91]
  v_cndmask_b32 v35, v42, v35, s[92:93]
  v_cndmask_b32 v36, v42, v36, s[94:95]
  v_cndmask_b32 v37, v42, v37, s[96:97]
  v_cndmask_b32 v38, v42, v38, s[98:99]
  v_cndmask_b32 v39, v42, v39, s[100:101]
  v_max3_f32 v40, v40, v24, v25
  v_max3_f32 v40, v40, v26, v27
  v_max3_f32 v40, v40, v28, v29
  v_max3_f32 v40, v40, v30, v31
  v_max3_f32 v40, v40, v32, v33
  v_max3_f32 v40, v40, v34, v35
  v_max3_f32 v40, v40, v36, v37
  v_max3_f32 v40, v40, v38, v39
L_fb1_a8:
  v_mov_b32 v41, v40
  s_nop 1
  v_permlane32_swap_b32 v40, v41
  s_nop 1
  v_max_f32 v40, v40, v41
  v_mov_b32 v64, 0
  v_mov_b32 v65, 0
  v_mov_b32 v66, 0
  v_mov_b32 v67, 0
  v_mov_b32 v68, 0
  v_mov_b32 v69, 0
  v_mov_b32 v70, 0
  v_mov_b32 v71, 0
  v_mov_b32 v72, 0
  v_mov_b32 v73, 0
  v_mov_b32 v74, 0
  v_mov_b32 v75, 0
  v_mov_b32 v76, 0
  v_mov_b32 v77, 0
  v_mov_b32 v78, 0
  v_mov_b32 v79, 0
  s_add_u32 s50, s44, 0
  s_cmp_lt_u32 s50, 8
  s_cbranch_scc1 L_fb1_b0
  v_mfma_f32_32x32x16_bf16 v[24:39], a[4:7], v[116:119], 0
  s_nop 15
  v_cndmask_b32 v24, v24, v42, s[70:71]
  v_cndmask_b32 v25, v25, v42, s[72:73]
  v_cndmask_b32 v26, v26, v42, s[74:75]
  v_cndmask_b32 v27, v27, v42, s[76:77]
  v_cndmask_b32 v28, v28, v42, s[78:79]
  v_cndmask_b32 v29, v29, v42, s[80:81]
  v_cndmask_b32 v30, v30, v42, s[82:83]
  v_cndmask_b32 v31, v31, v42, s[84:85]
  v_cndmask_b32 v32, v32, v42, s[86:87]
  v_cndmask_b32 v33, v33, v42, s[88:89]
  v_cndmask_b32 v34, v34, v42, s[90:91]
  v_cndmask_b32 v35, v35, v42, s[92:93]
  v_cndmask_b32 v36, v36, v42, s[94:95]
  v_cndmask_b32 v37, v37, v42, s[96:97]
  v_cndmask_b32 v38, v38, v42, s[98:99]
  v_cndmask_b32 v39, v39, v42, s[100:101]
  v_sub_f32 v24, v24, v40
  v_sub_f32 v25, v25, v40
  v_sub_f32 v26, v26, v40
  v_sub_f32 v27, v27, v40
  v_sub_f32 v28, v28, v40
  v_sub_f32 v29, v29, v40
  v_sub_f32 v30, v30, v40
  v_sub_f32 v31, v31, v40
  v_sub_f32 v32, v32, v40
  v_sub_f32 v33, v33, v40
  v_sub_f32 v34, v34, v40
  v_sub_f32 v35, v35, v40
  v_sub_f32 v36, v36, v40
  v_sub_f32 v37, v37, v40
  v_sub_f32 v38, v38, v40
  v_sub_f32 v39, v39, v40
  v_exp_f32 v24, v24
  v_exp_f32 v25, v25
  v_exp_f32 v26, v26
  v_exp_f32 v27, v27
  v_exp_f32 v28, v28
  v_exp_f32 v29, v29
  v_exp_f32 v30, v30
  v_exp_f32 v31, v31
  v_exp_f32 v32, v32
  v_exp_f32 v33, v33
  v_exp_f32 v34, v34
  v_exp_f32 v35, v35
  v_exp_f32 v36, v36
  v_exp_f32 v37, v37
  v_exp_f32 v38, v38
  v_exp_f32 v39, v39
  s_nop 0
  v_cvt_pk_bf16_f32 v96, v24, v25
  v_cvt_pk_bf16_f32 v97, v26, v27
  v_cvt_pk_bf16_f32 v98, v28, v29
  v_cvt_pk_bf16_f32 v99, v30, v31
  v_cvt_pk_bf16_f32 v100, v32, v33
  v_cvt_pk_bf16_f32 v101, v34, v35
  v_cvt_pk_bf16_f32 v102, v36, v37
  v_cvt_pk_bf16_f32 v103, v38, v39
  s_nop 1
  v_mfma_f32_32x32x16_bf16 v[64:79], a[76:79], v[96:99], v[64:79]
  v_mfma_f32_32x32x16_bf16 v[64:79], a[84:87], v[100:103], v[64:79]
  s_nop 7
L_fb1_b0:
  s_add_u32 s50, s44, 1
  s_cmp_lt_u32 s50, 8
  s_cbranch_scc1 L_fb1_b1
  v_mfma_f32_32x32x16_bf16 v[24:39], a[12:15], v[116:119], 0
  s_nop 15
  v_sub_f32 v24, v24, v40
  v_sub_f32 v25, v25, v40
  v_sub_f32 v26, v26, v40
  v_sub_f32 v27, v27, v40
  v_sub_f32 v28, v28, v40
  v_sub_f32 v29, v29, v40
  v_sub_f32 v30, v30, v40
  v_sub_f32 v31, v31, v40
  v_sub_f32 v32, v32, v40
  v_sub_f32 v33, v33, v40
  v_sub_f32 v34, v34, v40
  v_sub_f32 v35, v35, v40
  v_sub_f32 v36, v36, v40
  v_sub_f32 v37, v37, v40
  v_sub_f32 v38, v38, v40
  v_sub_f32 v39, v39, v40
  v_exp_f32 v24, v24
  v_exp_f32 v25, v25
  v_exp_f32 v26, v26
  v_exp_f32 v27, v27
  v_exp_f32 v28, v28
  v_exp_f32 v29, v29
  v_exp_f32 v30, v30
  v_exp_f32 v31, v31
  v_exp_f32 v32, v32
  v_exp_f32 v33, v33
  v_exp_f32 v34, v34
  v_exp_f32 v35, v35
  v_exp_f32 v36, v36
  v_exp_f32 v37, v37
  v_exp_f32 v38, v38
  v_exp_f32 v39, v39
  s_nop 0
  v_cvt_pk_bf16_f32 v96, v24, v25
  v_cvt_pk_bf16_f32 v97, v26, v27
  v_cvt_pk_bf16_f32 v98, v28, v29
  v_cvt_pk_bf16_f32 v99, v30, v31
  v_cvt_pk_bf16_f32 v100, v32, v33
  v_cvt_pk_bf16_f32 v101, v34, v35
  v_cvt_pk_bf16_f32 v102, v36, v37
  v_cvt_pk_bf16_f32 v103, v38, v39
  s_nop 1
  v_mfma_f32_32x32x16_bf16 v[64:79], a[92:95], v[96:99], v[64:79]
  v_mfma_f32_32x32x16_bf16 v[64:79], a[100:103], v[100:103], v[64:79]
  s_nop 7
L_fb1_b1:
  s_add_u32 s50, s44, 2
  s_cmp_lt_u32 s50, 8
  s_cbranch_scc1 L_fb1_b2
  v_mfma_f32_32x32x16_bf16 v[24:39], a[20:23], v[116:119], 0
  s_nop 15
  v_sub_f32 v24, v24, v40
  v_sub_f32 v25, v25, v40
  v_sub_f32 v26, v26, v40
  v_sub_f32 v27, v27, v40
  v_sub_f32 v28, v28, v40
  v_sub_f32 v29, v29, v40
  v_sub_f32 v30, v30, v40
  v_sub_f32 v31, v31, v40
  v_sub_f32 v32, v32, v40
  v_sub_f32 v33, v33, v40
  v_sub_f32 v34, v34, v40
  v_sub_f32 v35, v35, v40
  v_sub_f32 v36, v36, v40
  v_sub_f32 v37, v37, v40
  v_sub_f32 v38, v38, v40
  v_sub_f32 v39, v39, v40
  v_exp_f32 v24, v24
  v_exp_f32 v25, v25
  v_exp_f32 v26, v26
  v_exp_f32 v27, v27
  v_exp_f32 v28, v28
  v_exp_f32 v29, v29
  v_exp_f32 v30, v30
  v_exp_f32 v31, v31
  v_exp_f32 v32, v32
  v_exp_f32 v33, v33
  v_exp_f32 v34, v34
  v_exp_f32 v35, v35
  v_exp_f32 v36, v36
  v_exp_f32 v37, v37
  v_exp_f32 v38, v38
  v_exp_f32 v39, v39
  s_nop 0
  v_cvt_pk_bf16_f32 v96, v24, v25
  v_cvt_pk_bf16_f32 v97, v26, v27
  v_cvt_pk_bf16_f32 v98, v28, v29
  v_cvt_pk_bf16_f32 v99, v30, v31
  v_cvt_pk_bf16_f32 v100, v32, v33
  v_cvt_pk_bf16_f32 v101, v34, v35
  v_cvt_pk_bf16_f32 v102, v36, v37
  v_cvt_pk_bf16_f32 v103, v38, v39
  s_nop 1
  v_mfma_f32_32x32x16_bf16 v[64:79], a[108:111], v[96:99], v[64:79]
  v_mfma_f32_32x32x16_bf16 v[64:79], a[116:119], v[100:103], v[64:79]
  s_nop 7
L_fb1_b2:
  s_add_u32 s50, s44, 3
  s_cmp_lt_u32 s50, 8
  s_cbranch_scc1 L_fb1_b3
  v_mfma_f32_32x32x16_bf16 v[24:39], a[28:31], v[116:119], 0
  s_nop 15
  v_sub_f32 v24, v24, v40
  v_sub_f32 v25, v25, v40
  v_sub_f32 v26, v26, v40
  v_sub_f32 v27, v27, v40
  v_sub_f32 v28, v28, v40
  v_sub_f32 v29, v29, v40
  v_sub_f32 v30, v30, v40
  v_sub_f32 v31, v31, v40
  v_sub_f32 v32, v32, v40
  v_sub_f32 v33, v33, v40
  v_sub_f32 v34, v34, v40
  v_sub_f32 v35, v35, v40
  v_sub_f32 v36, v36, v40
  v_sub_f32 v37, v37, v40
  v_sub_f32 v38, v38, v40
  v_sub_f32 v39, v39, v40
  v_exp_f32 v24, v24
  v_exp_f32 v25, v25
  v_exp_f32 v26, v26
  v_exp_f32 v27, v27
  v_exp_f32 v28, v28
  v_exp_f32 v29, v29
  v_exp_f32 v30, v30
  v_exp_f32 v31, v31
  v_exp_f32 v32, v32
  v_exp_f32 v33, v33
  v_exp_f32 v34, v34
  v_exp_f32 v35, v35
  v_exp_f32 v36, v36
  v_exp_f32 v37, v37
  v_exp_f32 v38, v38
  v_exp_f32 v39, v39
  s_nop 0
  v_cvt_pk_bf16_f32 v96, v24, v25
  v_cvt_pk_bf16_f32 v97, v26, v27
  v_cvt_pk_bf16_f32 v98, v28, v29
  v_cvt_pk_bf16_f32 v99, v30, v31
  v_cvt_pk_bf16_f32 v100, v32, v33
  v_cvt_pk_bf16_f32 v101, v34, v35
  v_cvt_pk_bf16_f32 v102, v36, v37
  v_cvt_pk_bf16_f32 v103, v38, v39
  s_nop 1
  v_mfma_f32_32x32x16_bf16 v[64:79], a[124:127], v[96:99], v[64:79]
  v_mfma_f32_32x32x16_bf16 v[64:79], a[132:135], v[100:103], v[64:79]
  s_nop 7
L_fb1_b3:
  s_add_u32 s50, s44, 4
  s_cmp_lt_u32 s50, 8
  s_cbranch_scc1 L_fb1_b4
  v_mfma_f32_32x32x16_bf16 v[24:39], a[36:39], v[116:119], 0
  s_nop 15
  v_sub_f32 v24, v24, v40
  v_sub_f32 v25, v25, v40
  v_sub_f32 v26, v26, v40
  v_sub_f32 v27, v27, v40
  v_sub_f32 v28, v28, v40
  v_sub_f32 v29, v29, v40
  v_sub_f32 v30, v30, v40
  v_sub_f32 v31, v31, v40
  v_sub_f32 v32, v32, v40
  v_sub_f32 v33, v33, v40
  v_sub_f32 v34, v34, v40
  v_sub_f32 v35, v35, v40
  v_sub_f32 v36, v36, v40
  v_sub_f32 v37, v37, v40
  v_sub_f32 v38, v38, v40
  v_sub_f32 v39, v39, v40
  v_exp_f32 v24, v24
  v_exp_f32 v25, v25
  v_exp_f32 v26, v26
  v_exp_f32 v27, v27
  v_exp_f32 v28, v28
  v_exp_f32 v29, v29
  v_exp_f32 v30, v30
  v_exp_f32 v31, v31
  v_exp_f32 v32, v32
  v_exp_f32 v33, v33
  v_exp_f32 v34, v34
  v_exp_f32 v35, v35
  v_exp_f32 v36, v36
  v_exp_f32 v37, v37
  v_exp_f32 v38, v38
  v_exp_f32 v39, v39
  s_nop 0
  v_cvt_pk_bf16_f32 v96, v24, v25
  v_cvt_pk_bf16_f32 v97, v26, v27
  v_cvt_pk_bf16_f32 v98, v28, v29
  v_cvt_pk_bf16_f32 v99, v30, v31
  v_cvt_pk_bf16_f32 v100, v32, v33
  v_cvt_pk_bf16_f32 v101, v34, v35
  v_cvt_pk_bf16_f32 v102, v36, v37
  v_cvt_pk_bf16_f32 v103, v38, v39
  s_nop 1
  v_mfma_f32_32x32x16_bf16 v[64:79], a[140:143], v[96:99], v[64:79]
  v_mfma_f32_32x32x16_bf16 v[64:79], a[148:151], v[100:103], v[64:79]
  s_nop 7
L_fb1_b4:
  s_add_u32 s50, s44, 5
  s_cmp_lt_u32 s50, 8
  s_cbranch_scc1 L_fb1_b5
  v_mfma_f32_32x32x16_bf16 v[24:39], a[44:47], v[116:119], 0
  s_nop 15
  v_sub_f32 v24, v24, v40
  v_sub_f32 v25, v25, v40
  v_sub_f32 v26, v26, v40
  v_sub_f32 v27, v27, v40
  v_sub_f32 v28, v28, v40
  v_sub_f32 v29, v29, v40
  v_sub_f32 v30, v30, v40
  v_sub_f32 v31, v31, v40
  v_sub_f32 v32, v32, v40
  v_sub_f32 v33, v33, v40
  v_sub_f32 v34, v34, v40
  v_sub_f32 v35, v35, v40
  v_sub_f32 v36, v36, v40
  v_sub_f32 v37, v37, v40
  v_sub_f32 v38, v38, v40
  v_sub_f32 v39, v39, v40
  v_exp_f32 v24, v24
  v_exp_f32 v25, v25
  v_exp_f32 v26, v26
  v_exp_f32 v27, v27
  v_exp_f32 v28, v28
  v_exp_f32 v29, v29
  v_exp_f32 v30, v30
  v_exp_f32 v31, v31
  v_exp_f32 v32, v32
  v_exp_f32 v33, v33
  v_exp_f32 v34, v34
  v_exp_f32 v35, v35
  v_exp_f32 v36, v36
  v_exp_f32 v37, v37
  v_exp_f32 v38, v38
  v_exp_f32 v39, v39
  s_nop 0
  v_cvt_pk_bf16_f32 v96, v24, v25
  v_cvt_pk_bf16_f32 v97, v26, v27
  v_cvt_pk_bf16_f32 v98, v28, v29
  v_cvt_pk_bf16_f32 v99, v30, v31
  v_cvt_pk_bf16_f32 v100, v32, v33
  v_cvt_pk_bf16_f32 v101, v34, v35
  v_cvt_pk_bf16_f32 v102, v36, v37
  v_cvt_pk_bf16_f32 v103, v38, v39
  s_nop 1
  v_mfma_f32_32x32x16_bf16 v[64:79], a[156:159], v[96:99], v[64:79]
  v_mfma_f32_32x32x16_bf16 v[64:79], a[164:167], v[100:103], v[64:79]
  s_nop 7
L_fb1_b5:
  s_add_u32 s50, s44, 6
  s_cmp_lt_u32 s50, 8
  s_cbranch_scc1 L_fb1_b6
  v_mfma_f32_32x32x16_bf16 v[24:39], a[52:55], v[116:119], 0
  s_nop 15
  v_sub_f32 v24, v24, v40
  v_sub_f32 v25, v25, v40
  v_sub_f32 v26, v26, v40
  v_sub_f32 v27, v27, v40
  v_sub_f32 v28, v28, v40
  v_sub_f32 v29, v29, v40
  v_sub_f32 v30, v30, v40
  v_sub_f32 v31, v31, v40
  v_sub_f32 v32, v32, v40
  v_sub_f32 v33, v33, v40
  v_sub_f32 v34, v34, v40
  v_sub_f32 v35, v35, v40
  v_sub_f32 v36, v36, v40
  v_sub_f32 v37, v37, v40
  v_sub_f32 v38, v38, v40
  v_sub_f32 v39, v39, v40
  v_exp_f32 v24, v24
  v_exp_f32 v25, v25
  v_exp_f32 v26, v26
  v_exp_f32 v27, v27
  v_exp_f32 v28, v28
  v_exp_f32 v29, v29
  v_exp_f32 v30, v30
  v_exp_f32 v31, v31
  v_exp_f32 v32, v32
  v_exp_f32 v33, v33
  v_exp_f32 v34, v34
  v_exp_f32 v35, v35
  v_exp_f32 v36, v36
  v_exp_f32 v37, v37
  v_exp_f32 v38, v38
  v_exp_f32 v39, v39
  s_nop 0
  v_cvt_pk_bf16_f32 v96, v24, v25
  v_cvt_pk_bf16_f32 v97, v26, v27
  v_cvt_pk_bf16_f32 v98, v28, v29
  v_cvt_pk_bf16_f32 v99, v30, v31
  v_cvt_pk_bf16_f32 v100, v32, v33
  v_cvt_pk_bf16_f32 v101, v34, v35
  v_cvt_pk_bf16_f32 v102, v36, v37
  v_cvt_pk_bf16_f32 v103, v38, v39
  s_nop 1
  v_mfma_f32_32x32x16_bf16 v[64:79], a[172:175], v[96:99], v[64:79]
  v_mfma_f32_32x32x16_bf16 v[64:79], a[180:183], v[100:103], v[64:79]
  s_nop 7
L_fb1_b6:
  s_add_u32 s50, s44, 7
  s_cmp_lt_u32 s50, 8
  s_cbranch_scc1 L_fb1_b7
  v_mfma_f32_32x32x16_bf16 v[24:39], a[60:63], v[116:119], 0
  s_nop 15
  v_sub_f32 v24, v24, v40
  v_sub_f32 v25, v25, v40
  v_sub_f32 v26, v26, v40
  v_sub_f32 v27, v27, v40
  v_sub_f32 v28, v28, v40
  v_sub_f32 v29, v29, v40
  v_sub_f32 v30, v30, v40
  v_sub_f32 v31, v31, v40
  v_sub_f32 v32, v32, v40
  v_sub_f32 v33, v33, v40
  v_sub_f32 v34, v34, v40
  v_sub_f32 v35, v35, v40
  v_sub_f32 v36, v36, v40
  v_sub_f32 v37, v37, v40
  v_sub_f32 v38, v38, v40
  v_sub_f32 v39, v39, v40
  v_exp_f32 v24, v24
  v_exp_f32 v25, v25
  v_exp_f32 v26, v26
  v_exp_f32 v27, v27
  v_exp_f32 v28, v28
  v_exp_f32 v29, v29
  v_exp_f32 v30, v30
  v_exp_f32 v31, v31
  v_exp_f32 v32, v32
  v_exp_f32 v33, v33
  v_exp_f32 v34, v34
  v_exp_f32 v35, v35
  v_exp_f32 v36, v36
  v_exp_f32 v37, v37
  v_exp_f32 v38, v38
  v_exp_f32 v39, v39
  s_nop 0
  v_cvt_pk_bf16_f32 v96, v24, v25
  v_cvt_pk_bf16_f32 v97, v26, v27
  v_cvt_pk_bf16_f32 v98, v28, v29
  v_cvt_pk_bf16_f32 v99, v30, v31
  v_cvt_pk_bf16_f32 v100, v32, v33
  v_cvt_pk_bf16_f32 v101, v34, v35
  v_cvt_pk_bf16_f32 v102, v36, v37
  v_cvt_pk_bf16_f32 v103, v38, v39
  s_nop 1
  v_mfma_f32_32x32x16_bf16 v[64:79], a[188:191], v[96:99], v[64:79]
  v_mfma_f32_32x32x16_bf16 v[64:79], a[196:199], v[100:103], v[64:79]
  s_nop 7
L_fb1_b7:
  v_mfma_f32_32x32x16_bf16 v[24:39], a[68:71], v[116:119], 0
  s_nop 15
  v_cndmask_b32 v24, v42, v24, s[70:71]
  v_cndmask_b32 v25, v42, v25, s[72:73]
  v_cndmask_b32 v26, v42, v26, s[74:75]
  v_cndmask_b32 v27, v42, v27, s[76:77]
  v_cndmask_b32 v28, v42, v28, s[78:79]
  v_cndmask_b32 v29, v42, v29, s[80:81]
  v_cndmask_b32 v30, v42, v30, s[82:83]
  v_cndmask_b32 v31, v42, v31, s[84:85]
  v_cndmask_b32 v32, v42, v32, s[86:87]
  v_cndmask_b32 v33, v42, v33, s[88:89]
  v_cndmask_b32 v34, v42, v34, s[90:91]
  v_cndmask_b32 v35, v42, v35, s[92:93]
  v_cndmask_b32 v36, v42, v36, s[94:95]
  v_cndmask_b32 v37, v42, v37, s[96:97]
  v_cndmask_b32 v38, v42, v38, s[98:99]
  v_cndmask_b32 v39, v42, v39, s[100:101]
  v_sub_f32 v24, v24, v40
  v_sub_f32 v25, v25, v40
  v_sub_f32 v26, v26, v40
  v_sub_f32 v27, v27, v40
  v_sub_f32 v28, v28, v40
  v_sub_f32 v29, v29, v40
  v_sub_f32 v30, v30, v40
  v_sub_f32 v31, v31, v40
  v_sub_f32 v32, v32, v40
  v_sub_f32 v33, v33, v40
  v_sub_f32 v34, v34, v40
  v_sub_f32 v35, v35, v40
  v_sub_f32 v36, v36, v40
  v_sub_f32 v37, v37, v40
  v_sub_f32 v38, v38, v40
  v_sub_f32 v39, v39, v40
  v_exp_f32 v24, v24
  v_exp_f32 v25, v25
  v_exp_f32 v26, v26
  v_exp_f32 v27, v27
  v_exp_f32 v28, v28
  v_exp_f32 v29, v29
  v_exp_f32 v30, v30
  v_exp_f32 v31, v31
  v_exp_f32 v32, v32
  v_exp_f32 v33, v33
  v_exp_f32 v34, v34
  v_exp_f32 v35, v35
  v_exp_f32 v36, v36
  v_exp_f32 v37, v37
  v_exp_f32 v38, v38
  v_exp_f32 v39, v39
  s_nop 0
  v_cvt_pk_bf16_f32 v96, v24, v25
  v_cvt_pk_bf16_f32 v97, v26, v27
  v_cvt_pk_bf16_f32 v98, v28, v29
  v_cvt_pk_bf16_f32 v99, v30, v31
  v_cvt_pk_bf16_f32 v100, v32, v33
  v_cvt_pk_bf16_f32 v101, v34, v35
  v_cvt_pk_bf16_f32 v102, v36, v37
  v_cvt_pk_bf16_f32 v103, v38, v39
  s_nop 1
  v_mfma_f32_32x32x16_bf16 v[64:79], a[204:207], v[96:99], v[64:79]
  v_mfma_f32_32x32x16_bf16 v[64:79], a[212:215], v[100:103], v[64:79]
  s_nop 7
L_fb1_b8:
  s_nop 15
  s_branch L_fb1_back
.section .rodata,"a"
.p2align 6
.amdhsa_kernel recurrent_scan__sliding_block__mixer_channel_mlp__prompt_kernel
  .amdhsa_next_free_vgpr 512
  .amdhsa_next_free_sgpr 102
  .amdhsa_accum_offset 256
  .amdhsa_group_segment_fixed_size 0
  .amdhsa_kernarg_size 88
  .amdhsa_user_sgpr_count 2
  .amdhsa_user_sgpr_kernarg_segment_ptr 1
  .amdhsa_system_sgpr_workgroup_id_x 1
  .amdhsa_float_denorm_mode_32 3
.end_amdhsa_kernel
```
